```python
import torch

def _softmax(x, axis=-1):
    return torch.softmax(x, dim=axis)
def _gelu(x):
    return torch.nn.functional.gelu(x, approximate="tanh")
def _silu(x):
    return torch.nn.functional.silu(x)
def _sigmoid(x):
    return torch.sigmoid(x)
def _layernorm(x, axis=-1, eps=1e-5):
    m = x.mean(dim=axis, keepdim=True)
    v = x.var(dim=axis, keepdim=True, unbiased=False)
    return (x - m) / torch.sqrt(v + eps)
def _scatter_add(tgt, idx, src, axis=0):
    return tgt.clone().index_add_(axis, idx, src)
def _segment_sum(src, seg, n):
    out = torch.zeros((n,) + src.shape[1:], dtype=src.dtype)
    return out.index_add_(0, seg, src)
def _pad(x, pw):
    flat = tuple(v for pair in reversed(pw) for v in pair)
    return torch.nn.functional.pad(x, flat)

kernel_name = 'interleave_layers__linear_attn_block__dense_activation_gelu__prompt'

def setup_inputs():

    _w = (lambda a: (lambda t: t.to(torch.bfloat16) if t.is_floating_point() else t)(torch.as_tensor(a)))
    def _A_setup():
        B, S, D = 1, 2048, 1024
        return {
            "x": _w((lambda *s: torch.randn(*s, dtype=torch.bfloat16) * 0.05)(B, S, D)),
            "wqkv": _w((lambda *s: torch.randn(*s, dtype=torch.bfloat16) * 0.05)(D, 3 * D)),
            "wo": _w((lambda *s: torch.randn(*s, dtype=torch.bfloat16) * 0.05)(D, D)),
        }
    _A_in = _A_setup()

    def _B_setup():
        B, S, D, F = 1, 2048, 1024, 3584
        return {
            "x": _w((lambda *s: torch.randn(*s, dtype=torch.bfloat16) * 0.05)(B, S, D)),
            "w1": _w((lambda *s: torch.randn(*s, dtype=torch.bfloat16) * 3.2)(D, F) * (D ** -0.5)),
            "b1": _w((lambda *s: torch.randn(*s, dtype=torch.bfloat16) * 0.8)(F) * 0.01),
            "w2": _w((lambda *s: torch.randn(*s, dtype=torch.bfloat16) * 0.8)(F, D) * (F ** -0.5)),
            "b2": _w((lambda *s: torch.randn(*s, dtype=torch.bfloat16) * 0.8)(D) * 0.01),
        }
    _B_in = _B_setup()

    return {
        "A_x": _A_in["x"],
        "A_wqkv": _A_in["wqkv"],
        "A_wo": _A_in["wo"],
        "B_x": _B_in["x"],
        "B_w1": _B_in["w1"],
        "B_b1": _B_in["b1"],
        "B_w2": _B_in["w2"],
        "B_b2": _B_in["b2"],
    }

def reference(A_x, A_wqkv, A_wo, B_x, B_w1, B_b1, B_w2, B_b2):
    def _A_ref(x, wqkv, wo):
        B, S, D = x.shape
        H = 32; Dh = D // H
        qkv = (lambda x, *d: x.permute(*d))((x @ wqkv).reshape(B, S, 3, H, Dh), 2, 0, 3, 1, 4)
        q, k, v = qkv[0], qkv[1], qkv[2]
        phi = lambda t: torch.where(t > 0, t + 1, torch.exp(t)) + 1e-6
        pq, pk = phi(q), phi(k)
        kv = torch.einsum("bhsd,bhse->bhde", pk, v)
        z = torch.einsum("bhsd->bhd", pk)
        num = torch.einsum("bhqd,bhde->bhqe", pq, kv)
        den = torch.einsum("bhqd,bhd->bhq", pq, z)[..., None] + 1e-6
        o = num / den
        return (lambda x, *d: x.permute(*d))(o, 0, 2, 1, 3).reshape(B, S, D) @ wo

    def _B_ref(x, w1, b1, w2, b2):
        h = torch.einsum("bsd,df->bsf", x, w1) + b1
        h = _gelu(h)
        return torch.einsum("bsf,fd->bsd", h, w2) + b2

    x = A_x
    x = x + _A_ref(_layernorm(x, axis=-1), A_wqkv, A_wo)
    x = x + _B_ref(_layernorm(x, axis=-1), B_w1, B_b1, B_w2, B_b2)
    x = x + _A_ref(_layernorm(x, axis=-1), A_wqkv, A_wo)
    x = x + _B_ref(_layernorm(x, axis=-1), B_w1, B_b1, B_w2, B_b2)
    return x
```

```asm
; @launch grid=(256,1,1) block=(512,1,1) lds=162112
.amdgcn_target "amdgcn-amd-amdhsa--gfx950"
.text
.globl interleave_layers__linear_attn_block__dense_activation_gelu__prompt_kernel
.p2align 8
.type interleave_layers__linear_attn_block__dense_activation_gelu__prompt_kernel,@function
interleave_layers__linear_attn_block__dense_activation_gelu__prompt_kernel:
    s_cmp_ge_u32 s2, 256
    s_cbranch_scc1 L_end
    s_nop 0
    s_load_dwordx16 s[24:39], s[0:1], 0
    s_load_dwordx4 s[40:43], s[0:1], 64
    s_load_dwordx2 s[16:17], s[0:1], 80
    v_lshrrev_b32 v1, 6, v0
    v_and_b32 v0, 63, v0
    v_readfirstlane_b32 s6, v1
    s_getpc_b64 s[58:59]
L_pc:
    s_sub_u32 s58, s58, L_pc-interleave_layers__linear_attn_block__dense_activation_gelu__prompt_kernel
    s_subb_u32 s59, s59, 0
    s_lshr_b32 s50, s2, 3
    s_lshl_b32 s50, s50, 3
    s_add_u32 s50, s50, s6
    s_lshl_b32 s50, s50, 8
    v_and_b32 v20, 1, v0
    v_lshl_add_u32 v20, v20, 7, s50
    v_min_u32 v20, L_end-interleave_layers__linear_attn_block__dense_activation_gelu__prompt_kernel, v20
    global_load_dword v254, v20, s[58:59]
    s_and_b32 s5, s2, 7
    s_lshr_b32 s4, s2, 5
    s_and_b32 s48, s2, 1
    s_lshl_b32 s48, s48, 3
    s_add_u32 s4, s4, s48
    s_nop 0
    s_bfe_u32 s3, s2, 0x20003
    s_lshr_b32 s48, s48, 2
    s_and_b32 s48, s48, 0
    s_xor_b32 s48, s48, s2
    s_and_b32 s48, s48, 6
    s_lshl_b32 s48, s48, 1
    s_add_u32 s3, s3, s48
    s_mov_b32 s7, 0
    s_mov_b32 s47, 0
    s_mov_b32 s44, 1
    s_nop 0
    s_mov_b32 s85, 2097152
    s_mov_b32 s18, 268435456
    s_mov_b32 s19, 0x20000
    s_and_b32 s56, s6, 4
    s_and_b32 s6, s6, 3
    s_lshl_b32 s66, s6, 12
    s_lshl_b32 s67, s6, 11
    v_lshrrev_b32 v16, 3, v0
    s_lshl_b32 s48, s6, 4
    v_add_u32 v24, s48, v16
    v_and_b32 v18, 7, v0
    v_and_b32 v17, 2, v16
    v_xor_b32 v17, v17, v18
    v_lshlrev_b32 v27, 4, v17
    v_add_u32 v16, s48, v24
    v_lshlrev_b32 v16, 11, v16
    v_lshrrev_b32 v17, 4, v0
    v_xor_b32_e64 v17, v17, v18
    v_lshl_add_u32 v4, v17, 4, v16
    v_xor_b32_e64 v5, 64, v4
    v_add_u32 v5, 15360, v5
    v_add_u32 v6, 30720, v4
    v_add_u32 v7, 30720, v5
    s_lshl_b32 s82, s4, 7
    s_nop 0
    s_add_u32 s80, s82, 2048
    s_add_u32 s81, s82, 4096
    s_mov_b32 s49, 6144
    v_mul_lo_u32 v16, v24, s49
    v_add_u32 v16, v16, v27
    v_xor_b32 v17, 64, v16
    v_add_u32 v17, 48128, v17
    v_add_u32 v8, s80, v16
    v_add_u32 v9, s80, v17
    v_add_u32 v10, s81, v16
    v_add_u32 v11, s81, v17
    v_add_u32 v12, s82, v16
    v_add_u32 v13, s82, v17
    s_lshl_b32 s48, s3, 18
    s_lshl_b32 s64, s3, 7
    s_mul_i32 s65, s3, 393216
    s_add_u32 m0, s66, 135168
    s_waitcnt lgkmcnt(0)
    s_add_u32 s8, s24, s48
    s_addc_u32 s9, s25, 0
    s_nop 0
    s_mov_b32 s10, 262144
    s_mov_b32 s11, 0x20000
    s_cmp_lg_u32 s56, 0
    s_cbranch_scc1 L_loader
    buffer_load_dwordx4 v4, s[8:11], s82 offen offset:0 lds
    buffer_load_dwordx4 v5, s[8:11], s82 offen offset:1024 lds
    buffer_load_dwordx4 v6, s[8:11], s82 offen offset:2048 lds
    buffer_load_dwordx4 v7, s[8:11], s82 offen offset:3072 lds
    s_branch L_compute
L_loader:
    s_mov_b32 s12, s26
    s_mov_b32 s13, s27
    s_nop 0
    s_mov_b32 s14, 6291456
    s_mov_b32 s15, 0x20000
    s_add_u32 m0, s67, 0
    s_nop 0
    buffer_load_dwordx4 v8, s[12:15], s65 offen offset:0 lds
    buffer_load_dwordx4 v9, s[12:15], s65 offen offset:1024 lds
    s_add_u32 m0, s67, 8192
    s_nop 0
    s_nop 0
    buffer_load_dwordx4 v10, s[12:15], s65 offen offset:0 lds
    buffer_load_dwordx4 v11, s[12:15], s65 offen offset:1024 lds
    s_add_u32 m0, s67, 16384
    s_nop 0
    s_nop 0
    buffer_load_dwordx4 v12, s[12:15], s65 offen offset:0 lds
    buffer_load_dwordx4 v13, s[12:15], s65 offen offset:1024 lds
    s_add_u32 m0, s66, 86016
    s_nop 0
    s_nop 0
    buffer_load_dwordx4 v4, s[8:11], s64 offen offset:0 sc1 lds
    buffer_load_dwordx4 v5, s[8:11], s64 offen offset:1024 sc1 lds
    buffer_load_dwordx4 v6, s[8:11], s64 offen offset:2048 sc1 lds
    buffer_load_dwordx4 v7, s[8:11], s64 offen offset:3072 sc1 lds
    s_lshl_b32 s68, s6, 10
    s_nop 0
    s_mov_b32 s72, 128
    s_and_b32 s63, s2, 1
    s_mul_i32 s63, s63, 24
    s_mov_b32 s75, s63
    s_lshr_b32 s62, s3, 1
    s_and_b32 s62, s62, 6
    s_nop 0
    s_mov_b32 s48, 0x76543210
    s_mov_b32 s49, 0xfedcba98
    s_lshl_b32 s52, s62, 3
    s_lshr_b64 s[100:101], s[48:49], s52
    s_sub_u32 s52, 64, s52
    s_lshl_b64 s[48:49], s[48:49], s52
    s_or_b64 s[100:101], s[100:101], s[48:49]
    s_mov_b32 s99, s100
    s_and_b32 s48, s3, 3
    s_nop 0
    s_mul_i32 s48, s48, 0x1111
    s_xor_b32 s100, s100, s48
    s_nop 0
    s_bfe_u32 s69, s100, 0x40004
    s_mul_i32 s73, s69, s72
    s_lshl_b32 s69, s69, 6
    s_mul_i32 s74, s69, 6144
    s_add_u32 m0, s67, 28672
    s_nop 0
    s_nop 0
    buffer_load_dwordx4 v8, s[12:15], s74 offen offset:0 lds
    buffer_load_dwordx4 v9, s[12:15], s74 offen offset:1024 lds
    s_add_u32 m0, s67, 36864
    s_nop 0
    s_nop 0
    buffer_load_dwordx4 v10, s[12:15], s74 offen offset:0 lds
    buffer_load_dwordx4 v11, s[12:15], s74 offen offset:1024 lds
    s_add_u32 m0, s67, 45056
    s_nop 0
    s_nop 0
    buffer_load_dwordx4 v12, s[12:15], s74 offen offset:0 lds
    buffer_load_dwordx4 v13, s[12:15], s74 offen offset:1024 lds
    s_add_u32 m0, s66, 102400
    s_nop 0
    s_nop 0
    buffer_load_dwordx4 v4, s[8:11], s73 offen offset:0 sc1 lds
    buffer_load_dwordx4 v5, s[8:11], s73 offen offset:1024 sc1 lds
    buffer_load_dwordx4 v6, s[8:11], s73 offen offset:2048 sc1 lds
    buffer_load_dwordx4 v7, s[8:11], s73 offen offset:3072 sc1 lds
    s_lshr_b32 s48, s6, 1
    s_lshl_b32 s48, s48, 5
    s_and_b32 s49, s6, 1
    s_lshl_b32 s49, s49, 3
    s_add_u32 s48, s48, s49
    s_nop 0
    v_bfe_u32 v16, v0, 3, 2
    v_lshrrev_b32_e64 v17, 5, v0
    v_lshl_add_u32 v16, v17, 4, v16
    v_add_u32_e64 v25, s48, v16
    v_bfe_u32 v16, v0, 2, 2
    v_lshl_add_u32 v16, v17, 2, v16
    v_and_b32_e64 v18, 16, v0
    v_add3_u32 v26, v16, v18, s48
    v_lshlrev_b32 v17, 1, v17
    v_and_b32 v18, 3, v0
    v_xor_b32 v17, v17, v18
    v_lshlrev_b32 v28, 4, v17
    v_lshlrev_b32 v32, 2, v0
    v_lshlrev_b32 v33, 4, v0
    s_lshl_b32 s48, s6, 8
    v_add_u32 v34, s48, v32
    s_lshl_b32 s48, s3, 8
    v_add_u32 v36, s48, v32
    v_lshrrev_b32 v16, 2, v0
    v_and_b32 v16, 7, v16
    v_lshlrev_b32_e64 v16, 7, v16
    v_lshl_add_u32 v16, v18, 2, v16
    s_lshl_b32 s48, s3, 4
    s_andn2_b32 s49, 8, s4
    s_add_u32 s48, s48, s49
    s_lshl_b32 s48, s48, 7
    s_add_u32 s48, s48, 65536
    v_add_u32 v37, s48, v16
    v_lshrrev_b32 v17, 4, v0
    v_and_b32 v16, 15, v0
    v_lshlrev_b32 v16, 4, v16
    v_lshl_add_u32 v16, v17, 12, v16
    s_lshl_b32 s48, s6, 8
    v_add_u32 v35, s48, v16
    v_bfe_u32 v16, v0, 2, 2
    v_lshl_add_u32 v16, v17, 3, v16
    v_lshlrev_b32_e64 v18, 3, v18
    v_bfe_u32 v17, v0, 3, 2
    v_lshl_add_u32 v29, v17, 5, v18
    v_lshl_add_u32 v29, v16, 7, v29
    v_lshrrev_b32_e64 v17, 1, v17
    v_lshl_add_u32 v30, v17, 5, v18
    v_lshl_add_u32 v30, v16, 6, v30
    s_lshr_b32 s88, s2, 3
    s_lshl_b32 s88, s88, 1
    s_lshr_b32 s48, s6, 1
    s_add_u32 s88, s88, s48
    s_and_b32 s89, s6, 1
    s_lshl_b32 s89, s89, 6
    s_getreg_b32 s48, hwreg(HW_REG_XCC_ID, 0, 4)
    s_and_b32 s48, s48, 7
    s_mul_i32 s49, s48, s48
    s_lshl_b32 s48, s48, 6
    s_lshl_b32 s49, s49, 14
    s_add_u32 s87, s48, s49
    s_add_u32 s87, s87, 1
    s_lshl_b32 s80, s4, 7
    s_xor_b32 s81, s80, 1024
    s_mov_b32 s49, 2048
    v_mul_lo_u32 v16, v25, s49
    v_add_u32 v16, v16, v27
    v_xor_b32 v17, 64, v16
    v_add_u32 v17, 7168, v17
    v_add_u32 v44, s80, v16
    v_add_u32 v45, s80, v17
    v_add_u32 v46, s81, v16
    v_add_u32 v47, s81, v17
    s_and_b32 s48, s4, 7
    s_lshl_b32 s48, s48, 7
    s_lshr_b32 s49, s4, 3
    s_nop 0
    s_mul_i32 s80, s49, 3072
    s_add_u32 s80, s80, s48
    s_nop 0
    s_add_u32 s81, s80, 1024
    s_add_u32 s82, s80, 2048
    s_lshl_b32 s49, s49, 6
    s_add_u32 s83, s48, s49
    s_add_u32 s83, s83, 6144
    s_mov_b32 s49, 7168
    v_mul_lo_u32 v16, v25, s49
    v_add_u32 v16, v16, v27
    v_xor_b32 v17, 64, v16
    v_add_u32 v17, 27648, v17
    v_add_u32 v48, s80, v16
    v_add_u32 v49, s80, v17
    v_add_u32 v50, s81, v16
    v_add_u32 v51, s81, v17
    v_add_u32 v52, s82, v16
    v_add_u32 v53, s82, v17
    v_mul_lo_u32 v18, v26, s49
    v_add3_u32 v54, v18, v28, s83
    s_waitcnt vmcnt(10)
L_l_layer:
    s_barrier
    s_cmp_lg_u32 s7, 0
    s_cbranch_scc1 csd_1
    s_lshl_b32 s48, s6, 13
    s_add_u32 s48, s48, 0
    v_add_u32 v16, s48, v29
    v_xor_b32 v17, 0, v16
    ds_read_b64_tr_b16 v[64:65], v17 offset:0
    ds_read_b64_tr_b16 v[66:67], v17 offset:512
    ds_read_b64_tr_b16 v[68:69], v17 offset:4096
    ds_read_b64_tr_b16 v[70:71], v17 offset:4608
    v_xor_b32_e64 v17, 32, v16
    ds_read_b64_tr_b16 v[72:73], v17 offset:0
    ds_read_b64_tr_b16 v[74:75], v17 offset:512
    ds_read_b64_tr_b16 v[76:77], v17 offset:4096
    ds_read_b64_tr_b16 v[78:79], v17 offset:4608
    v_xor_b32_e64 v17, 64, v16
    ds_read_b64_tr_b16 v[80:81], v17 offset:0
    ds_read_b64_tr_b16 v[82:83], v17 offset:512
    ds_read_b64_tr_b16 v[84:85], v17 offset:4096
    ds_read_b64_tr_b16 v[86:87], v17 offset:4608
    v_xor_b32 v17, 96, v16
    ds_read_b64_tr_b16 v[88:89], v17 offset:0
    ds_read_b64_tr_b16 v[90:91], v17 offset:512
    ds_read_b64_tr_b16 v[92:93], v17 offset:4096
    ds_read_b64_tr_b16 v[94:95], v17 offset:4608
csd_1:
    s_bfe_u32 s69, s100, 0x40008
    s_lshl_b32 s69, s69, 6
    s_nop 0
    s_mul_i32 s65, s69, 6144
    s_add_u32 m0, s67, 57344
    s_nop 0
    s_nop 0
    buffer_load_dwordx4 v8, s[12:15], s65 offen offset:0 lds
    buffer_load_dwordx4 v9, s[12:15], s65 offen offset:1024 lds
    s_add_u32 m0, s67, 65536
    s_nop 0
    s_nop 0
    buffer_load_dwordx4 v10, s[12:15], s65 offen offset:0 lds
    buffer_load_dwordx4 v11, s[12:15], s65 offen offset:1024 lds
    s_add_u32 m0, s67, 73728
    s_nop 0
    s_nop 0
    buffer_load_dwordx4 v12, s[12:15], s65 offen offset:0 lds
    buffer_load_dwordx4 v13, s[12:15], s65 offen offset:1024 lds
    s_cmp_eq_u32 s7, 0
    s_cbranch_scc1 f0_4
    s_add_u32 s84, s47, -7
    s_cmp_ge_u32 s4, 8
    s_cselect_b32 s76, 0, -1
    s_cselect_b32 s77, -1, 0
poll_5:
    buffer_load_dword v38, v36, s[16:19], 0 offen sc1
    s_waitcnt vmcnt(0)
pollc_6:
    v_cmp_le_u32 vcc, s84, v38
    s_nop 0
    s_andn2_b64 s[78:79], s[76:77], vcc
    s_cbranch_scc0 polld_7
    s_sub_u32 s85, s85, 1
    s_cbranch_scc0 poll_5
    s_mov_b32 s85, 0
polld_7:
    s_bfe_u32 s69, s100, 0x40004
    s_mul_i32 s73, s69, s72
    s_nop 0
    s_add_u32 m0, s66, 102400
    s_nop 0
    s_nop 0
    buffer_load_dwordx4 v4, s[8:11], s73 offen offset:0 sc1 lds
    buffer_load_dwordx4 v5, s[8:11], s73 offen offset:1024 sc1 lds
    buffer_load_dwordx4 v6, s[8:11], s73 offen offset:2048 sc1 lds
    buffer_load_dwordx4 v7, s[8:11], s73 offen offset:3072 sc1 lds
f0_4:
    s_bfe_u32 s69, s100, 0x40008
    s_mul_i32 s64, s69, s72
    s_nop 0
    s_add_u32 m0, s66, 118784
    s_nop 0
    s_nop 0
    buffer_load_dwordx4 v4, s[8:11], s64 offen offset:0 sc1 lds
    buffer_load_dwordx4 v5, s[8:11], s64 offen offset:1024 sc1 lds
    buffer_load_dwordx4 v6, s[8:11], s64 offen offset:2048 sc1 lds
    buffer_load_dwordx4 v7, s[8:11], s64 offen offset:3072 sc1 lds
    s_cmp_lg_u32 s7, 0
    s_cbranch_scc1 csd_8
    s_waitcnt lgkmcnt(0)
csd_8:
    s_nop 0
    s_bfe_u32 s48, s99, 0x40010
    s_lshl_b32 s48, s48, 6
    s_add_u32 s48, s48, s88
    s_mul_i32 s48, s48, 6144
    s_add_u32 s48, s48, s89
    s_and_b32 s49, s4, 8
    s_mul_i32 s49, s49, 128
    s_add_u32 s48, s48, s49
    s_add_u32 s92, s26, s48
    s_addc_u32 s93, s27, 0
    s_nop 0
    s_load_dword s94, s[92:93], 384
    s_load_dword s94, s[92:93], 2432
    s_load_dword s94, s[92:93], 4480
    s_bfe_u32 s69, s100, 0x4000c
    s_mul_i32 s73, s69, s72
    s_lshl_b32 s69, s69, 6
    s_mul_i32 s74, s69, 6144
    s_waitcnt vmcnt(10)
    s_cmp_eq_u32 s7, 0
    s_cbranch_scc1 wc_11
    s_waitcnt vmcnt(4)
wc_11:
    s_barrier
    s_nop 0
    s_add_u32 m0, s66, 86016
    s_nop 0
    s_nop 0
    buffer_load_dwordx4 v4, s[8:11], s73 offen offset:0 sc1 lds
    buffer_load_dwordx4 v5, s[8:11], s73 offen offset:1024 sc1 lds
    buffer_load_dwordx4 v6, s[8:11], s73 offen offset:2048 sc1 lds
    buffer_load_dwordx4 v7, s[8:11], s73 offen offset:3072 sc1 lds
    s_add_u32 m0, s67, 0
    s_nop 0
    buffer_load_dwordx4 v8, s[12:15], s74 offen offset:0 lds
    buffer_load_dwordx4 v9, s[12:15], s74 offen offset:1024 lds
    s_add_u32 m0, s67, 8192
    s_nop 0
    s_nop 0
    buffer_load_dwordx4 v10, s[12:15], s74 offen offset:0 lds
    buffer_load_dwordx4 v11, s[12:15], s74 offen offset:1024 lds
    s_add_u32 m0, s67, 16384
    s_nop 0
    s_nop 0
    buffer_load_dwordx4 v12, s[12:15], s74 offen offset:0 lds
    buffer_load_dwordx4 v13, s[12:15], s74 offen offset:1024 lds
    s_bfe_u32 s48, s99, 0x40014
    s_lshl_b32 s48, s48, 6
    s_add_u32 s48, s48, s88
    s_mul_i32 s48, s48, 6144
    s_add_u32 s48, s48, s89
    s_and_b32 s49, s4, 8
    s_mul_i32 s49, s49, 128
    s_add_u32 s48, s48, s49
    s_add_u32 s92, s26, s48
    s_addc_u32 s93, s27, 0
    s_nop 0
    s_load_dword s94, s[92:93], 384
    s_load_dword s94, s[92:93], 2432
    s_load_dword s94, s[92:93], 4480
    s_bfe_u32 s69, s100, 0x40010
    s_mul_i32 s64, s69, s72
    s_lshl_b32 s69, s69, 6
    s_mul_i32 s65, s69, 6144
    s_cmp_lg_u32 s7, 0
    s_cbranch_scc1 csd_12
    v_mov_b32 v112, 0x3f803f80
    v_mov_b32 v113, 0x3f803f80
    v_mov_b32 v114, 0x3f803f80
    v_mov_b32 v115, 0x3f803f80
    s_nop 1
    s_nop 0
    v_mfma_f32_16x16x32_bf16 v[96:99], v[112:115], v[64:67], 0
    v_mfma_f32_16x16x32_bf16 v[96:99], v[112:115], v[68:71], v[96:99]
    v_mfma_f32_16x16x32_bf16 v[100:103], v[112:115], v[72:75], 0
    v_mfma_f32_16x16x32_bf16 v[100:103], v[112:115], v[76:79], v[100:103]
    v_mfma_f32_16x16x32_bf16 v[104:107], v[112:115], v[80:83], 0
    v_mfma_f32_16x16x32_bf16 v[104:107], v[112:115], v[84:87], v[104:107]
    v_mfma_f32_16x16x32_bf16 v[108:111], v[112:115], v[88:91], 0
    v_mfma_f32_16x16x32_bf16 v[108:111], v[112:115], v[92:95], v[108:111]
    s_lshl_b32 s48, s4, 14
    s_lshl_b32 s49, s3, 10
    s_add_u32 s48, s48, s49
    s_nop 0
    s_add_u32 s48, s48, 2097152
    v_cmp_gt_u32 vcc, 16, v0
    s_nop 1
    v_cndmask_b32 v96, v100, v96, vcc
    v_cmp_gt_u32 vcc, 48, v0
    s_nop 1
    v_cndmask_b32 v104, v108, v104, vcc
    v_cmp_gt_u32 vcc, 32, v0
    s_nop 1
    v_cndmask_b32_e64 v96, v104, v96, vcc
    buffer_store_dword v96, v34, s[16:19], s48 offen sc1
csd_12:
    s_waitcnt vmcnt(11)
    s_cmp_eq_u32 s7, 0
    s_cbranch_scc1 wc_15
    s_waitcnt vmcnt(10)
wc_15:
    s_barrier
    s_nop 0
    s_add_u32 m0, s66, 102400
    s_nop 0
    s_nop 0
    buffer_load_dwordx4 v4, s[8:11], s64 offen offset:0 sc1 lds
    buffer_load_dwordx4 v5, s[8:11], s64 offen offset:1024 sc1 lds
    buffer_load_dwordx4 v6, s[8:11], s64 offen offset:2048 sc1 lds
    buffer_load_dwordx4 v7, s[8:11], s64 offen offset:3072 sc1 lds
    s_add_u32 m0, s67, 28672
    s_nop 0
    s_nop 0
    buffer_load_dwordx4 v8, s[12:15], s65 offen offset:0 lds
    buffer_load_dwordx4 v9, s[12:15], s65 offen offset:1024 lds
    s_add_u32 m0, s67, 36864
    s_nop 0
    s_nop 0
    buffer_load_dwordx4 v10, s[12:15], s65 offen offset:0 lds
    buffer_load_dwordx4 v11, s[12:15], s65 offen offset:1024 lds
    s_add_u32 m0, s67, 45056
    s_nop 0
    s_nop 0
    buffer_load_dwordx4 v12, s[12:15], s65 offen offset:0 lds
    buffer_load_dwordx4 v13, s[12:15], s65 offen offset:1024 lds
    s_bfe_u32 s48, s99, 0x40018
    s_lshl_b32 s48, s48, 6
    s_add_u32 s48, s48, s88
    s_mul_i32 s48, s48, 6144
    s_add_u32 s48, s48, s89
    s_and_b32 s49, s4, 8
    s_mul_i32 s49, s49, 128
    s_add_u32 s48, s48, s49
    s_add_u32 s92, s26, s48
    s_addc_u32 s93, s27, 0
    s_nop 0
    s_load_dword s94, s[92:93], 384
    s_load_dword s94, s[92:93], 2432
    s_load_dword s94, s[92:93], 4480
    s_bfe_u32 s69, s100, 0x40014
    s_mul_i32 s73, s69, s72
    s_lshl_b32 s69, s69, 6
    s_mul_i32 s74, s69, 6144
    s_cmp_lg_u32 s7, 0
    s_cbranch_scc1 jt_16
    s_lshl_b32 s48, s2, 2
    s_add_u32 s48, s48, s6
    s_mul_i32 s49, s48, 2048
    s_add_u32 s90, s28, s49
    s_addc_u32 s91, s29, 0
    s_load_dword s94, s[90:91], 0
    s_load_dword s94, s[90:91], 64
    s_load_dword s94, s[90:91], 128
    s_load_dword s94, s[90:91], 192
    s_load_dword s94, s[90:91], 256
    s_load_dword s94, s[90:91], 320
jt_16:
    s_waitcnt vmcnt(11)
    s_cmp_eq_u32 s7, 0
    s_cbranch_scc1 wc_17
    s_waitcnt vmcnt(10)
wc_17:
    s_barrier
    s_nop 0
    s_add_u32 m0, s66, 118784
    s_nop 0
    s_nop 0
    buffer_load_dwordx4 v4, s[8:11], s73 offen offset:0 sc1 lds
    buffer_load_dwordx4 v5, s[8:11], s73 offen offset:1024 sc1 lds
    buffer_load_dwordx4 v6, s[8:11], s73 offen offset:2048 sc1 lds
    buffer_load_dwordx4 v7, s[8:11], s73 offen offset:3072 sc1 lds
    s_add_u32 m0, s67, 57344
    s_nop 0
    s_nop 0
    buffer_load_dwordx4 v8, s[12:15], s74 offen offset:0 lds
    buffer_load_dwordx4 v9, s[12:15], s74 offen offset:1024 lds
    s_add_u32 m0, s67, 65536
    s_nop 0
    s_nop 0
    buffer_load_dwordx4 v10, s[12:15], s74 offen offset:0 lds
    buffer_load_dwordx4 v11, s[12:15], s74 offen offset:1024 lds
    s_add_u32 m0, s67, 73728
    s_nop 0
    s_nop 0
    buffer_load_dwordx4 v12, s[12:15], s74 offen offset:0 lds
    buffer_load_dwordx4 v13, s[12:15], s74 offen offset:1024 lds
    s_bfe_u32 s48, s99, 0x4001c
    s_lshl_b32 s48, s48, 6
    s_add_u32 s48, s48, s88
    s_mul_i32 s48, s48, 6144
    s_add_u32 s48, s48, s89
    s_and_b32 s49, s4, 8
    s_mul_i32 s49, s49, 128
    s_add_u32 s48, s48, s49
    s_add_u32 s92, s26, s48
    s_addc_u32 s93, s27, 0
    s_nop 0
    s_load_dword s94, s[92:93], 384
    s_load_dword s94, s[92:93], 2432
    s_load_dword s94, s[92:93], 4480
    s_bfe_u32 s69, s100, 0x40018
    s_mul_i32 s64, s69, s72
    s_lshl_b32 s69, s69, 6
    s_mul_i32 s65, s69, 6144
    s_cmp_lg_u32 s7, 0
    s_cbranch_scc1 jt_18
    s_lshl_b32 s48, s2, 2
    s_add_u32 s48, s48, s6
    s_mul_i32 s49, s48, 2048
    s_add_u32 s90, s28, s49
    s_addc_u32 s91, s29, 0
    s_load_dword s94, s[90:91], 384
    s_load_dword s94, s[90:91], 448
    s_load_dword s94, s[90:91], 512
    s_load_dword s94, s[90:91], 576
    s_load_dword s94, s[90:91], 640
    s_load_dword s94, s[90:91], 704
jt_18:
    s_waitcnt vmcnt(10)
    s_barrier
    s_add_u32 m0, s66, 86016
    s_nop 0
    s_nop 0
    buffer_load_dwordx4 v4, s[8:11], s64 offen offset:0 sc1 lds
    buffer_load_dwordx4 v5, s[8:11], s64 offen offset:1024 sc1 lds
    buffer_load_dwordx4 v6, s[8:11], s64 offen offset:2048 sc1 lds
    buffer_load_dwordx4 v7, s[8:11], s64 offen offset:3072 sc1 lds
    s_add_u32 m0, s67, 0
    s_nop 0
    buffer_load_dwordx4 v8, s[12:15], s65 offen offset:0 lds
    buffer_load_dwordx4 v9, s[12:15], s65 offen offset:1024 lds
    s_add_u32 m0, s67, 8192
    s_nop 0
    s_nop 0
    buffer_load_dwordx4 v10, s[12:15], s65 offen offset:0 lds
    buffer_load_dwordx4 v11, s[12:15], s65 offen offset:1024 lds
    s_add_u32 m0, s67, 16384
    s_nop 0
    s_nop 0
    buffer_load_dwordx4 v12, s[12:15], s65 offen offset:0 lds
    buffer_load_dwordx4 v13, s[12:15], s65 offen offset:1024 lds
    s_bfe_u32 s48, s101, 0x40000
    s_lshl_b32 s48, s48, 6
    s_add_u32 s48, s48, s88
    s_mul_i32 s48, s48, 6144
    s_add_u32 s48, s48, s89
    s_and_b32 s49, s4, 8
    s_mul_i32 s49, s49, 128
    s_add_u32 s48, s48, s49
    s_add_u32 s92, s26, s48
    s_addc_u32 s93, s27, 0
    s_nop 0
    s_load_dword s94, s[92:93], 384
    s_load_dword s94, s[92:93], 2432
    s_load_dword s94, s[92:93], 4480
    s_bfe_u32 s69, s100, 0x4001c
    s_mul_i32 s73, s69, s72
    s_lshl_b32 s69, s69, 6
    s_mul_i32 s74, s69, 6144
    s_cmp_lg_u32 s7, 0
    s_cbranch_scc1 jt_19
    s_lshl_b32 s48, s2, 2
    s_add_u32 s48, s48, s6
    s_mul_i32 s49, s48, 2048
    s_add_u32 s90, s28, s49
    s_addc_u32 s91, s29, 0
    s_load_dword s94, s[90:91], 768
    s_load_dword s94, s[90:91], 832
    s_load_dword s94, s[90:91], 896
    s_load_dword s94, s[90:91], 960
    s_load_dword s94, s[90:91], 1024
    s_load_dword s94, s[90:91], 1088
jt_19:
    s_waitcnt vmcnt(10)
    s_barrier
    buffer_load_dword v38, v37, s[16:19], 0 offen sc1
    s_add_u32 m0, s66, 102400
    s_nop 0
    s_nop 0
    buffer_load_dwordx4 v4, s[8:11], s73 offen offset:0 sc1 lds
    buffer_load_dwordx4 v5, s[8:11], s73 offen offset:1024 sc1 lds
    buffer_load_dwordx4 v6, s[8:11], s73 offen offset:2048 sc1 lds
    buffer_load_dwordx4 v7, s[8:11], s73 offen offset:3072 sc1 lds
    s_add_u32 m0, s67, 28672
    s_nop 0
    s_nop 0
    buffer_load_dwordx4 v8, s[12:15], s74 offen offset:0 lds
    buffer_load_dwordx4 v9, s[12:15], s74 offen offset:1024 lds
    s_add_u32 m0, s67, 36864
    s_nop 0
    s_nop 0
    buffer_load_dwordx4 v10, s[12:15], s74 offen offset:0 lds
    buffer_load_dwordx4 v11, s[12:15], s74 offen offset:1024 lds
    s_add_u32 m0, s67, 45056
    s_nop 0
    s_nop 0
    buffer_load_dwordx4 v12, s[12:15], s74 offen offset:0 lds
    buffer_load_dwordx4 v13, s[12:15], s74 offen offset:1024 lds
    s_bfe_u32 s48, s101, 0x40004
    s_lshl_b32 s48, s48, 6
    s_add_u32 s48, s48, s88
    s_mul_i32 s48, s48, 6144
    s_add_u32 s48, s48, s89
    s_and_b32 s49, s4, 8
    s_mul_i32 s49, s49, 128
    s_add_u32 s48, s48, s49
    s_add_u32 s92, s26, s48
    s_addc_u32 s93, s27, 0
    s_nop 0
    s_load_dword s94, s[92:93], 384
    s_load_dword s94, s[92:93], 2432
    s_load_dword s94, s[92:93], 4480
    s_bfe_u32 s69, s101, 0x40000
    s_mul_i32 s64, s69, s72
    s_lshl_b32 s69, s69, 6
    s_mul_i32 s65, s69, 6144
    s_cmp_lg_u32 s7, 0
    s_cbranch_scc1 jt_20
    s_lshl_b32 s48, s2, 2
    s_add_u32 s48, s48, s6
    s_mul_i32 s49, s48, 2048
    s_add_u32 s90, s28, s49
    s_addc_u32 s91, s29, 0
    s_load_dword s94, s[90:91], 1152
    s_load_dword s94, s[90:91], 1216
    s_load_dword s94, s[90:91], 1280
    s_load_dword s94, s[90:91], 1344
    s_load_dword s94, s[90:91], 1408
    s_load_dword s94, s[90:91], 1472
jt_20:
    s_waitcnt vmcnt(10)
    s_barrier
    s_cmp_eq_u32 s7, 0
    s_cbranch_scc1 fc_21
    s_add_u32 s84, s47, -7
    s_cmp_lt_u32 s4, 8
    s_cselect_b32 s76, 0, -1
    s_cselect_b32 s77, -1, 0
    v_cmp_le_u32 vcc, s84, v38
    s_nop 0
    s_andn2_b64 s[78:79], s[76:77], vcc
    s_cbranch_scc1 fcc_22
fc_21:
    s_add_u32 m0, s66, 118784
    s_nop 0
    s_nop 0
    buffer_load_dwordx4 v4, s[8:11], s64 offen offset:0 sc1 lds
    buffer_load_dwordx4 v5, s[8:11], s64 offen offset:1024 sc1 lds
    buffer_load_dwordx4 v6, s[8:11], s64 offen offset:2048 sc1 lds
    buffer_load_dwordx4 v7, s[8:11], s64 offen offset:3072 sc1 lds
    s_add_u32 m0, s67, 57344
    s_nop 0
    s_nop 0
    buffer_load_dwordx4 v8, s[12:15], s65 offen offset:0 lds
    buffer_load_dwordx4 v9, s[12:15], s65 offen offset:1024 lds
    s_add_u32 m0, s67, 65536
    s_nop 0
    s_nop 0
    buffer_load_dwordx4 v10, s[12:15], s65 offen offset:0 lds
    buffer_load_dwordx4 v11, s[12:15], s65 offen offset:1024 lds
    s_add_u32 m0, s67, 73728
    s_nop 0
    s_nop 0
    buffer_load_dwordx4 v12, s[12:15], s65 offen offset:0 lds
    buffer_load_dwordx4 v13, s[12:15], s65 offen offset:1024 lds
    s_bfe_u32 s48, s101, 0x40008
    s_lshl_b32 s48, s48, 6
    s_add_u32 s48, s48, s88
    s_mul_i32 s48, s48, 6144
    s_add_u32 s48, s48, s89
    s_and_b32 s49, s4, 8
    s_mul_i32 s49, s49, 128
    s_add_u32 s48, s48, s49
    s_add_u32 s92, s26, s48
    s_addc_u32 s93, s27, 0
    s_nop 0
    s_load_dword s94, s[92:93], 384
    s_load_dword s94, s[92:93], 2432
    s_load_dword s94, s[92:93], 4480
    s_bfe_u32 s69, s101, 0x40004
    s_mul_i32 s73, s69, s72
    s_lshl_b32 s69, s69, 6
    s_mul_i32 s74, s69, 6144
    s_cmp_lg_u32 s7, 0
    s_cbranch_scc1 jt_26
    s_lshl_b32 s48, s2, 2
    s_add_u32 s48, s48, s6
    s_mul_i32 s49, s48, 2048
    s_add_u32 s90, s28, s49
    s_addc_u32 s91, s29, 0
    s_load_dword s94, s[90:91], 1536
    s_load_dword s94, s[90:91], 1600
    s_load_dword s94, s[90:91], 1664
    s_load_dword s94, s[90:91], 1728
    s_load_dword s94, s[90:91], 1792
    s_load_dword s94, s[90:91], 1856
jt_26:
    s_waitcnt vmcnt(10)
    s_barrier
    s_add_u32 m0, s66, 86016
    s_nop 0
    s_nop 0
    buffer_load_dwordx4 v4, s[8:11], s73 offen offset:0 sc1 lds
    buffer_load_dwordx4 v5, s[8:11], s73 offen offset:1024 sc1 lds
    buffer_load_dwordx4 v6, s[8:11], s73 offen offset:2048 sc1 lds
    buffer_load_dwordx4 v7, s[8:11], s73 offen offset:3072 sc1 lds
    s_add_u32 m0, s67, 0
    s_nop 0
    buffer_load_dwordx4 v8, s[12:15], s74 offen offset:0 lds
    buffer_load_dwordx4 v9, s[12:15], s74 offen offset:1024 lds
    s_add_u32 m0, s67, 8192
    s_nop 0
    s_nop 0
    buffer_load_dwordx4 v10, s[12:15], s74 offen offset:0 lds
    buffer_load_dwordx4 v11, s[12:15], s74 offen offset:1024 lds
    s_add_u32 m0, s67, 16384
    s_nop 0
    s_nop 0
    buffer_load_dwordx4 v12, s[12:15], s74 offen offset:0 lds
    buffer_load_dwordx4 v13, s[12:15], s74 offen offset:1024 lds
    s_bfe_u32 s48, s101, 0x4000c
    s_lshl_b32 s48, s48, 6
    s_add_u32 s48, s48, s88
    s_mul_i32 s48, s48, 6144
    s_add_u32 s48, s48, s89
    s_and_b32 s49, s4, 8
    s_mul_i32 s49, s49, 128
    s_add_u32 s48, s48, s49
    s_add_u32 s92, s26, s48
    s_addc_u32 s93, s27, 0
    s_nop 0
    s_load_dword s94, s[92:93], 384
    s_load_dword s94, s[92:93], 2432
    s_load_dword s94, s[92:93], 4480
    s_bfe_u32 s69, s101, 0x40008
    s_mul_i32 s64, s69, s72
    s_lshl_b32 s69, s69, 6
    s_mul_i32 s65, s69, 6144
    s_cmp_lg_u32 s7, 0
    s_cbranch_scc1 jt_27
    s_lshl_b32 s48, s2, 2
    s_add_u32 s48, s48, s6
    s_mul_i32 s49, s48, 2048
    s_add_u32 s90, s28, s49
    s_addc_u32 s91, s29, 0
    s_load_dword s94, s[90:91], 1920
    s_load_dword s94, s[90:91], 1984
    s_mul_i32 s49, s48, 7168
    s_add_u32 s90, s32, s49
    s_addc_u32 s91, s33, 0
    s_load_dword s94, s[90:91], 0
    s_load_dword s94, s[90:91], 64
    s_load_dword s94, s[90:91], 128
    s_load_dword s94, s[90:91], 192
jt_27:
    s_waitcnt vmcnt(10)
    s_barrier
    s_add_u32 m0, s66, 102400
    s_nop 0
    s_nop 0
    buffer_load_dwordx4 v4, s[8:11], s64 offen offset:0 sc1 lds
    buffer_load_dwordx4 v5, s[8:11], s64 offen offset:1024 sc1 lds
    buffer_load_dwordx4 v6, s[8:11], s64 offen offset:2048 sc1 lds
    buffer_load_dwordx4 v7, s[8:11], s64 offen offset:3072 sc1 lds
    s_add_u32 m0, s67, 28672
    s_nop 0
    s_nop 0
    buffer_load_dwordx4 v8, s[12:15], s65 offen offset:0 lds
    buffer_load_dwordx4 v9, s[12:15], s65 offen offset:1024 lds
    s_add_u32 m0, s67, 36864
    s_nop 0
    s_nop 0
    buffer_load_dwordx4 v10, s[12:15], s65 offen offset:0 lds
    buffer_load_dwordx4 v11, s[12:15], s65 offen offset:1024 lds
    s_add_u32 m0, s67, 45056
    s_nop 0
    s_nop 0
    buffer_load_dwordx4 v12, s[12:15], s65 offen offset:0 lds
    buffer_load_dwordx4 v13, s[12:15], s65 offen offset:1024 lds
    s_bfe_u32 s48, s101, 0x40010
    s_lshl_b32 s48, s48, 6
    s_add_u32 s48, s48, s88
    s_mul_i32 s48, s48, 6144
    s_add_u32 s48, s48, s89
    s_and_b32 s49, s4, 8
    s_mul_i32 s49, s49, 128
    s_add_u32 s48, s48, s49
    s_add_u32 s92, s26, s48
    s_addc_u32 s93, s27, 0
    s_nop 0
    s_load_dword s94, s[92:93], 384
    s_load_dword s94, s[92:93], 2432
    s_load_dword s94, s[92:93], 4480
    s_bfe_u32 s69, s101, 0x4000c
    s_mul_i32 s73, s69, s72
    s_lshl_b32 s69, s69, 6
    s_mul_i32 s74, s69, 6144
    s_cmp_lg_u32 s7, 0
    s_cbranch_scc1 jt_28
    s_lshl_b32 s48, s2, 2
    s_add_u32 s48, s48, s6
    s_mul_i32 s49, s48, 7168
    s_add_u32 s90, s32, s49
    s_addc_u32 s91, s33, 0
    s_load_dword s94, s[90:91], 256
    s_load_dword s94, s[90:91], 320
    s_load_dword s94, s[90:91], 384
    s_load_dword s94, s[90:91], 448
    s_load_dword s94, s[90:91], 512
    s_load_dword s94, s[90:91], 576
jt_28:
    s_waitcnt vmcnt(10)
    s_barrier
    s_add_u32 m0, s66, 118784
    s_nop 0
    s_nop 0
    buffer_load_dwordx4 v4, s[8:11], s73 offen offset:0 sc1 lds
    buffer_load_dwordx4 v5, s[8:11], s73 offen offset:1024 sc1 lds
    buffer_load_dwordx4 v6, s[8:11], s73 offen offset:2048 sc1 lds
    buffer_load_dwordx4 v7, s[8:11], s73 offen offset:3072 sc1 lds
    s_add_u32 m0, s67, 57344
    s_nop 0
    s_nop 0
    buffer_load_dwordx4 v8, s[12:15], s74 offen offset:0 lds
    buffer_load_dwordx4 v9, s[12:15], s74 offen offset:1024 lds
    s_add_u32 m0, s67, 65536
    s_nop 0
    s_nop 0
    buffer_load_dwordx4 v10, s[12:15], s74 offen offset:0 lds
    buffer_load_dwordx4 v11, s[12:15], s74 offen offset:1024 lds
    s_add_u32 m0, s67, 73728
    s_nop 0
    s_nop 0
    buffer_load_dwordx4 v12, s[12:15], s74 offen offset:0 lds
    buffer_load_dwordx4 v13, s[12:15], s74 offen offset:1024 lds
    s_bfe_u32 s48, s101, 0x40014
    s_lshl_b32 s48, s48, 6
    s_add_u32 s48, s48, s88
    s_mul_i32 s48, s48, 6144
    s_add_u32 s48, s48, s89
    s_and_b32 s49, s4, 8
    s_mul_i32 s49, s49, 128
    s_add_u32 s48, s48, s49
    s_add_u32 s92, s26, s48
    s_addc_u32 s93, s27, 0
    s_nop 0
    s_load_dword s94, s[92:93], 384
    s_load_dword s94, s[92:93], 2432
    s_load_dword s94, s[92:93], 4480
    s_bfe_u32 s69, s101, 0x40010
    s_mul_i32 s64, s69, s72
    s_lshl_b32 s69, s69, 6
    s_mul_i32 s65, s69, 6144
    s_cmp_lg_u32 s7, 0
    s_cbranch_scc1 jt_29
    s_lshl_b32 s48, s2, 2
    s_add_u32 s48, s48, s6
    s_mul_i32 s49, s48, 7168
    s_add_u32 s90, s32, s49
    s_addc_u32 s91, s33, 0
    s_load_dword s94, s[90:91], 640
    s_load_dword s94, s[90:91], 704
    s_load_dword s94, s[90:91], 768
    s_load_dword s94, s[90:91], 832
    s_load_dword s94, s[90:91], 896
    s_load_dword s94, s[90:91], 960
jt_29:
    s_waitcnt vmcnt(10)
    s_barrier
    s_cmp_lg_u32 s7, 0
    s_cbranch_scc1 jpd_30
    s_mov_b32 s20, s42
    s_mov_b32 s21, s43
    s_mov_b32 s22, 256
    s_mov_b32 s23, 0x20000
    buffer_load_dword v38, v32, s[20:23], 0 offen sc1
jpd_30:
    s_add_u32 m0, s66, 86016
    s_nop 0
    s_nop 0
    buffer_load_dwordx4 v4, s[8:11], s64 offen offset:0 sc1 lds
    buffer_load_dwordx4 v5, s[8:11], s64 offen offset:1024 sc1 lds
    buffer_load_dwordx4 v6, s[8:11], s64 offen offset:2048 sc1 lds
    buffer_load_dwordx4 v7, s[8:11], s64 offen offset:3072 sc1 lds
    s_add_u32 m0, s67, 0
    s_nop 0
    buffer_load_dwordx4 v8, s[12:15], s65 offen offset:0 lds
    buffer_load_dwordx4 v9, s[12:15], s65 offen offset:1024 lds
    s_add_u32 m0, s67, 8192
    s_nop 0
    s_nop 0
    buffer_load_dwordx4 v10, s[12:15], s65 offen offset:0 lds
    buffer_load_dwordx4 v11, s[12:15], s65 offen offset:1024 lds
    s_add_u32 m0, s67, 16384
    s_nop 0
    s_nop 0
    buffer_load_dwordx4 v12, s[12:15], s65 offen offset:0 lds
    buffer_load_dwordx4 v13, s[12:15], s65 offen offset:1024 lds
    s_bfe_u32 s48, s101, 0x40018
    s_lshl_b32 s48, s48, 6
    s_add_u32 s48, s48, s88
    s_mul_i32 s48, s48, 6144
    s_add_u32 s48, s48, s89
    s_and_b32 s49, s4, 8
    s_mul_i32 s49, s49, 128
    s_add_u32 s48, s48, s49
    s_add_u32 s92, s26, s48
    s_addc_u32 s93, s27, 0
    s_nop 0
    s_load_dword s94, s[92:93], 384
    s_load_dword s94, s[92:93], 2432
    s_load_dword s94, s[92:93], 4480
    s_bfe_u32 s69, s101, 0x40014
    s_mul_i32 s73, s69, s72
    s_lshl_b32 s69, s69, 6
    s_mul_i32 s74, s69, 6144
    s_cmp_lg_u32 s7, 0
    s_cbranch_scc1 jt_31
    s_lshl_b32 s48, s2, 2
    s_add_u32 s48, s48, s6
    s_mul_i32 s49, s48, 7168
    s_add_u32 s90, s32, s49
    s_addc_u32 s91, s33, 0
    s_load_dword s94, s[90:91], 1024
    s_load_dword s94, s[90:91], 1088
    s_load_dword s94, s[90:91], 1152
    s_load_dword s94, s[90:91], 1216
    s_load_dword s94, s[90:91], 1280
    s_load_dword s94, s[90:91], 1344
jt_31:
    s_waitcnt vmcnt(10)
    s_barrier
    s_add_u32 m0, s66, 102400
    s_nop 0
    s_nop 0
    buffer_load_dwordx4 v4, s[8:11], s73 offen offset:0 sc1 lds
    buffer_load_dwordx4 v5, s[8:11], s73 offen offset:1024 sc1 lds
    buffer_load_dwordx4 v6, s[8:11], s73 offen offset:2048 sc1 lds
    buffer_load_dwordx4 v7, s[8:11], s73 offen offset:3072 sc1 lds
    s_add_u32 m0, s67, 28672
    s_nop 0
    s_nop 0
    buffer_load_dwordx4 v8, s[12:15], s74 offen offset:0 lds
    buffer_load_dwordx4 v9, s[12:15], s74 offen offset:1024 lds
    s_add_u32 m0, s67, 36864
    s_nop 0
    s_nop 0
    buffer_load_dwordx4 v10, s[12:15], s74 offen offset:0 lds
    buffer_load_dwordx4 v11, s[12:15], s74 offen offset:1024 lds
    s_add_u32 m0, s67, 45056
    s_nop 0
    s_nop 0
    buffer_load_dwordx4 v12, s[12:15], s74 offen offset:0 lds
    buffer_load_dwordx4 v13, s[12:15], s74 offen offset:1024 lds
    s_bfe_u32 s48, s101, 0x4001c
    s_lshl_b32 s48, s48, 6
    s_add_u32 s48, s48, s88
    s_mul_i32 s48, s48, 6144
    s_add_u32 s48, s48, s89
    s_and_b32 s49, s4, 8
    s_mul_i32 s49, s49, 128
    s_add_u32 s48, s48, s49
    s_add_u32 s92, s26, s48
    s_addc_u32 s93, s27, 0
    s_nop 0
    s_load_dword s94, s[92:93], 384
    s_load_dword s94, s[92:93], 2432
    s_load_dword s94, s[92:93], 4480
    s_bfe_u32 s69, s101, 0x40018
    s_mul_i32 s64, s69, s72
    s_lshl_b32 s69, s69, 6
    s_mul_i32 s65, s69, 6144
    s_cmp_lg_u32 s7, 0
    s_cbranch_scc1 jgd_32
    s_mov_b32 s20, s42
    s_mov_b32 s21, s43
    s_mov_b32 s22, 256
    s_mov_b32 s23, 0x20000
    s_mov_b32 s84, 32
    s_nop 0
    s_mov_b32 s76, 0x01010101
    s_mov_b32 s77, 0x01010101
    s_branch pollc_34
poll_33:
    s_nop 0
    buffer_load_dword v38, v32, s[20:23], 0 offen sc1
    s_waitcnt vmcnt(0)
pollc_34:
    v_and_b32 v39, 63, v38
    v_cmp_le_u32 vcc, s84, v39
    s_nop 0
    s_andn2_b64 s[78:79], s[76:77], vcc
    s_cbranch_scc0 polld_35
    s_sub_u32 s85, s85, 1
    s_cbranch_scc0 poll_33
    s_mov_b32 s85, 0
polld_35:
    s_lshl_b32 s48, s5, 3
    s_lshl_b32 s49, s87, 5
    s_nop 0
    v_readlane_b32 s50, v38, s48
    s_nop 0
    s_cmp_lg_u32 s50, s49
    s_cselect_b32 s44, 1, 0
    s_xor_b32 s48, s48, 8
    v_readlane_b32 s51, v38, s48
    v_mov_b32 v16, 155904
    s_bfe_u32 s48, s51, 0x3000b
    s_mul_i32 s49, s48, s48
    s_lshl_b32 s49, s49, 8
    s_add_u32 s49, s49, s48
    s_lshl_b32 s49, s49, 11
    s_add_u32 s49, s49, 32
    s_nop 0
    s_lshr_b32 s48, 170, s48
    s_and_b32 s48, s48, 1
    s_nop 0
    s_bfe_u32 s50, s50, 0x3000b
    s_lshr_b32 s50, 170, s50
    s_and_b32 s50, s50, 1
    s_sub_u32 s30, s48, s50
    s_cmp_lg_u32 s51, s49
    s_cselect_b32 s30, 0, s30
    s_cmp_lg_u32 s44, 0
    s_cselect_b32 s30, 0, s30
    s_mul_i32 s30, s30, 1
    s_add_u32 s30, s30, 1
    s_lshl_b32 s48, s30, 1
    s_or_b32 s48, s48, s44
    v_mov_b32_e64 v17, s48
    ds_write_b32 v16, v17
jgd_32:
    s_cmp_lg_u32 s7, 0
    s_cbranch_scc1 jt_36
    s_lshl_b32 s48, s2, 2
    s_add_u32 s48, s48, s6
    s_mul_i32 s49, s48, 7168
    s_add_u32 s90, s32, s49
    s_addc_u32 s91, s33, 0
    s_load_dword s94, s[90:91], 1408
    s_load_dword s94, s[90:91], 1472
    s_load_dword s94, s[90:91], 1536
    s_load_dword s94, s[90:91], 1600
    s_load_dword s94, s[90:91], 1664
    s_load_dword s94, s[90:91], 1728
jt_36:
    s_waitcnt vmcnt(10)
    s_barrier
    s_lshl_b32 s48, s7, 19
    s_lshl_b32 s49, s3, 14
    s_add_u32 s48, s48, s49
    s_nop 0
    s_add_u32 s48, s48, 1048576
    buffer_load_dwordx4 v[64:67], v35, s[16:19], s48 offen offset:0 sc1
    buffer_load_dwordx4 v[68:71], v35, s[16:19], s48 offen offset:1024 sc1
    buffer_load_dwordx4 v[72:75], v35, s[16:19], s48 offen offset:2048 sc1
    buffer_load_dwordx4 v[76:79], v35, s[16:19], s48 offen offset:3072 sc1
    s_add_u32 m0, s66, 118784
    s_nop 0
    s_nop 0
    buffer_load_dwordx4 v4, s[8:11], s64 offen offset:0 sc1 lds
    buffer_load_dwordx4 v5, s[8:11], s64 offen offset:1024 sc1 lds
    buffer_load_dwordx4 v6, s[8:11], s64 offen offset:2048 sc1 lds
    buffer_load_dwordx4 v7, s[8:11], s64 offen offset:3072 sc1 lds
    s_add_u32 m0, s67, 57344
    s_nop 0
    s_nop 0
    buffer_load_dwordx4 v8, s[12:15], s65 offen offset:0 lds
    buffer_load_dwordx4 v9, s[12:15], s65 offen offset:1024 lds
    s_add_u32 m0, s67, 65536
    s_nop 0
    s_nop 0
    buffer_load_dwordx4 v10, s[12:15], s65 offen offset:0 lds
    buffer_load_dwordx4 v11, s[12:15], s65 offen offset:1024 lds
    s_bfe_u32 s69, s101, 0x4001c
    s_mul_i32 s73, s69, s72
    s_lshl_b32 s69, s69, 6
    s_mul_i32 s74, s69, 6144
    s_cmp_lg_u32 s7, 0
    s_cbranch_scc1 jt_37
    s_lshl_b32 s48, s2, 2
    s_add_u32 s48, s48, s6
    s_mul_i32 s49, s48, 7168
    s_add_u32 s90, s32, s49
    s_addc_u32 s91, s33, 0
    s_load_dword s94, s[90:91], 1792
    s_load_dword s94, s[90:91], 1856
    s_load_dword s94, s[90:91], 1920
    s_load_dword s94, s[90:91], 1984
    s_load_dword s94, s[90:91], 2048
    s_load_dword s94, s[90:91], 2112
jt_37:
    s_waitcnt vmcnt(12)
    s_barrier
    s_cmp_lg_u32 s7, 0
    s_cbranch_scc1 jgc_38
    s_lshl_b32 s48, s4, 14
    s_nop 0
    s_add_u32 s48, s48, 2097152
    buffer_load_dwordx4 v[80:83], v35, s[16:19], s48 offen offset:0 sc1
    buffer_load_dwordx4 v[84:87], v35, s[16:19], s48 offen offset:1024 sc1
    buffer_load_dwordx4 v[88:91], v35, s[16:19], s48 offen offset:2048 sc1
    buffer_load_dwordx4 v[92:95], v35, s[16:19], s48 offen offset:3072 sc1
jgc_38:
    s_add_u32 m0, s66, 86016
    s_nop 0
    s_nop 0
    buffer_load_dwordx4 v4, s[8:11], s73 offen offset:0 sc1 lds
    buffer_load_dwordx4 v5, s[8:11], s73 offen offset:1024 sc1 lds
    buffer_load_dwordx4 v6, s[8:11], s73 offen offset:2048 sc1 lds
    buffer_load_dwordx4 v7, s[8:11], s73 offen offset:3072 sc1 lds
    s_add_u32 m0, s67, 0
    s_nop 0
    buffer_load_dwordx4 v8, s[12:15], s74 offen offset:0 lds
    buffer_load_dwordx4 v9, s[12:15], s74 offen offset:1024 lds
    s_add_u32 m0, s67, 8192
    s_nop 0
    s_nop 0
    buffer_load_dwordx4 v10, s[12:15], s74 offen offset:0 lds
    buffer_load_dwordx4 v11, s[12:15], s74 offen offset:1024 lds
    s_cmp_lg_u32 s7, 0
    s_cbranch_scc1 jt_39
    s_lshl_b32 s48, s2, 2
    s_add_u32 s48, s48, s6
    s_mul_i32 s49, s48, 7168
    s_add_u32 s90, s32, s49
    s_addc_u32 s91, s33, 0
    s_load_dword s94, s[90:91], 2176
    s_load_dword s94, s[90:91], 2240
    s_load_dword s94, s[90:91], 2304
    s_load_dword s94, s[90:91], 2368
    s_load_dword s94, s[90:91], 2432
    s_load_dword s94, s[90:91], 2496
jt_39:
    s_waitcnt vmcnt(20)
    s_cmp_eq_u32 s7, 0
    s_cbranch_scc1 jrc_41
    s_waitcnt vmcnt(16)
jrc_41:
    v_add_f32 v64, v64, v72
    v_add_f32 v65, v65, v73
    v_add_f32 v66, v66, v74
    v_add_f32 v67, v67, v75
    v_add_f32 v68, v68, v76
    v_add_f32 v69, v69, v77
    v_add_f32 v70, v70, v78
    v_add_f32 v71, v71, v79
    v_add_f32 v64, v64, v68
    v_add_f32 v65, v65, v69
    v_add_f32 v66, v66, v70
    v_add_f32 v67, v67, v71
    s_nop 0
    v_permlane32_swap_b32 v64, v66
    v_permlane32_swap_b32 v65, v67
    v_add_f32 v64, v64, v66
    v_add_f32 v65, v65, v67
    s_nop 1
    v_permlane16_swap_b32 v64, v65
    v_add_f32 v64, v64, v65
    v_cmp_u_f32 vcc, v64, v64
    s_cbranch_vccz rtd_42
    s_sub_u32 s85, s85, 1
    s_cbranch_scc0 jrr_40
    s_mov_b32 s85, 0
rtd_42:
    s_waitcnt vmcnt(12)
    s_cmp_eq_u32 s7, 0
    s_cbranch_scc1 wc_43
    s_waitcnt vmcnt(8)
wc_43:
    s_barrier
    s_add_u32 m0, s67, 73728
    s_nop 0
    s_nop 0
    buffer_load_dwordx4 v12, s[12:15], s65 offen offset:0 lds
    buffer_load_dwordx4 v13, s[12:15], s65 offen offset:1024 lds
    s_add_u32 m0, s67, 16384
    s_nop 0
    s_nop 0
    buffer_load_dwordx4 v12, s[12:15], s74 offen offset:0 lds
    buffer_load_dwordx4 v13, s[12:15], s74 offen offset:1024 lds
    s_cmp_lg_u32 s7, 0
    s_cbranch_scc1 jw_44
    s_mov_b32 s20, s32
    s_mov_b32 s21, s33
    s_mov_b32 s22, 7340032
    s_mov_b32 s23, 0x20000
    s_lshl_b32 s48, s2, 2
    s_add_u32 s48, s48, s6
    s_mul_i32 s48, s48, 7168
    s_add_u32 s48, s48, 2560
    v_min_u32 v16, 35, v0
    v_lshlrev_b32 v16, 7, v16
    buffer_load_dword v31, v16, s[20:23], s48 offen
jw_44:
    v_mul_f32 v64, 0x3a800000, v64
    v_and_b32 v72, 15, v0
    v_mov_b32 v65, v64
    v_lshrrev_b32_e64 v73, 5, v0
    v_lshl_add_u32 v72, v72, 1, v73
    v_permlane16_swap_b32 v64, v65
    s_lshl_b32 s48, s6, 7
    s_add_u32 s48, s48, 151552
    v_fma_f32 v68, -v64, v64, v65
    v_max_f32_e64 v68, 0, v68
    v_add_f32 v68, 0x3727c5ac, v68
    v_rsq_f32_e64 v68, v68
    v_lshl_add_u32 v73, v72, 2, s48
    v_mul_f32 v70, -v64, v68
    ds_write2_b32 v73, v68, v70 offset0:0 offset1:128
    s_cmp_lg_u32 s7, 0
    s_cbranch_scc1 jre_45
    s_waitcnt vmcnt(13)
jrc_47:
    v_add_f32 v80, v80, v88
    v_add_f32 v81, v81, v89
    v_add_f32 v82, v82, v90
    v_add_f32 v83, v83, v91
    v_add_f32 v84, v84, v92
    v_add_f32 v85, v85, v93
    v_add_f32 v86, v86, v94
    v_add_f32 v87, v87, v95
    v_add_f32 v80, v80, v84
    v_add_f32 v81, v81, v85
    v_add_f32 v82, v82, v86
    v_add_f32 v83, v83, v87
    s_nop 0
    v_permlane32_swap_b32 v80, v82
    v_permlane32_swap_b32 v81, v83
    v_add_f32 v80, v80, v82
    v_add_f32 v81, v81, v83
    s_nop 1
    v_permlane16_swap_b32 v80, v81
    v_add_f32 v80, v80, v81
    v_and_b32 v72, 15, v0
    s_lshl_b32 s48, s6, 8
    s_nop 0
    s_add_u32 s48, s48, 152576
    v_lshl_add_u32 v73, v72, 4, s48
    v_lshrrev_b32_e64 v72, 4, v0
    v_lshl_add_u32 v73, v72, 2, v73
    ds_write_b32 v73, v80
jre_45:
    s_waitcnt vmcnt(5)
    s_cmp_eq_u32 s7, 0
    s_cbranch_scc1 wc_48
    s_waitcnt vmcnt(4)
wc_48:
    s_barrier
    s_waitcnt vmcnt(1)
    s_cmp_eq_u32 s7, 0
    s_cbranch_scc1 wc_49
    s_waitcnt vmcnt(0)
wc_49:
    s_waitcnt lgkmcnt(0)
    s_barrier
    s_cmp_lg_u32 s7, 0
    s_cbranch_scc1 tb_50
    s_nop 0
    s_mov_b32 s48, 0x76543210
    s_mov_b32 s49, 0x76543210
    s_lshl_b32 s52, s62, 2
    s_lshr_b64 s[48:49], s[48:49], s52
    s_cmp_ge_u32 s4, 8
    s_nop 0
    s_cselect_b32 s49, 0x88888888, 0
    s_or_b32 s48, s48, s49
    s_nop 0
    s_xor_b32 s101, s48, 0x88888888
    s_and_b32 s49, s4, 8
    s_add_u32 s49, s49, 3
    s_sub_u32 s52, s4, s62
    s_and_b32 s52, s52, 7
    s_lshl_b32 s52, s52, 2
    s_bfm_b32 s50, s52, 0
    s_and_b32 s100, s48, s50
    s_lshl_b32 s100, s100, 4
    s_or_b32 s100, s100, s4
    s_lshl_b32 s50, s50, 4
    s_or_b32 s50, s50, 15
    s_andn2_b32 s50, s48, s50
    s_or_b32 s100, s100, s50
    s_sub_u32 s52, s49, s62
    s_and_b32 s52, s52, 7
    s_lshl_b32 s52, s52, 2
    s_bfm_b32 s50, s52, 0
    s_and_b32 s99, s48, s50
    s_lshl_b32 s99, s99, 4
    s_or_b32 s99, s99, s49
    s_lshl_b32 s50, s50, 4
    s_or_b32 s50, s50, 15
    s_andn2_b32 s50, s48, s50
    s_or_b32 s99, s99, s50
    s_and_b32 s49, s3, 1
    s_add_u32 s49, s49, s62
    s_lshl_b32 s50, s3, 2
    s_xor_b32 s50, s50, s4
    s_and_b32 s50, s50, 8
    s_add_u32 s61, s49, s50
tb_50:
    s_mov_b32 s12, s28
    s_mov_b32 s13, s29
    s_mov_b32 s14, 2097152
    s_mov_b32 s15, 0x20000
    v_mov_b64 v[244:245], -1
    v_mov_b64 v[246:247], -1
    v_lshlrev_b32 v16, 4, v0
    s_lshl_b32 s48, s2, 14
    s_lshl_b32 s49, s6, 12
    s_add_u32 s48, s48, s49
    s_add_u32 s48, s48, 16777216
    buffer_store_dwordx4 v[244:247], v16, s[16:19], s48 offen offset:0 sc1
    buffer_store_dwordx4 v[244:247], v16, s[16:19], s48 offen offset:1024 sc1
    buffer_store_dwordx4 v[244:247], v16, s[16:19], s48 offen offset:2048 sc1
    buffer_store_dwordx4 v[244:247], v16, s[16:19], s48 offen offset:3072 sc1
    s_cmp_lg_u32 s7, 0
    s_cbranch_scc1 jc_51
    s_mov_b32 s20, s34
    s_mov_b32 s21, s35
    s_mov_b32 s22, 7168
    s_mov_b32 s23, 0x20000
    s_cmp_eq_u32 s6, 1
    s_cselect_b32 s48, s81, s80
    s_cmp_eq_u32 s6, 2
    s_cselect_b32 s48, s82, s48
    s_cmp_eq_u32 s6, 3
    s_cselect_b32 s48, s83, s48
    v_lshlrev_b32_e64 v16, 1, v0
    buffer_load_ushort v56, v16, s[20:23], s48 offen
    s_mov_b32 s20, s38
    s_mov_b32 s21, s39
    s_mov_b32 s22, 2048
    s_mov_b32 s23, 0x20000
    s_lshl_b32 s48, s4, 7
    s_nop 0
    buffer_load_ushort v57, v16, s[20:23], s48 offen
    v_lshlrev_b32 v16, 4, v0
    v_and_b32 v17, 15, v0
    v_lshlrev_b32 v17, 2, v17
    s_lshl_b32 s48, s4, 16
    s_lshl_b32 s49, s3, 10
    s_add_u32 s48, s48, s49
    s_lshl_b32 s49, s6, 14
    s_add_u32 s48, s48, s49
    s_lshr_b32 s49, s48, 4
    s_nop 0
    s_add_u32 s48, s48, 4194304
    s_add_u32 s49, s49, 5308416
    buffer_store_dwordx4 v[244:247], v16, s[16:19], s48 offen sc1
    buffer_store_dword v244, v17, s[16:19], s49 offen sc1
    s_lshl_b32 s48, s3, 14
    s_lshl_b32 s49, s4, 10
    s_add_u32 s48, s48, s49
    s_nop 0
    s_add_u32 s48, s48, 1048576
    s_add_u32 s48, s48, 262144
    buffer_store_dword v244, v34, s[16:19], s48 offen sc1
    s_add_u32 s48, s48, 262144
    buffer_store_dword v244, v34, s[16:19], s48 offen sc1
    s_add_u32 s48, s48, 262144
    buffer_store_dword v244, v34, s[16:19], s48 offen sc1
jc_51:
    v_add_u32_e64 v4, s66, v33
    s_mov_b32 s72, 32768
    v_add_u32 v5, 128, v4
    v_cmp_gt_u32 vcc, 24, v0
    s_nop 1
    v_cndmask_b32_e64 v4, v5, v4, vcc
    v_add_u32 v5, 15360, v4
    v_mov_b32 v6, v4
    v_mov_b32 v7, v5
    s_mul_i32 s48, s3, 1835008
    s_add_u32 s48, s48, 33554432
    s_add_u32 s8, s16, s48
    s_addc_u32 s9, s17, 0
    s_mov_b32 s10, 1835008
    s_mov_b32 s11, 0x20000
    s_lshl_b32 s48, s7, 20
    s_lshl_b32 s49, s4, 16
    s_add_u32 s48, s48, s49
    s_lshl_b32 s49, s6, 14
    s_add_u32 s48, s48, s49
    s_lshr_b32 s52, s48, 4
    s_add_u32 s48, s48, 3145728
    s_mov_b32 s53, s48
    s_nop 0
    s_add_u32 s52, s52, 5242880
    s_add_u32 s48, s62, 2
    s_and_b32 s48, s48, 6
    s_lshl_b32 s48, s48, 11
    s_add_u32 s48, s48, s53
    s_add_u32 s49, s62, 4
    s_and_b32 s49, s49, 6
    s_lshl_b32 s49, s49, 11
    s_add_u32 s49, s49, s53
    s_add_u32 s50, s62, 6
    s_and_b32 s50, s50, 6
    s_lshl_b32 s50, s50, 11
    s_add_u32 s50, s50, s53
    s_add_u32 s51, s62, 8
    s_and_b32 s51, s51, 6
    s_lshl_b32 s51, s51, 11
    s_add_u32 s51, s51, s53
    v_and_b32 v132, 15, v0
    v_lshlrev_b32 v132, 6, v132
    v_and_b32 v133, 48, v0
    v_add_u32 v132, v132, v133
    s_lshr_b32 s53, s6, 1
    s_lshl_b32 s53, s53, 10
    s_and_b32 s54, s6, 1
    s_lshl_b32 s54, s54, 3
    s_add_u32 s53, s53, s54
    s_nop 0
    s_add_u32 s53, s53, 160064
    v_add_u32_e64 v134, s53, v33
    s_add_u32 s53, s68, 155968
    v_add_u32_e64 v135, s53, v33
    s_mov_b32 s56, 0x3f80
    s_mov_b32 s57, 0x3f800000
    s_mov_b32 s98, 15
    s_barrier
    s_barrier
    s_bfe_u32 s69, s100, 0x40000
    s_lshl_b32 s69, s69, 6
    s_nop 0
    s_mul_i32 s65, s69, 2048
    s_add_u32 m0, s67, 0
    s_nop 0
    buffer_load_dwordx4 v44, s[12:15], s65 offen offset:0 lds
    buffer_load_dwordx4 v45, s[12:15], s65 offen offset:1024 lds
    s_bfe_u32 s69, s100, 0x40004
    s_lshl_b32 s69, s69, 6
    s_nop 0
    s_mul_i32 s74, s69, 2048
    s_add_u32 m0, s67, 8192
    s_nop 0
    s_nop 0
    buffer_load_dwordx4 v44, s[12:15], s74 offen offset:0 lds
    buffer_load_dwordx4 v45, s[12:15], s74 offen offset:1024 lds
    s_bfe_u32 s69, s100, 0x40008
    s_lshl_b32 s69, s69, 6
    s_nop 0
    s_mul_i32 s65, s69, 2048
    s_add_u32 m0, s67, 32768
    s_nop 0
    s_nop 0
    buffer_load_dwordx4 v44, s[12:15], s65 offen offset:0 lds
    buffer_load_dwordx4 v45, s[12:15], s65 offen offset:1024 lds
    s_bfe_u32 s69, s100, 0x4000c
    s_lshl_b32 s69, s69, 6
    s_nop 0
    s_mul_i32 s74, s69, 2048
    s_add_u32 m0, s67, 40960
    s_nop 0
    s_nop 0
    buffer_load_dwordx4 v44, s[12:15], s74 offen offset:0 lds
    buffer_load_dwordx4 v45, s[12:15], s74 offen offset:1024 lds
    s_bfe_u32 s69, s100, 0x40010
    s_lshl_b32 s69, s69, 6
    s_nop 0
    s_mul_i32 s65, s69, 2048
    s_add_u32 m0, s67, 65536
    s_nop 0
    s_nop 0
    buffer_load_dwordx4 v44, s[12:15], s65 offen offset:0 lds
    buffer_load_dwordx4 v45, s[12:15], s65 offen offset:1024 lds
    s_bfe_u32 s69, s100, 0x4001c
    s_lshl_b32 s69, s69, 6
    s_nop 0
    s_mul_i32 s74, s69, 2048
    s_add_u32 m0, s67, 106496
    s_nop 0
    s_nop 0
    buffer_load_dwordx4 v44, s[12:15], s74 offen offset:0 lds
    buffer_load_dwordx4 v45, s[12:15], s74 offen offset:1024 lds
kv1_54:
    buffer_load_dwordx4 v[64:67], v33, s[16:19], s48 offen offset:0 sc1
    buffer_load_dwordx4 v[68:71], v33, s[16:19], s48 offen offset:1024 sc1
    buffer_load_dwordx4 v[72:75], v33, s[16:19], s48 offen offset:2048 sc1
    buffer_load_dwordx4 v[76:79], v33, s[16:19], s48 offen offset:3072 sc1
    buffer_load_dwordx4 v[80:83], v33, s[16:19], s49 offen offset:0 sc1
    buffer_load_dwordx4 v[84:87], v33, s[16:19], s49 offen offset:1024 sc1
    buffer_load_dwordx4 v[88:91], v33, s[16:19], s49 offen offset:2048 sc1
    buffer_load_dwordx4 v[92:95], v33, s[16:19], s49 offen offset:3072 sc1
    buffer_load_dwordx4 v[96:99], v33, s[16:19], s50 offen offset:0 sc1
    buffer_load_dwordx4 v[100:103], v33, s[16:19], s50 offen offset:1024 sc1
    buffer_load_dwordx4 v[104:107], v33, s[16:19], s50 offen offset:2048 sc1
    buffer_load_dwordx4 v[108:111], v33, s[16:19], s50 offen offset:3072 sc1
    buffer_load_dwordx4 v[112:115], v33, s[16:19], s51 offen offset:0 sc1
    buffer_load_dwordx4 v[116:119], v33, s[16:19], s51 offen offset:1024 sc1
    buffer_load_dwordx4 v[120:123], v33, s[16:19], s51 offen offset:2048 sc1
    buffer_load_dwordx4 v[124:127], v33, s[16:19], s51 offen offset:3072 sc1
    buffer_load_dwordx4 v[128:131], v132, s[16:19], s52 offen sc1
    s_waitcnt vmcnt(16)
    v_lshlrev_b32 v144, 16, v64
    v_and_b32 v145, 0xffff0000, v64
    v_lshlrev_b32_e64 v146, 16, v65
    v_and_b32 v147, 0xffff0000, v65
    v_lshlrev_b32_e64 v148, 16, v66
    v_and_b32 v149, 0xffff0000, v66
    v_lshlrev_b32_e64 v150, 16, v67
    v_and_b32 v151, 0xffff0000, v67
    s_waitcnt vmcnt(15)
    v_dot2c_f32_bf16 v144, s56, v68
    v_dot2c_f32_bf16 v145, s57, v68
    v_dot2c_f32_bf16 v146, s56, v69
    v_dot2c_f32_bf16 v147, s57, v69
    v_dot2c_f32_bf16 v148, s56, v70
    v_dot2c_f32_bf16 v149, s57, v70
    v_dot2c_f32_bf16 v150, s56, v71
    v_dot2c_f32_bf16 v151, s57, v71
    s_waitcnt vmcnt(14)
    v_dot2c_f32_bf16 v144, s56, v72
    v_dot2c_f32_bf16 v145, s57, v72
    v_dot2c_f32_bf16 v146, s56, v73
    v_dot2c_f32_bf16 v147, s57, v73
    v_dot2c_f32_bf16 v148, s56, v74
    v_dot2c_f32_bf16 v149, s57, v74
    v_dot2c_f32_bf16 v150, s56, v75
    v_dot2c_f32_bf16 v151, s57, v75
    s_waitcnt vmcnt(13)
    v_dot2c_f32_bf16 v144, s56, v76
    v_dot2c_f32_bf16 v145, s57, v76
    v_dot2c_f32_bf16 v146, s56, v77
    v_dot2c_f32_bf16 v147, s57, v77
    v_dot2c_f32_bf16 v148, s56, v78
    v_dot2c_f32_bf16 v149, s57, v78
    v_dot2c_f32_bf16 v150, s56, v79
    v_dot2c_f32_bf16 v151, s57, v79
    v_add_f32 v136, v144, v146
    s_nop 0
    v_add_f32 v137, v148, v150
    v_cmp_u_f32 vcc, v136, v137
    s_cbranch_vccnz kva_56
    s_bitset0_b32 s98, 0
kva_56:
    s_waitcnt vmcnt(12)
    v_lshlrev_b32_e64 v152, 16, v80
    v_and_b32 v153, 0xffff0000, v80
    v_lshlrev_b32_e64 v154, 16, v81
    v_and_b32 v155, 0xffff0000, v81
    v_lshlrev_b32_e64 v156, 16, v82
    v_and_b32 v157, 0xffff0000, v82
    v_lshlrev_b32_e64 v158, 16, v83
    v_and_b32 v159, 0xffff0000, v83
    s_waitcnt vmcnt(11)
    v_dot2c_f32_bf16 v152, s56, v84
    v_dot2c_f32_bf16 v153, s57, v84
    v_dot2c_f32_bf16 v154, s56, v85
    v_dot2c_f32_bf16 v155, s57, v85
    v_dot2c_f32_bf16 v156, s56, v86
    v_dot2c_f32_bf16 v157, s57, v86
    v_dot2c_f32_bf16 v158, s56, v87
    v_dot2c_f32_bf16 v159, s57, v87
    s_waitcnt vmcnt(10)
    v_dot2c_f32_bf16 v152, s56, v88
    v_dot2c_f32_bf16 v153, s57, v88
    v_dot2c_f32_bf16 v154, s56, v89
    v_dot2c_f32_bf16 v155, s57, v89
    v_dot2c_f32_bf16 v156, s56, v90
    v_dot2c_f32_bf16 v157, s57, v90
    v_dot2c_f32_bf16 v158, s56, v91
    v_dot2c_f32_bf16 v159, s57, v91
    s_waitcnt vmcnt(9)
    v_dot2c_f32_bf16 v152, s56, v92
    v_dot2c_f32_bf16 v153, s57, v92
    v_dot2c_f32_bf16 v154, s56, v93
    v_dot2c_f32_bf16 v155, s57, v93
    v_dot2c_f32_bf16 v156, s56, v94
    v_dot2c_f32_bf16 v157, s57, v94
    v_dot2c_f32_bf16 v158, s56, v95
    v_dot2c_f32_bf16 v159, s57, v95
    v_add_f32 v136, v152, v154
    s_nop 0
    v_add_f32 v137, v156, v158
    v_cmp_u_f32 vcc, v136, v137
    s_cbranch_vccnz kva_57
    s_bitset0_b32 s98, 1
kva_57:
    s_waitcnt vmcnt(8)
    v_lshlrev_b32_e64 v160, 16, v96
    v_and_b32 v161, 0xffff0000, v96
    v_lshlrev_b32_e64 v162, 16, v97
    v_and_b32 v163, 0xffff0000, v97
    v_lshlrev_b32_e64 v164, 16, v98
    v_and_b32 v165, 0xffff0000, v98
    v_lshlrev_b32_e64 v166, 16, v99
    v_and_b32 v167, 0xffff0000, v99
    s_waitcnt vmcnt(7)
    v_dot2c_f32_bf16 v160, s56, v100
    v_dot2c_f32_bf16 v161, s57, v100
    v_dot2c_f32_bf16 v162, s56, v101
    v_dot2c_f32_bf16 v163, s57, v101
    v_dot2c_f32_bf16 v164, s56, v102
    v_dot2c_f32_bf16 v165, s57, v102
    v_dot2c_f32_bf16 v166, s56, v103
    v_dot2c_f32_bf16 v167, s57, v103
    s_waitcnt vmcnt(6)
    v_dot2c_f32_bf16 v160, s56, v104
    v_dot2c_f32_bf16 v161, s57, v104
    v_dot2c_f32_bf16 v162, s56, v105
    v_dot2c_f32_bf16 v163, s57, v105
    v_dot2c_f32_bf16 v164, s56, v106
    v_dot2c_f32_bf16 v165, s57, v106
    v_dot2c_f32_bf16 v166, s56, v107
    v_dot2c_f32_bf16 v167, s57, v107
    s_waitcnt vmcnt(5)
    v_dot2c_f32_bf16 v160, s56, v108
    v_dot2c_f32_bf16 v161, s57, v108
    v_dot2c_f32_bf16 v162, s56, v109
    v_dot2c_f32_bf16 v163, s57, v109
    v_dot2c_f32_bf16 v164, s56, v110
    v_dot2c_f32_bf16 v165, s57, v110
    v_dot2c_f32_bf16 v166, s56, v111
    v_dot2c_f32_bf16 v167, s57, v111
    v_add_f32 v136, v160, v162
    s_nop 0
    v_add_f32 v137, v164, v166
    v_cmp_u_f32 vcc, v136, v137
    s_cbranch_vccnz kva_58
    s_bitset0_b32 s98, 2
kva_58:
    s_waitcnt vmcnt(4)
    v_lshlrev_b32_e64 v168, 16, v112
    v_and_b32 v169, 0xffff0000, v112
    v_lshlrev_b32_e64 v170, 16, v113
    v_and_b32 v171, 0xffff0000, v113
    v_lshlrev_b32_e64 v172, 16, v114
    v_and_b32 v173, 0xffff0000, v114
    v_lshlrev_b32_e64 v174, 16, v115
    v_and_b32 v175, 0xffff0000, v115
    s_waitcnt vmcnt(3)
    v_dot2c_f32_bf16 v168, s56, v116
    v_dot2c_f32_bf16 v169, s57, v116
    v_dot2c_f32_bf16 v170, s56, v117
    v_dot2c_f32_bf16 v171, s57, v117
    v_dot2c_f32_bf16 v172, s56, v118
    v_dot2c_f32_bf16 v173, s57, v118
    v_dot2c_f32_bf16 v174, s56, v119
    v_dot2c_f32_bf16 v175, s57, v119
    s_waitcnt vmcnt(2)
    v_dot2c_f32_bf16 v168, s56, v120
    v_dot2c_f32_bf16 v169, s57, v120
    v_dot2c_f32_bf16 v170, s56, v121
    v_dot2c_f32_bf16 v171, s57, v121
    v_dot2c_f32_bf16 v172, s56, v122
    v_dot2c_f32_bf16 v173, s57, v122
    v_dot2c_f32_bf16 v174, s56, v123
    v_dot2c_f32_bf16 v175, s57, v123
    s_waitcnt vmcnt(1)
    v_dot2c_f32_bf16 v168, s56, v124
    v_dot2c_f32_bf16 v169, s57, v124
    v_dot2c_f32_bf16 v170, s56, v125
    v_dot2c_f32_bf16 v171, s57, v125
    v_dot2c_f32_bf16 v172, s56, v126
    v_dot2c_f32_bf16 v173, s57, v126
    v_dot2c_f32_bf16 v174, s56, v127
    v_dot2c_f32_bf16 v175, s57, v127
    v_add_f32 v136, v168, v170
    s_nop 0
    v_add_f32 v137, v172, v174
    v_cmp_u_f32 vcc, v136, v137
    s_cbranch_vccnz kva_59
    s_bitset0_b32 s98, 3
kva_59:
    s_waitcnt vmcnt(0)
kvz_55:
    v_max3_u32 v133, v128, v129, v130
    v_max_u32 v133, v133, v131
    v_cmp_eq_u32 vcc, -1, v133
    s_nop 0
    s_or_b32 s53, vcc_lo, vcc_hi
    s_or_b32 s53, s53, s98
    s_cbranch_scc0 kvd_53
    s_sub_u32 s85, s85, 1
    s_cbranch_scc0 kvp_52
    s_mov_b32 s85, 0
kvd_53:
    s_nop 0
    v_pk_add_f32 v[144:145], v[144:145], v[152:153]
    v_pk_add_f32 v[146:147], v[146:147], v[154:155]
    v_pk_add_f32 v[148:149], v[148:149], v[156:157]
    v_pk_add_f32 v[150:151], v[150:151], v[158:159]
    v_pk_add_f32 v[160:161], v[160:161], v[168:169]
    v_pk_add_f32 v[162:163], v[162:163], v[170:171]
    v_pk_add_f32 v[164:165], v[164:165], v[172:173]
    v_pk_add_f32 v[166:167], v[166:167], v[174:175]
    v_pk_add_f32 v[144:145], v[144:145], v[160:161]
    v_pk_add_f32 v[146:147], v[146:147], v[162:163]
    v_pk_add_f32 v[148:149], v[148:149], v[164:165]
    v_pk_add_f32 v[150:151], v[150:151], v[166:167]
    v_cvt_pk_bf16_f32 v136, v144, v145
    v_cvt_pk_bf16_f32 v137, v146, v147
    v_cvt_pk_bf16_f32 v138, v148, v149
    v_cvt_pk_bf16_f32 v139, v150, v151
    ds_write_b128 v135, v[136:139]
    v_add_f32_dpp v128, v128, v128 row_ror:8 row_mask:0xf bank_mask:0xf
    v_add_f32_dpp v129, v129, v129 row_ror:8 row_mask:0xf bank_mask:0xf
    v_add_f32_dpp v130, v130, v130 row_ror:8 row_mask:0xf bank_mask:0xf
    v_add_f32_dpp v131, v131, v131 row_ror:8 row_mask:0xf bank_mask:0xf
    v_add_f32_dpp v128, v128, v128 row_ror:4 row_mask:0xf bank_mask:0xf
    v_add_f32_dpp v129, v129, v129 row_ror:4 row_mask:0xf bank_mask:0xf
    v_add_f32_dpp v130, v130, v130 row_ror:4 row_mask:0xf bank_mask:0xf
    v_add_f32_dpp v131, v131, v131 row_ror:4 row_mask:0xf bank_mask:0xf
    v_add_f32_dpp v128, v128, v128 row_ror:2 row_mask:0xf bank_mask:0xf
    v_add_f32_dpp v129, v129, v129 row_ror:2 row_mask:0xf bank_mask:0xf
    v_add_f32_dpp v130, v130, v130 row_ror:2 row_mask:0xf bank_mask:0xf
    v_add_f32_dpp v131, v131, v131 row_ror:2 row_mask:0xf bank_mask:0xf
    v_add_f32_dpp v128, v128, v128 row_ror:1 row_mask:0xf bank_mask:0xf
    v_add_f32_dpp v129, v129, v129 row_ror:1 row_mask:0xf bank_mask:0xf
    v_add_f32_dpp v130, v130, v130 row_ror:1 row_mask:0xf bank_mask:0xf
    v_add_f32_dpp v131, v131, v131 row_ror:1 row_mask:0xf bank_mask:0xf
    v_cvt_pk_bf16_f32 v128, v128, v129
    v_cvt_pk_bf16_f32 v129, v130, v131
    ds_write_b64 v134, v[128:129]
    s_waitcnt lgkmcnt(0)
    s_barrier
    s_bfe_u32 s69, s100, 0x40014
    s_lshl_b32 s69, s69, 6
    s_nop 0
    s_mul_i32 s74, s69, 2048
    s_add_u32 m0, s67, 73728
    s_nop 0
    s_nop 0
    buffer_load_dwordx4 v44, s[12:15], s74 offen offset:0 lds
    buffer_load_dwordx4 v45, s[12:15], s74 offen offset:1024 lds
    s_bfe_u32 s69, s100, 0x40018
    s_lshl_b32 s69, s69, 6
    s_nop 0
    s_mul_i32 s65, s69, 2048
    s_add_u32 m0, s67, 98304
    s_nop 0
    s_nop 0
    buffer_load_dwordx4 v44, s[12:15], s65 offen offset:0 lds
    buffer_load_dwordx4 v45, s[12:15], s65 offen offset:1024 lds
    s_barrier
    s_add_u32 s84, s47, 1
    s_cmp_ge_u32 s4, 8
    s_cselect_b32 s76, 0, -1
    s_cselect_b32 s77, -1, 0
poll_60:
    s_nop 0
    buffer_load_dword v38, v36, s[16:19], 0 offen sc1
    s_waitcnt vmcnt(0)
pollc_61:
    v_cmp_le_u32 vcc, s84, v38
    s_nop 0
    s_andn2_b64 s[78:79], s[76:77], vcc
    s_cbranch_scc0 polld_62
    s_sub_u32 s85, s85, 1
    s_cbranch_scc0 poll_60
    s_mov_b32 s85, 0
polld_62:
    s_bfe_u32 s69, s100, 0x40004
    s_and_b32 s49, s69, 8
    s_lshl_b32 s49, s49, 1
    s_add_u32 s73, s69, s49
    s_lshl_b32 s73, s73, 15
    s_add_u32 m0, s66, 49152
    s_nop 0
    s_nop 0
    buffer_load_dwordx4 v4, s[8:11], s73 offen offset:0 sc1 lds
    buffer_load_dwordx4 v5, s[8:11], s73 offen offset:1024 sc1 lds
    buffer_load_dwordx4 v6, s[8:11], s73 offen offset:2048 sc1 lds
    buffer_load_dwordx4 v7, s[8:11], s73 offen offset:3072 sc1 lds
    s_bfe_u32 s69, s100, 0x40008
    s_and_b32 s49, s69, 8
    s_lshl_b32 s49, s49, 1
    s_add_u32 s64, s69, s49
    s_lshl_b32 s64, s64, 15
    s_add_u32 m0, s66, 81920
    s_nop 0
    s_nop 0
    buffer_load_dwordx4 v4, s[8:11], s64 offen offset:0 sc1 lds
    buffer_load_dwordx4 v5, s[8:11], s64 offen offset:1024 sc1 lds
    buffer_load_dwordx4 v6, s[8:11], s64 offen offset:2048 sc1 lds
    buffer_load_dwordx4 v7, s[8:11], s64 offen offset:3072 sc1 lds
    s_bfe_u32 s69, s100, 0x4000c
    s_and_b32 s49, s69, 8
    s_lshl_b32 s49, s49, 1
    s_add_u32 s73, s69, s49
    s_lshl_b32 s73, s73, 15
    s_add_u32 m0, s66, 114688
    s_nop 0
    s_nop 0
    buffer_load_dwordx4 v4, s[8:11], s73 offen offset:0 sc1 lds
    buffer_load_dwordx4 v5, s[8:11], s73 offen offset:1024 sc1 lds
    buffer_load_dwordx4 v6, s[8:11], s73 offen offset:2048 sc1 lds
    buffer_load_dwordx4 v7, s[8:11], s73 offen offset:3072 sc1 lds
    s_bfe_u32 s48, s101, 0x40000
    s_lshl_b32 s48, s48, 6
    s_add_u32 s48, s48, s88
    s_mul_i32 s48, s48, 2048
    s_add_u32 s48, s48, s89
    s_and_b32 s49, s4, 8
    s_mul_i32 s49, s49, 128
    s_add_u32 s48, s48, s49
    s_add_u32 s92, s28, s48
    s_addc_u32 s93, s29, 0
    s_nop 0
    s_load_dword s94, s[92:93], 384
    s_bfe_u32 s69, s100, 0x40010
    s_and_b32 s49, s69, 8
    s_lshl_b32 s49, s49, 1
    s_add_u32 s64, s69, s49
    s_lshl_b32 s64, s64, 15
    s_waitcnt vmcnt(8)
    s_barrier
    s_add_u32 m0, s66, 16384
    s_nop 0
    s_nop 0
    buffer_load_dwordx4 v4, s[8:11], s64 offen offset:0 sc1 lds
    buffer_load_dwordx4 v5, s[8:11], s64 offen offset:1024 sc1 lds
    buffer_load_dwordx4 v6, s[8:11], s64 offen offset:2048 sc1 lds
    buffer_load_dwordx4 v7, s[8:11], s64 offen offset:3072 sc1 lds
    s_bfe_u32 s48, s101, 0x40004
    s_lshl_b32 s48, s48, 6
    s_add_u32 s48, s48, s88
    s_mul_i32 s48, s48, 2048
    s_add_u32 s48, s48, s89
    s_and_b32 s49, s4, 8
    s_mul_i32 s49, s49, 128
    s_add_u32 s48, s48, s49
    s_add_u32 s92, s28, s48
    s_addc_u32 s93, s29, 0
    s_nop 0
    s_load_dword s94, s[92:93], 384
    s_bfe_u32 s69, s100, 0x40014
    s_and_b32 s49, s69, 8
    s_lshl_b32 s49, s49, 1
    s_add_u32 s73, s69, s49
    s_lshl_b32 s73, s73, 15
    s_bfe_u32 s69, s101, 0x40000
    s_lshl_b32 s69, s69, 6
    s_nop 0
    s_mul_i32 s65, s69, 2048
    s_waitcnt vmcnt(8)
    s_barrier
    s_add_u32 m0, s66, 49152
    s_nop 0
    s_nop 0
    buffer_load_dwordx4 v4, s[8:11], s73 offen offset:0 sc1 lds
    buffer_load_dwordx4 v5, s[8:11], s73 offen offset:1024 sc1 lds
    buffer_load_dwordx4 v6, s[8:11], s73 offen offset:2048 sc1 lds
    buffer_load_dwordx4 v7, s[8:11], s73 offen offset:3072 sc1 lds
    s_add_u32 m0, s67, 0
    s_nop 0
    buffer_load_dwordx4 v44, s[12:15], s65 offen offset:0 lds
    buffer_load_dwordx4 v45, s[12:15], s65 offen offset:1024 lds
    s_bfe_u32 s48, s101, 0x40008
    s_lshl_b32 s48, s48, 6
    s_add_u32 s48, s48, s88
    s_mul_i32 s48, s48, 2048
    s_add_u32 s48, s48, s89
    s_and_b32 s49, s4, 8
    s_mul_i32 s49, s49, 128
    s_add_u32 s48, s48, s49
    s_add_u32 s92, s28, s48
    s_addc_u32 s93, s29, 0
    s_nop 0
    s_load_dword s94, s[92:93], 384
    s_bfe_u32 s69, s100, 0x40018
    s_and_b32 s49, s69, 8
    s_lshl_b32 s49, s49, 1
    s_add_u32 s64, s69, s49
    s_lshl_b32 s64, s64, 15
    s_bfe_u32 s69, s101, 0x40004
    s_lshl_b32 s69, s69, 6
    s_nop 0
    s_mul_i32 s74, s69, 2048
    s_waitcnt vmcnt(10)
    s_barrier
    buffer_load_dword v38, v37, s[16:19], 0 offen sc1
    s_add_u32 m0, s66, 81920
    s_nop 0
    s_nop 0
    buffer_load_dwordx4 v4, s[8:11], s64 offen offset:0 sc1 lds
    buffer_load_dwordx4 v5, s[8:11], s64 offen offset:1024 sc1 lds
    buffer_load_dwordx4 v6, s[8:11], s64 offen offset:2048 sc1 lds
    buffer_load_dwordx4 v7, s[8:11], s64 offen offset:3072 sc1 lds
    s_add_u32 m0, s67, 8192
    s_nop 0
    s_nop 0
    buffer_load_dwordx4 v44, s[12:15], s74 offen offset:0 lds
    buffer_load_dwordx4 v45, s[12:15], s74 offen offset:1024 lds
    s_bfe_u32 s69, s100, 0x4001c
    s_and_b32 s49, s69, 8
    s_lshl_b32 s49, s49, 1
    s_add_u32 s73, s69, s49
    s_lshl_b32 s73, s73, 15
    s_bfe_u32 s69, s101, 0x40008
    s_lshl_b32 s69, s69, 6
    s_nop 0
    s_mul_i32 s65, s69, 2048
    s_waitcnt vmcnt(13)
    s_barrier
    s_add_u32 m0, s66, 114688
    s_nop 0
    s_nop 0
    buffer_load_dwordx4 v4, s[8:11], s73 offen offset:0 sc1 lds
    buffer_load_dwordx4 v5, s[8:11], s73 offen offset:1024 sc1 lds
    buffer_load_dwordx4 v6, s[8:11], s73 offen offset:2048 sc1 lds
    buffer_load_dwordx4 v7, s[8:11], s73 offen offset:3072 sc1 lds
    s_add_u32 m0, s67, 32768
    s_nop 0
    s_nop 0
    buffer_load_dwordx4 v44, s[12:15], s65 offen offset:0 lds
    buffer_load_dwordx4 v45, s[12:15], s65 offen offset:1024 lds
    s_bfe_u32 s48, s101, 0x4000c
    s_lshl_b32 s48, s48, 6
    s_add_u32 s48, s48, s88
    s_mul_i32 s48, s48, 2048
    s_add_u32 s48, s48, s89
    s_and_b32 s49, s4, 8
    s_mul_i32 s49, s49, 128
    s_add_u32 s48, s48, s49
    s_add_u32 s92, s28, s48
    s_addc_u32 s93, s29, 0
    s_nop 0
    s_load_dword s94, s[92:93], 384
    s_bfe_u32 s69, s101, 0x40000
    s_and_b32 s49, s69, 8
    s_lshl_b32 s49, s49, 1
    s_add_u32 s64, s69, s49
    s_lshl_b32 s64, s64, 15
    s_waitcnt vmcnt(12)
    s_barrier
    s_add_u32 s84, s47, 1
    s_cmp_lt_u32 s4, 8
    s_cselect_b32 s76, 0, -1
    s_cselect_b32 s77, -1, 0
    v_cmp_le_u32 vcc, s84, v38
    s_nop 0
    s_andn2_b64 s[78:79], s[76:77], vcc
    s_cbranch_scc1 fcc_64
fc_63:
    s_add_u32 m0, s66, 16384
    s_nop 0
    s_nop 0
    buffer_load_dwordx4 v4, s[8:11], s64 offen offset:0 sc1 lds
    buffer_load_dwordx4 v5, s[8:11], s64 offen offset:1024 sc1 lds
    buffer_load_dwordx4 v6, s[8:11], s64 offen offset:2048 sc1 lds
    buffer_load_dwordx4 v7, s[8:11], s64 offen offset:3072 sc1 lds
    s_bfe_u32 s48, s101, 0x40010
    s_lshl_b32 s48, s48, 6
    s_add_u32 s48, s48, s88
    s_mul_i32 s48, s48, 2048
    s_add_u32 s48, s48, s89
    s_and_b32 s49, s4, 8
    s_mul_i32 s49, s49, 128
    s_add_u32 s48, s48, s49
    s_add_u32 s92, s28, s48
    s_addc_u32 s93, s29, 0
    s_nop 0
    s_load_dword s94, s[92:93], 384
    s_bfe_u32 s69, s101, 0x40004
    s_and_b32 s49, s69, 8
    s_lshl_b32 s49, s49, 1
    s_add_u32 s73, s69, s49
    s_lshl_b32 s73, s73, 15
    s_bfe_u32 s69, s101, 0x4000c
    s_lshl_b32 s69, s69, 6
    s_nop 0
    s_mul_i32 s74, s69, 2048
    s_waitcnt vmcnt(12)
    s_barrier
    s_add_u32 m0, s66, 49152
    s_nop 0
    s_nop 0
    buffer_load_dwordx4 v4, s[8:11], s73 offen offset:0 sc1 lds
    buffer_load_dwordx4 v5, s[8:11], s73 offen offset:1024 sc1 lds
    buffer_load_dwordx4 v6, s[8:11], s73 offen offset:2048 sc1 lds
    buffer_load_dwordx4 v7, s[8:11], s73 offen offset:3072 sc1 lds
    s_add_u32 m0, s67, 40960
    s_nop 0
    s_nop 0
    buffer_load_dwordx4 v44, s[12:15], s74 offen offset:0 lds
    buffer_load_dwordx4 v45, s[12:15], s74 offen offset:1024 lds
    s_bfe_u32 s69, s101, 0x40008
    s_and_b32 s49, s69, 8
    s_lshl_b32 s49, s49, 1
    s_add_u32 s64, s69, s49
    s_lshl_b32 s64, s64, 15
    s_bfe_u32 s69, s101, 0x40010
    s_lshl_b32 s69, s69, 6
    s_nop 0
    s_mul_i32 s65, s69, 2048
    s_waitcnt vmcnt(12)
    s_barrier
    s_add_u32 m0, s66, 81920
    s_nop 0
    s_nop 0
    buffer_load_dwordx4 v4, s[8:11], s64 offen offset:0 sc1 lds
    buffer_load_dwordx4 v5, s[8:11], s64 offen offset:1024 sc1 lds
    buffer_load_dwordx4 v6, s[8:11], s64 offen offset:2048 sc1 lds
    buffer_load_dwordx4 v7, s[8:11], s64 offen offset:3072 sc1 lds
    s_add_u32 m0, s67, 65536
    s_nop 0
    s_nop 0
    buffer_load_dwordx4 v44, s[12:15], s65 offen offset:0 lds
    buffer_load_dwordx4 v45, s[12:15], s65 offen offset:1024 lds
    s_bfe_u32 s48, s101, 0x40014
    s_lshl_b32 s48, s48, 6
    s_add_u32 s48, s48, s88
    s_mul_i32 s48, s48, 2048
    s_add_u32 s48, s48, s89
    s_and_b32 s49, s4, 8
    s_mul_i32 s49, s49, 128
    s_add_u32 s48, s48, s49
    s_add_u32 s92, s28, s48
    s_addc_u32 s93, s29, 0
    s_nop 0
    s_load_dword s94, s[92:93], 384
    s_bfe_u32 s69, s101, 0x4000c
    s_and_b32 s49, s69, 8
    s_lshl_b32 s49, s49, 1
    s_add_u32 s73, s69, s49
    s_lshl_b32 s73, s73, 15
    s_waitcnt vmcnt(12)
    s_barrier
    s_add_u32 m0, s66, 114688
    s_nop 0
    s_nop 0
    buffer_load_dwordx4 v4, s[8:11], s73 offen offset:0 sc1 lds
    buffer_load_dwordx4 v5, s[8:11], s73 offen offset:1024 sc1 lds
    buffer_load_dwordx4 v6, s[8:11], s73 offen offset:2048 sc1 lds
    buffer_load_dwordx4 v7, s[8:11], s73 offen offset:3072 sc1 lds
    s_bfe_u32 s48, s101, 0x40018
    s_lshl_b32 s48, s48, 6
    s_add_u32 s48, s48, s88
    s_mul_i32 s48, s48, 2048
    s_add_u32 s48, s48, s89
    s_and_b32 s49, s4, 8
    s_mul_i32 s49, s49, 128
    s_add_u32 s48, s48, s49
    s_add_u32 s92, s28, s48
    s_addc_u32 s93, s29, 0
    s_nop 0
    s_load_dword s94, s[92:93], 384
    s_bfe_u32 s69, s101, 0x40010
    s_and_b32 s49, s69, 8
    s_lshl_b32 s49, s49, 1
    s_add_u32 s64, s69, s49
    s_lshl_b32 s64, s64, 15
    s_bfe_u32 s69, s101, 0x40014
    s_lshl_b32 s69, s69, 6
    s_nop 0
    s_mul_i32 s74, s69, 2048
    s_waitcnt vmcnt(12)
    s_barrier
    s_add_u32 m0, s66, 16384
    s_nop 0
    s_nop 0
    buffer_load_dwordx4 v4, s[8:11], s64 offen offset:0 sc1 lds
    buffer_load_dwordx4 v5, s[8:11], s64 offen offset:1024 sc1 lds
    buffer_load_dwordx4 v6, s[8:11], s64 offen offset:2048 sc1 lds
    buffer_load_dwordx4 v7, s[8:11], s64 offen offset:3072 sc1 lds
    s_add_u32 m0, s67, 73728
    s_nop 0
    s_nop 0
    buffer_load_dwordx4 v44, s[12:15], s74 offen offset:0 lds
    buffer_load_dwordx4 v45, s[12:15], s74 offen offset:1024 lds
    s_bfe_u32 s48, s101, 0x4001c
    s_lshl_b32 s48, s48, 6
    s_add_u32 s48, s48, s88
    s_mul_i32 s48, s48, 2048
    s_add_u32 s48, s48, s89
    s_and_b32 s49, s4, 8
    s_mul_i32 s49, s49, 128
    s_add_u32 s48, s48, s49
    s_add_u32 s92, s28, s48
    s_addc_u32 s93, s29, 0
    s_nop 0
    s_load_dword s94, s[92:93], 384
    s_bfe_u32 s69, s101, 0x40014
    s_and_b32 s49, s69, 8
    s_lshl_b32 s49, s49, 1
    s_add_u32 s73, s69, s49
    s_lshl_b32 s73, s73, 15
    s_bfe_u32 s69, s101, 0x40018
    s_lshl_b32 s69, s69, 6
    s_nop 0
    s_mul_i32 s65, s69, 2048
    s_waitcnt vmcnt(12)
    s_barrier
    s_add_u32 m0, s66, 49152
    s_nop 0
    s_nop 0
    buffer_load_dwordx4 v4, s[8:11], s73 offen offset:0 sc1 lds
    buffer_load_dwordx4 v5, s[8:11], s73 offen offset:1024 sc1 lds
    buffer_load_dwordx4 v6, s[8:11], s73 offen offset:2048 sc1 lds
    buffer_load_dwordx4 v7, s[8:11], s73 offen offset:3072 sc1 lds
    s_add_u32 m0, s67, 98304
    s_nop 0
    s_nop 0
    buffer_load_dwordx4 v44, s[12:15], s65 offen offset:0 lds
    buffer_load_dwordx4 v45, s[12:15], s65 offen offset:1024 lds
    s_bfe_u32 s48, s99, 0x40000
    s_lshl_b32 s48, s48, 6
    s_add_u32 s48, s48, s88
    s_mul_i32 s48, s48, 7168
    s_add_u32 s48, s48, s89
    s_add_u32 s90, s32, s48
    s_addc_u32 s91, s33, 0
    s_nop 0
    s_load_dword s94, s[90:91], 6528
    s_and_b32 s49, s4, 8
    s_nop 0
    s_mul_i32 s49, s49, 384
    s_add_u32 s48, s48, s49
    s_add_u32 s92, s32, s48
    s_addc_u32 s93, s33, 0
    s_nop 0
    s_load_dword s94, s[92:93], 384
    s_load_dword s94, s[92:93], 1408
    s_load_dword s94, s[92:93], 2432
    s_bfe_u32 s69, s101, 0x40018
    s_and_b32 s49, s69, 8
    s_lshl_b32 s49, s49, 1
    s_add_u32 s64, s69, s49
    s_lshl_b32 s64, s64, 15
    s_bfe_u32 s69, s101, 0x4001c
    s_lshl_b32 s69, s69, 6
    s_nop 0
    s_mul_i32 s74, s69, 2048
    s_waitcnt vmcnt(12)
    s_barrier
    s_add_u32 m0, s66, 81920
    s_nop 0
    s_nop 0
    buffer_load_dwordx4 v4, s[8:11], s64 offen offset:0 sc1 lds
    buffer_load_dwordx4 v5, s[8:11], s64 offen offset:1024 sc1 lds
    buffer_load_dwordx4 v6, s[8:11], s64 offen offset:2048 sc1 lds
    buffer_load_dwordx4 v7, s[8:11], s64 offen offset:3072 sc1 lds
    s_add_u32 m0, s67, 106496
    s_nop 0
    s_nop 0
    buffer_load_dwordx4 v44, s[12:15], s74 offen offset:0 lds
    buffer_load_dwordx4 v45, s[12:15], s74 offen offset:1024 lds
    s_bfe_u32 s48, s99, 0x40004
    s_lshl_b32 s48, s48, 6
    s_add_u32 s48, s48, s88
    s_mul_i32 s48, s48, 7168
    s_add_u32 s48, s48, s89
    s_add_u32 s90, s32, s48
    s_addc_u32 s91, s33, 0
    s_nop 0
    s_load_dword s94, s[90:91], 6528
    s_and_b32 s49, s4, 8
    s_nop 0
    s_mul_i32 s49, s49, 384
    s_add_u32 s48, s48, s49
    s_add_u32 s92, s32, s48
    s_addc_u32 s93, s33, 0
    s_nop 0
    s_load_dword s94, s[92:93], 384
    s_load_dword s94, s[92:93], 1408
    s_load_dword s94, s[92:93], 2432
    s_bfe_u32 s69, s101, 0x4001c
    s_and_b32 s49, s69, 8
    s_lshl_b32 s49, s49, 1
    s_add_u32 s73, s69, s49
    s_lshl_b32 s73, s73, 15
    s_waitcnt vmcnt(14)
    s_barrier
    s_add_u32 m0, s66, 114688
    s_nop 0
    s_nop 0
    buffer_load_dwordx4 v4, s[8:11], s73 offen offset:0 sc1 lds
    buffer_load_dwordx4 v5, s[8:11], s73 offen offset:1024 sc1 lds
    buffer_load_dwordx4 v6, s[8:11], s73 offen offset:2048 sc1 lds
    buffer_load_dwordx4 v7, s[8:11], s73 offen offset:3072 sc1 lds
    s_waitcnt vmcnt(12)
    s_barrier
    s_mov_b32 s12, s32
    s_mov_b32 s13, s33
    s_mov_b32 s14, 7340032
    s_mov_b32 s15, 0x20000
    s_bfe_u32 s69, s100, 0x40000
    s_lshl_b32 s69, s69, 6
    s_nop 0
    s_mul_i32 s65, s69, 7168
    s_add_u32 m0, s67, 0
    s_nop 0
    buffer_load_dwordx4 v48, s[12:15], s65 offen offset:0 lds
    buffer_load_dwordx4 v49, s[12:15], s65 offen offset:1024 lds
    s_add_u32 m0, s67, 8192
    s_nop 0
    s_nop 0
    buffer_load_dwordx4 v50, s[12:15], s65 offen offset:0 lds
    buffer_load_dwordx4 v51, s[12:15], s65 offen offset:1024 lds
    s_add_u32 m0, s67, 16384
    s_nop 0
    s_nop 0
    buffer_load_dwordx4 v52, s[12:15], s65 offen offset:0 lds
    buffer_load_dwordx4 v53, s[12:15], s65 offen offset:1024 lds
    s_add_u32 m0, s68, 24576
    s_nop 0
    s_nop 0
    buffer_load_dwordx4 v54, s[12:15], s65 offen offset:0 lds
    s_waitcnt vmcnt(13)
    s_barrier
    s_bfe_u32 s69, s100, 0x40004
    s_lshl_b32 s69, s69, 6
    s_nop 0
    s_mul_i32 s74, s69, 7168
    s_add_u32 m0, s67, 28672
    s_nop 0
    s_nop 0
    buffer_load_dwordx4 v48, s[12:15], s74 offen offset:0 lds
    buffer_load_dwordx4 v49, s[12:15], s74 offen offset:1024 lds
    s_add_u32 m0, s67, 36864
    s_nop 0
    s_nop 0
    buffer_load_dwordx4 v50, s[12:15], s74 offen offset:0 lds
    buffer_load_dwordx4 v51, s[12:15], s74 offen offset:1024 lds
    s_add_u32 m0, s67, 45056
    s_nop 0
    s_nop 0
    buffer_load_dwordx4 v52, s[12:15], s74 offen offset:0 lds
    buffer_load_dwordx4 v53, s[12:15], s74 offen offset:1024 lds
    s_add_u32 m0, s68, 53248
    s_nop 0
    s_nop 0
    buffer_load_dwordx4 v54, s[12:15], s74 offen offset:0 lds
    s_waitcnt vmcnt(14)
    s_barrier
    s_waitcnt lgkmcnt(0)
    s_barrier
    s_bfe_u32 s48, s99, 0x40008
    s_lshl_b32 s48, s48, 6
    s_add_u32 s48, s48, s88
    s_mul_i32 s48, s48, 7168
    s_add_u32 s48, s48, s89
    s_add_u32 s90, s32, s48
    s_addc_u32 s91, s33, 0
    s_nop 0
    s_load_dword s94, s[90:91], 6528
    s_and_b32 s49, s4, 8
    s_nop 0
    s_mul_i32 s49, s49, 384
    s_add_u32 s48, s48, s49
    s_add_u32 s92, s32, s48
    s_addc_u32 s93, s33, 0
    s_nop 0
    s_load_dword s94, s[92:93], 384
    s_load_dword s94, s[92:93], 1408
    s_load_dword s94, s[92:93], 2432
    s_bfe_u32 s48, s99, 0x4000c
    s_lshl_b32 s48, s48, 6
    s_add_u32 s48, s48, s88
    s_mul_i32 s48, s48, 7168
    s_add_u32 s48, s48, s89
    s_add_u32 s90, s32, s48
    s_addc_u32 s91, s33, 0
    s_nop 0
    s_load_dword s94, s[90:91], 6528
    s_and_b32 s49, s4, 8
    s_nop 0
    s_mul_i32 s49, s49, 384
    s_add_u32 s48, s48, s49
    s_add_u32 s92, s32, s48
    s_addc_u32 s93, s33, 0
    s_nop 0
    s_load_dword s94, s[92:93], 384
    s_load_dword s94, s[92:93], 1408
    s_load_dword s94, s[92:93], 2432
    s_mul_i32 s48, s3, 524288
    s_add_u32 s48, s48, 8388608
    s_add_u32 s8, s16, s48
    s_addc_u32 s9, s17, 0
    s_mov_b32 s10, 524288
    s_mov_b32 s11, 0x20000
    s_waitcnt vmcnt(7)
    s_barrier
    s_bfe_u32 s48, s100, 0x40000
    s_add_u32 s48, s48, s47
    s_cmp_lg_u32 s48, s61
    s_cbranch_scc1 csd_68
    s_cmp_eq_u32 s6, 3
    s_cbranch_scc1 csh_69
    s_lshl_b32 s48, s6, 13
    s_add_u32 s48, s48, 0
    v_add_u32 v16, s48, v29
    v_xor_b32_e64 v17, 0, v16
    ds_read_b64_tr_b16 v[64:65], v17 offset:0
    ds_read_b64_tr_b16 v[66:67], v17 offset:512
    ds_read_b64_tr_b16 v[68:69], v17 offset:4096
    ds_read_b64_tr_b16 v[70:71], v17 offset:4608
    v_xor_b32_e64 v17, 32, v16
    ds_read_b64_tr_b16 v[72:73], v17 offset:0
    ds_read_b64_tr_b16 v[74:75], v17 offset:512
    ds_read_b64_tr_b16 v[76:77], v17 offset:4096
    ds_read_b64_tr_b16 v[78:79], v17 offset:4608
    v_xor_b32_e64 v17, 64, v16
    ds_read_b64_tr_b16 v[80:81], v17 offset:0
    ds_read_b64_tr_b16 v[82:83], v17 offset:512
    ds_read_b64_tr_b16 v[84:85], v17 offset:4096
    ds_read_b64_tr_b16 v[86:87], v17 offset:4608
    v_xor_b32 v17, 96, v16
    ds_read_b64_tr_b16 v[88:89], v17 offset:0
    ds_read_b64_tr_b16 v[90:91], v17 offset:512
    ds_read_b64_tr_b16 v[92:93], v17 offset:4096
    ds_read_b64_tr_b16 v[94:95], v17 offset:4608
    s_branch csd_68
csh_69:
    s_nop 0
    v_add_u32 v16, 24576, v30
    v_xor_b32_e64 v17, 0, v16
    ds_read_b64_tr_b16 v[64:65], v17 offset:0
    ds_read_b64_tr_b16 v[66:67], v17 offset:256
    ds_read_b64_tr_b16 v[68:69], v17 offset:2048
    ds_read_b64_tr_b16 v[70:71], v17 offset:2304
    v_xor_b32_e64 v17, 32, v16
    ds_read_b64_tr_b16 v[72:73], v17 offset:0
    ds_read_b64_tr_b16 v[74:75], v17 offset:256
    ds_read_b64_tr_b16 v[76:77], v17 offset:2048
    ds_read_b64_tr_b16 v[78:79], v17 offset:2304
    v_mov_b64 v[80:81], 0
    v_mov_b64 v[82:83], 0
    v_mov_b64 v[84:85], 0
    v_mov_b64 v[86:87], 0
    v_mov_b64 v[88:89], 0
    v_mov_b64 v[90:91], 0
    v_mov_b64 v[92:93], 0
    v_mov_b64 v[94:95], 0
csd_68:
    s_bfe_u32 s69, s100, 0x40008
    s_lshl_b32 s69, s69, 6
    s_nop 0
    s_mul_i32 s65, s69, 7168
    s_add_u32 m0, s67, 57344
    s_nop 0
    s_nop 0
    buffer_load_dwordx4 v48, s[12:15], s65 offen offset:0 lds
    buffer_load_dwordx4 v49, s[12:15], s65 offen offset:1024 lds
    s_add_u32 m0, s67, 65536
    s_nop 0
    s_nop 0
    buffer_load_dwordx4 v50, s[12:15], s65 offen offset:0 lds
    buffer_load_dwordx4 v51, s[12:15], s65 offen offset:1024 lds
    s_add_u32 m0, s67, 73728
    s_nop 0
    s_nop 0
    buffer_load_dwordx4 v52, s[12:15], s65 offen offset:0 lds
    buffer_load_dwordx4 v53, s[12:15], s65 offen offset:1024 lds
    s_add_u32 m0, s68, 81920
    s_nop 0
    s_nop 0
    buffer_load_dwordx4 v54, s[12:15], s65 offen offset:0 lds
    s_add_u32 s84, s47, 3
    s_cmp_ge_u32 s4, 8
    s_cselect_b32 s76, 0, -1
    s_cselect_b32 s77, -1, 0
poll_71:
    buffer_load_dword v38, v36, s[16:19], 0 offen sc1
    s_waitcnt vmcnt(0)
pollc_72:
    v_cmp_le_u32 vcc, s84, v38
    s_nop 0
    s_andn2_b64 s[78:79], s[76:77], vcc
    s_cbranch_scc0 polld_73
    s_sub_u32 s85, s85, 1
    s_cbranch_scc0 poll_71
    s_mov_b32 s85, 0
polld_73:
    s_bfe_u32 s69, s100, 0x40004
    s_lshl_b32 s73, s69, 15
    s_nop 0
    s_add_u32 m0, s66, 102400
    s_nop 0
    s_nop 0
    buffer_load_dwordx4 v4, s[8:11], s73 offen offset:0 sc1 lds
    buffer_load_dwordx4 v5, s[8:11], s73 offen offset:1024 sc1 lds
    buffer_load_dwordx4 v6, s[8:11], s73 offen offset:2048 sc1 lds
    buffer_load_dwordx4 v7, s[8:11], s73 offen offset:3072 sc1 lds
    s_bfe_u32 s69, s100, 0x40008
    s_lshl_b32 s64, s69, 15
    s_nop 0
    s_add_u32 m0, s66, 118784
    s_nop 0
    s_nop 0
    buffer_load_dwordx4 v4, s[8:11], s64 offen offset:0 sc1 lds
    buffer_load_dwordx4 v5, s[8:11], s64 offen offset:1024 sc1 lds
    buffer_load_dwordx4 v6, s[8:11], s64 offen offset:2048 sc1 lds
    buffer_load_dwordx4 v7, s[8:11], s64 offen offset:3072 sc1 lds
    s_bfe_u32 s48, s100, 0x40000
    s_add_u32 s48, s48, s47
    s_cmp_lg_u32 s48, s61
    s_cbranch_scc1 csd_74
    s_waitcnt lgkmcnt(0)
csd_74:
    s_bfe_u32 s48, s99, 0x40010
    s_lshl_b32 s48, s48, 6
    s_add_u32 s48, s48, s88
    s_mul_i32 s48, s48, 7168
    s_add_u32 s48, s48, s89
    s_add_u32 s90, s32, s48
    s_addc_u32 s91, s33, 0
    s_nop 0
    s_load_dword s94, s[90:91], 6528
    s_and_b32 s49, s4, 8
    s_nop 0
    s_mul_i32 s49, s49, 384
    s_add_u32 s48, s48, s49
    s_add_u32 s92, s32, s48
    s_addc_u32 s93, s33, 0
    s_nop 0
    s_load_dword s94, s[92:93], 384
    s_load_dword s94, s[92:93], 1408
    s_load_dword s94, s[92:93], 2432
    s_bfe_u32 s69, s100, 0x4000c
    s_lshl_b32 s73, s69, 15
    s_lshl_b32 s69, s69, 6
    s_mul_i32 s74, s69, 7168
    s_cmp_lg_u32 s7, 0
    s_cbranch_scc1 jt_77
    s_lshl_b32 s48, s2, 2
    s_add_u32 s48, s48, s6
    s_mul_i32 s49, s48, 7168
    s_add_u32 s90, s36, s49
    s_addc_u32 s91, s37, 0
    s_load_dword s94, s[90:91], 0
    s_load_dword s94, s[90:91], 64
    s_load_dword s94, s[90:91], 128
    s_load_dword s94, s[90:91], 192
    s_load_dword s94, s[90:91], 256
    s_load_dword s94, s[90:91], 320
    s_load_dword s94, s[90:91], 384
jt_77:
    s_waitcnt vmcnt(4)
    s_barrier
    s_bfe_u32 s48, s100, 0x40004
    s_add_u32 s48, s48, s47
    s_cmp_lg_u32 s48, s61
    s_cbranch_scc1 csd_78
    s_cmp_eq_u32 s6, 3
    s_cbranch_scc1 csh_79
    s_lshl_b32 s48, s6, 13
    s_add_u32 s48, s48, 28672
    v_add_u32 v16, s48, v29
    v_xor_b32 v17, 0, v16
    ds_read_b64_tr_b16 v[64:65], v17 offset:0
    ds_read_b64_tr_b16 v[66:67], v17 offset:512
    ds_read_b64_tr_b16 v[68:69], v17 offset:4096
    ds_read_b64_tr_b16 v[70:71], v17 offset:4608
    v_xor_b32_e64 v17, 32, v16
    ds_read_b64_tr_b16 v[72:73], v17 offset:0
    ds_read_b64_tr_b16 v[74:75], v17 offset:512
    ds_read_b64_tr_b16 v[76:77], v17 offset:4096
    ds_read_b64_tr_b16 v[78:79], v17 offset:4608
    v_xor_b32_e64 v17, 64, v16
    ds_read_b64_tr_b16 v[80:81], v17 offset:0
    ds_read_b64_tr_b16 v[82:83], v17 offset:512
    ds_read_b64_tr_b16 v[84:85], v17 offset:4096
    ds_read_b64_tr_b16 v[86:87], v17 offset:4608
    v_xor_b32 v17, 96, v16
    ds_read_b64_tr_b16 v[88:89], v17 offset:0
    ds_read_b64_tr_b16 v[90:91], v17 offset:512
    ds_read_b64_tr_b16 v[92:93], v17 offset:4096
    ds_read_b64_tr_b16 v[94:95], v17 offset:4608
    s_branch csd_78
csh_79:
    s_nop 0
    v_add_u32 v16, 53248, v30
    v_xor_b32_e64 v17, 0, v16
    ds_read_b64_tr_b16 v[64:65], v17 offset:0
    ds_read_b64_tr_b16 v[66:67], v17 offset:256
    ds_read_b64_tr_b16 v[68:69], v17 offset:2048
    ds_read_b64_tr_b16 v[70:71], v17 offset:2304
    v_xor_b32_e64 v17, 32, v16
    ds_read_b64_tr_b16 v[72:73], v17 offset:0
    ds_read_b64_tr_b16 v[74:75], v17 offset:256
    ds_read_b64_tr_b16 v[76:77], v17 offset:2048
    ds_read_b64_tr_b16 v[78:79], v17 offset:2304
    v_mov_b64 v[80:81], 0
    v_mov_b64 v[82:83], 0
    v_mov_b64 v[84:85], 0
    v_mov_b64 v[86:87], 0
    v_mov_b64 v[88:89], 0
    v_mov_b64 v[90:91], 0
    v_mov_b64 v[92:93], 0
    v_mov_b64 v[94:95], 0
csd_78:
    s_add_u32 m0, s66, 86016
    s_nop 0
    s_nop 0
    buffer_load_dwordx4 v4, s[8:11], s73 offen offset:0 sc1 lds
    buffer_load_dwordx4 v5, s[8:11], s73 offen offset:1024 sc1 lds
    buffer_load_dwordx4 v6, s[8:11], s73 offen offset:2048 sc1 lds
    buffer_load_dwordx4 v7, s[8:11], s73 offen offset:3072 sc1 lds
    s_add_u32 m0, s67, 0
    s_nop 0
    buffer_load_dwordx4 v48, s[12:15], s74 offen offset:0 lds
    buffer_load_dwordx4 v49, s[12:15], s74 offen offset:1024 lds
    s_add_u32 m0, s67, 8192
    s_nop 0
    s_nop 0
    buffer_load_dwordx4 v50, s[12:15], s74 offen offset:0 lds
    buffer_load_dwordx4 v51, s[12:15], s74 offen offset:1024 lds
    s_add_u32 m0, s67, 16384
    s_nop 0
    s_nop 0
    buffer_load_dwordx4 v52, s[12:15], s74 offen offset:0 lds
    buffer_load_dwordx4 v53, s[12:15], s74 offen offset:1024 lds
    s_add_u32 m0, s68, 24576
    s_nop 0
    s_nop 0
    buffer_load_dwordx4 v54, s[12:15], s74 offen offset:0 lds
    s_bfe_u32 s48, s100, 0x40004
    s_add_u32 s48, s48, s47
    s_cmp_lg_u32 s48, s61
    s_cbranch_scc1 csd_81
    s_waitcnt lgkmcnt(0)
csd_81:
    s_bfe_u32 s48, s99, 0x40014
    s_lshl_b32 s48, s48, 6
    s_add_u32 s48, s48, s88
    s_mul_i32 s48, s48, 7168
    s_add_u32 s48, s48, s89
    s_add_u32 s90, s32, s48
    s_addc_u32 s91, s33, 0
    s_nop 0
    s_load_dword s94, s[90:91], 6528
    s_and_b32 s49, s4, 8
    s_nop 0
    s_mul_i32 s49, s49, 384
    s_add_u32 s48, s48, s49
    s_add_u32 s92, s32, s48
    s_addc_u32 s93, s33, 0
    s_nop 0
    s_load_dword s94, s[92:93], 384
    s_load_dword s94, s[92:93], 1408
    s_load_dword s94, s[92:93], 2432
    s_bfe_u32 s69, s100, 0x40010
    s_lshl_b32 s64, s69, 15
    s_lshl_b32 s69, s69, 6
    s_mul_i32 s65, s69, 7168
    s_bfe_u32 s48, s100, 0x40000
    s_add_u32 s48, s48, s47
    s_cmp_lg_u32 s48, s61
    s_cbranch_scc1 csd_84
    s_nop 0
    v_mov_b32 v112, 0x3f803f80
    v_mov_b32 v113, 0x3f803f80
    v_mov_b32 v114, 0x3f803f80
    v_mov_b32 v115, 0x3f803f80
    s_nop 1
    s_nop 0
    v_mfma_f32_16x16x32_bf16 v[96:99], v[112:115], v[64:67], 0
    v_mfma_f32_16x16x32_bf16 v[96:99], v[112:115], v[68:71], v[96:99]
    v_mfma_f32_16x16x32_bf16 v[100:103], v[112:115], v[72:75], 0
    v_mfma_f32_16x16x32_bf16 v[100:103], v[112:115], v[76:79], v[100:103]
    v_mfma_f32_16x16x32_bf16 v[104:107], v[112:115], v[80:83], 0
    v_mfma_f32_16x16x32_bf16 v[104:107], v[112:115], v[84:87], v[104:107]
    v_mfma_f32_16x16x32_bf16 v[108:111], v[112:115], v[88:91], 0
    v_mfma_f32_16x16x32_bf16 v[108:111], v[112:115], v[92:95], v[108:111]
    s_lshl_b32 s48, s4, 14
    s_lshl_b32 s49, s3, 10
    s_add_u32 s48, s48, s49
    s_nop 0
    s_add_u32 s48, s48, 2359296
    v_cmp_gt_u32 vcc, 16, v0
    s_nop 1
    v_cndmask_b32 v96, v100, v96, vcc
    v_cmp_gt_u32 vcc, 48, v0
    s_nop 1
    v_cndmask_b32 v104, v108, v104, vcc
    v_cmp_gt_u32 vcc, 32, v0
    s_nop 1
    v_cndmask_b32_e64 v96, v104, v96, vcc
    buffer_store_dword v96, v34, s[16:19], s48 offen sc1
csd_84:
    s_cmp_lg_u32 s7, 0
    s_cbranch_scc1 jt_87
    s_lshl_b32 s48, s2, 2
    s_add_u32 s48, s48, s6
    s_mul_i32 s49, s48, 7168
    s_add_u32 s90, s36, s49
    s_addc_u32 s91, s37, 0
    s_load_dword s94, s[90:91], 448
    s_load_dword s94, s[90:91], 512
    s_load_dword s94, s[90:91], 576
    s_load_dword s94, s[90:91], 640
    s_load_dword s94, s[90:91], 704
    s_load_dword s94, s[90:91], 768
    s_load_dword s94, s[90:91], 832
jt_87:
    s_waitcnt vmcnt(11)
    s_barrier
    s_bfe_u32 s48, s100, 0x40008
    s_add_u32 s48, s48, s47
    s_cmp_lg_u32 s48, s61
    s_cbranch_scc1 csd_88
    s_cmp_eq_u32 s6, 3
    s_cbranch_scc1 csh_89
    s_lshl_b32 s48, s6, 13
    s_add_u32 s48, s48, 57344
    v_add_u32 v16, s48, v29
    v_xor_b32 v17, 0, v16
    ds_read_b64_tr_b16 v[64:65], v17 offset:0
    ds_read_b64_tr_b16 v[66:67], v17 offset:512
    ds_read_b64_tr_b16 v[68:69], v17 offset:4096
    ds_read_b64_tr_b16 v[70:71], v17 offset:4608
    v_xor_b32_e64 v17, 32, v16
    ds_read_b64_tr_b16 v[72:73], v17 offset:0
    ds_read_b64_tr_b16 v[74:75], v17 offset:512
    ds_read_b64_tr_b16 v[76:77], v17 offset:4096
    ds_read_b64_tr_b16 v[78:79], v17 offset:4608
    v_xor_b32_e64 v17, 64, v16
    ds_read_b64_tr_b16 v[80:81], v17 offset:0
    ds_read_b64_tr_b16 v[82:83], v17 offset:512
    ds_read_b64_tr_b16 v[84:85], v17 offset:4096
    ds_read_b64_tr_b16 v[86:87], v17 offset:4608
    v_xor_b32 v17, 96, v16
    ds_read_b64_tr_b16 v[88:89], v17 offset:0
    ds_read_b64_tr_b16 v[90:91], v17 offset:512
    ds_read_b64_tr_b16 v[92:93], v17 offset:4096
    ds_read_b64_tr_b16 v[94:95], v17 offset:4608
    s_branch csd_88
csh_89:
    s_nop 0
    v_add_u32 v16, 81920, v30
    v_xor_b32_e64 v17, 0, v16
    ds_read_b64_tr_b16 v[64:65], v17 offset:0
    ds_read_b64_tr_b16 v[66:67], v17 offset:256
    ds_read_b64_tr_b16 v[68:69], v17 offset:2048
    ds_read_b64_tr_b16 v[70:71], v17 offset:2304
    v_xor_b32_e64 v17, 32, v16
    ds_read_b64_tr_b16 v[72:73], v17 offset:0
    ds_read_b64_tr_b16 v[74:75], v17 offset:256
    ds_read_b64_tr_b16 v[76:77], v17 offset:2048
    ds_read_b64_tr_b16 v[78:79], v17 offset:2304
    v_mov_b64 v[80:81], 0
    v_mov_b64 v[82:83], 0
    v_mov_b64 v[84:85], 0
    v_mov_b64 v[86:87], 0
    v_mov_b64 v[88:89], 0
    v_mov_b64 v[90:91], 0
    v_mov_b64 v[92:93], 0
    v_mov_b64 v[94:95], 0
csd_88:
    s_add_u32 m0, s66, 102400
    s_nop 0
    s_nop 0
    buffer_load_dwordx4 v4, s[8:11], s64 offen offset:0 sc1 lds
    buffer_load_dwordx4 v5, s[8:11], s64 offen offset:1024 sc1 lds
    buffer_load_dwordx4 v6, s[8:11], s64 offen offset:2048 sc1 lds
    buffer_load_dwordx4 v7, s[8:11], s64 offen offset:3072 sc1 lds
    s_add_u32 m0, s67, 28672
    s_nop 0
    s_nop 0
    buffer_load_dwordx4 v48, s[12:15], s65 offen offset:0 lds
    buffer_load_dwordx4 v49, s[12:15], s65 offen offset:1024 lds
    s_add_u32 m0, s67, 36864
    s_nop 0
    s_nop 0
    buffer_load_dwordx4 v50, s[12:15], s65 offen offset:0 lds
    buffer_load_dwordx4 v51, s[12:15], s65 offen offset:1024 lds
    s_add_u32 m0, s67, 45056
    s_nop 0
    s_nop 0
    buffer_load_dwordx4 v52, s[12:15], s65 offen offset:0 lds
    buffer_load_dwordx4 v53, s[12:15], s65 offen offset:1024 lds
    s_add_u32 m0, s68, 53248
    s_nop 0
    s_nop 0
    buffer_load_dwordx4 v54, s[12:15], s65 offen offset:0 lds
    s_bfe_u32 s48, s100, 0x40008
    s_add_u32 s48, s48, s47
    s_cmp_lg_u32 s48, s61
    s_cbranch_scc1 csd_91
    s_waitcnt lgkmcnt(0)
csd_91:
    s_bfe_u32 s48, s99, 0x40018
    s_lshl_b32 s48, s48, 6
    s_add_u32 s48, s48, s88
    s_mul_i32 s48, s48, 7168
    s_add_u32 s48, s48, s89
    s_add_u32 s90, s32, s48
    s_addc_u32 s91, s33, 0
    s_nop 0
    s_load_dword s94, s[90:91], 6528
    s_and_b32 s49, s4, 8
    s_nop 0
    s_mul_i32 s49, s49, 384
    s_add_u32 s48, s48, s49
    s_add_u32 s92, s32, s48
    s_addc_u32 s93, s33, 0
    s_nop 0
    s_load_dword s94, s[92:93], 384
    s_load_dword s94, s[92:93], 1408
    s_load_dword s94, s[92:93], 2432
    s_bfe_u32 s69, s100, 0x40014
    s_lshl_b32 s73, s69, 15
    s_lshl_b32 s69, s69, 6
    s_mul_i32 s74, s69, 7168
    s_bfe_u32 s48, s100, 0x40004
    s_add_u32 s48, s48, s47
    s_cmp_lg_u32 s48, s61
    s_cbranch_scc1 csd_94
    s_nop 0
    v_mov_b32 v112, 0x3f803f80
    v_mov_b32 v113, 0x3f803f80
    v_mov_b32 v114, 0x3f803f80
    v_mov_b32 v115, 0x3f803f80
    s_nop 1
    s_nop 0
    v_mfma_f32_16x16x32_bf16 v[96:99], v[112:115], v[64:67], 0
    v_mfma_f32_16x16x32_bf16 v[96:99], v[112:115], v[68:71], v[96:99]
    v_mfma_f32_16x16x32_bf16 v[100:103], v[112:115], v[72:75], 0
    v_mfma_f32_16x16x32_bf16 v[100:103], v[112:115], v[76:79], v[100:103]
    v_mfma_f32_16x16x32_bf16 v[104:107], v[112:115], v[80:83], 0
    v_mfma_f32_16x16x32_bf16 v[104:107], v[112:115], v[84:87], v[104:107]
    v_mfma_f32_16x16x32_bf16 v[108:111], v[112:115], v[88:91], 0
    v_mfma_f32_16x16x32_bf16 v[108:111], v[112:115], v[92:95], v[108:111]
    s_lshl_b32 s48, s4, 14
    s_lshl_b32 s49, s3, 10
    s_add_u32 s48, s48, s49
    s_nop 0
    s_add_u32 s48, s48, 2359296
    v_cmp_gt_u32 vcc, 16, v0
    s_nop 1
    v_cndmask_b32 v96, v100, v96, vcc
    v_cmp_gt_u32 vcc, 48, v0
    s_nop 1
    v_cndmask_b32 v104, v108, v104, vcc
    v_cmp_gt_u32 vcc, 32, v0
    s_nop 1
    v_cndmask_b32_e64 v96, v104, v96, vcc
    buffer_store_dword v96, v34, s[16:19], s48 offen sc1
csd_94:
    s_cmp_lg_u32 s7, 0
    s_cbranch_scc1 jt_97
    s_lshl_b32 s48, s2, 2
    s_add_u32 s48, s48, s6
    s_mul_i32 s49, s48, 7168
    s_add_u32 s90, s36, s49
    s_addc_u32 s91, s37, 0
    s_load_dword s94, s[90:91], 896
    s_load_dword s94, s[90:91], 960
    s_load_dword s94, s[90:91], 1024
    s_load_dword s94, s[90:91], 1088
    s_load_dword s94, s[90:91], 1152
    s_load_dword s94, s[90:91], 1216
    s_load_dword s94, s[90:91], 1280
jt_97:
    s_waitcnt vmcnt(11)
    s_barrier
    s_add_u32 m0, s66, 118784
    s_nop 0
    s_nop 0
    buffer_load_dwordx4 v4, s[8:11], s73 offen offset:0 sc1 lds
    buffer_load_dwordx4 v5, s[8:11], s73 offen offset:1024 sc1 lds
    buffer_load_dwordx4 v6, s[8:11], s73 offen offset:2048 sc1 lds
    buffer_load_dwordx4 v7, s[8:11], s73 offen offset:3072 sc1 lds
    s_add_u32 m0, s67, 57344
    s_nop 0
    s_nop 0
    buffer_load_dwordx4 v48, s[12:15], s74 offen offset:0 lds
    buffer_load_dwordx4 v49, s[12:15], s74 offen offset:1024 lds
    s_add_u32 m0, s67, 65536
    s_nop 0
    s_nop 0
    buffer_load_dwordx4 v50, s[12:15], s74 offen offset:0 lds
    buffer_load_dwordx4 v51, s[12:15], s74 offen offset:1024 lds
    s_add_u32 m0, s67, 73728
    s_nop 0
    s_nop 0
    buffer_load_dwordx4 v52, s[12:15], s74 offen offset:0 lds
    buffer_load_dwordx4 v53, s[12:15], s74 offen offset:1024 lds
    s_add_u32 m0, s68, 81920
    s_nop 0
    s_nop 0
    buffer_load_dwordx4 v54, s[12:15], s74 offen offset:0 lds
    s_bfe_u32 s48, s99, 0x4001c
    s_lshl_b32 s48, s48, 6
    s_add_u32 s48, s48, s88
    s_mul_i32 s48, s48, 7168
    s_add_u32 s48, s48, s89
    s_add_u32 s90, s32, s48
    s_addc_u32 s91, s33, 0
    s_nop 0
    s_load_dword s94, s[90:91], 6528
    s_and_b32 s49, s4, 8
    s_nop 0
    s_mul_i32 s49, s49, 384
    s_add_u32 s48, s48, s49
    s_add_u32 s92, s32, s48
    s_addc_u32 s93, s33, 0
    s_nop 0
    s_load_dword s94, s[92:93], 384
    s_load_dword s94, s[92:93], 1408
    s_load_dword s94, s[92:93], 2432
    s_bfe_u32 s69, s100, 0x40018
    s_lshl_b32 s64, s69, 15
    s_lshl_b32 s69, s69, 6
    s_mul_i32 s65, s69, 7168
    s_bfe_u32 s48, s100, 0x40008
    s_add_u32 s48, s48, s47
    s_cmp_lg_u32 s48, s61
    s_cbranch_scc1 csd_98
    s_nop 0
    v_mov_b32 v112, 0x3f803f80
    v_mov_b32 v113, 0x3f803f80
    v_mov_b32 v114, 0x3f803f80
    v_mov_b32 v115, 0x3f803f80
    s_nop 1
    s_nop 0
    v_mfma_f32_16x16x32_bf16 v[96:99], v[112:115], v[64:67], 0
    v_mfma_f32_16x16x32_bf16 v[96:99], v[112:115], v[68:71], v[96:99]
    v_mfma_f32_16x16x32_bf16 v[100:103], v[112:115], v[72:75], 0
    v_mfma_f32_16x16x32_bf16 v[100:103], v[112:115], v[76:79], v[100:103]
    v_mfma_f32_16x16x32_bf16 v[104:107], v[112:115], v[80:83], 0
    v_mfma_f32_16x16x32_bf16 v[104:107], v[112:115], v[84:87], v[104:107]
    v_mfma_f32_16x16x32_bf16 v[108:111], v[112:115], v[88:91], 0
    v_mfma_f32_16x16x32_bf16 v[108:111], v[112:115], v[92:95], v[108:111]
    s_lshl_b32 s48, s4, 14
    s_lshl_b32 s49, s3, 10
    s_add_u32 s48, s48, s49
    s_nop 0
    s_add_u32 s48, s48, 2359296
    v_cmp_gt_u32 vcc, 16, v0
    s_nop 1
    v_cndmask_b32 v96, v100, v96, vcc
    v_cmp_gt_u32 vcc, 48, v0
    s_nop 1
    v_cndmask_b32 v104, v108, v104, vcc
    v_cmp_gt_u32 vcc, 32, v0
    s_nop 1
    v_cndmask_b32_e64 v96, v104, v96, vcc
    buffer_store_dword v96, v34, s[16:19], s48 offen sc1
csd_98:
    s_cmp_lg_u32 s7, 0
    s_cbranch_scc1 jt_101
    s_lshl_b32 s48, s2, 2
    s_add_u32 s48, s48, s6
    s_mul_i32 s49, s48, 7168
    s_add_u32 s90, s36, s49
    s_addc_u32 s91, s37, 0
    s_load_dword s94, s[90:91], 1344
    s_load_dword s94, s[90:91], 1408
    s_load_dword s94, s[90:91], 1472
    s_load_dword s94, s[90:91], 1536
    s_load_dword s94, s[90:91], 1600
    s_load_dword s94, s[90:91], 1664
    s_load_dword s94, s[90:91], 1728
jt_101:
    s_waitcnt vmcnt(11)
    s_barrier
    s_add_u32 m0, s66, 86016
    s_nop 0
    s_nop 0
    buffer_load_dwordx4 v4, s[8:11], s64 offen offset:0 sc1 lds
    buffer_load_dwordx4 v5, s[8:11], s64 offen offset:1024 sc1 lds
    buffer_load_dwordx4 v6, s[8:11], s64 offen offset:2048 sc1 lds
    buffer_load_dwordx4 v7, s[8:11], s64 offen offset:3072 sc1 lds
    s_add_u32 m0, s67, 0
    s_nop 0
    buffer_load_dwordx4 v48, s[12:15], s65 offen offset:0 lds
    buffer_load_dwordx4 v49, s[12:15], s65 offen offset:1024 lds
    s_add_u32 m0, s67, 8192
    s_nop 0
    s_nop 0
    buffer_load_dwordx4 v50, s[12:15], s65 offen offset:0 lds
    buffer_load_dwordx4 v51, s[12:15], s65 offen offset:1024 lds
    s_add_u32 m0, s67, 16384
    s_nop 0
    s_nop 0
    buffer_load_dwordx4 v52, s[12:15], s65 offen offset:0 lds
    buffer_load_dwordx4 v53, s[12:15], s65 offen offset:1024 lds
    s_add_u32 m0, s68, 24576
    s_nop 0
    s_nop 0
    buffer_load_dwordx4 v54, s[12:15], s65 offen offset:0 lds
    s_bfe_u32 s48, s101, 0x40000
    s_lshl_b32 s48, s48, 6
    s_add_u32 s48, s48, s88
    s_mul_i32 s48, s48, 7168
    s_add_u32 s48, s48, s89
    s_add_u32 s90, s32, s48
    s_addc_u32 s91, s33, 0
    s_nop 0
    s_load_dword s94, s[90:91], 6528
    s_and_b32 s49, s4, 8
    s_nop 0
    s_mul_i32 s49, s49, 384
    s_add_u32 s48, s48, s49
    s_add_u32 s92, s32, s48
    s_addc_u32 s93, s33, 0
    s_nop 0
    s_load_dword s94, s[92:93], 384
    s_load_dword s94, s[92:93], 1408
    s_load_dword s94, s[92:93], 2432
    s_bfe_u32 s69, s100, 0x4001c
    s_lshl_b32 s73, s69, 15
    s_lshl_b32 s69, s69, 6
    s_mul_i32 s74, s69, 7168
    s_cmp_lg_u32 s7, 0
    s_cbranch_scc1 jt_102
    s_lshl_b32 s48, s2, 2
    s_add_u32 s48, s48, s6
    s_mul_i32 s49, s48, 7168
    s_add_u32 s90, s36, s49
    s_addc_u32 s91, s37, 0
    s_load_dword s94, s[90:91], 1792
    s_load_dword s94, s[90:91], 1856
    s_load_dword s94, s[90:91], 1920
    s_load_dword s94, s[90:91], 1984
    s_load_dword s94, s[90:91], 2048
    s_load_dword s94, s[90:91], 2112
    s_load_dword s94, s[90:91], 2176
jt_102:
    s_waitcnt vmcnt(11)
    s_barrier
    buffer_load_dword v38, v37, s[16:19], 0 offen sc1
    s_add_u32 m0, s66, 102400
    s_nop 0
    s_nop 0
    buffer_load_dwordx4 v4, s[8:11], s73 offen offset:0 sc1 lds
    buffer_load_dwordx4 v5, s[8:11], s73 offen offset:1024 sc1 lds
    buffer_load_dwordx4 v6, s[8:11], s73 offen offset:2048 sc1 lds
    buffer_load_dwordx4 v7, s[8:11], s73 offen offset:3072 sc1 lds
    s_add_u32 m0, s67, 28672
    s_nop 0
    s_nop 0
    buffer_load_dwordx4 v48, s[12:15], s74 offen offset:0 lds
    buffer_load_dwordx4 v49, s[12:15], s74 offen offset:1024 lds
    s_add_u32 m0, s67, 36864
    s_nop 0
    s_nop 0
    buffer_load_dwordx4 v50, s[12:15], s74 offen offset:0 lds
    buffer_load_dwordx4 v51, s[12:15], s74 offen offset:1024 lds
    s_add_u32 m0, s67, 45056
    s_nop 0
    s_nop 0
    buffer_load_dwordx4 v52, s[12:15], s74 offen offset:0 lds
    buffer_load_dwordx4 v53, s[12:15], s74 offen offset:1024 lds
    s_add_u32 m0, s68, 53248
    s_nop 0
    s_nop 0
    buffer_load_dwordx4 v54, s[12:15], s74 offen offset:0 lds
    s_bfe_u32 s48, s101, 0x40004
    s_lshl_b32 s48, s48, 6
    s_add_u32 s48, s48, s88
    s_mul_i32 s48, s48, 7168
    s_add_u32 s48, s48, s89
    s_add_u32 s90, s32, s48
    s_addc_u32 s91, s33, 0
    s_nop 0
    s_load_dword s94, s[90:91], 6528
    s_and_b32 s49, s4, 8
    s_nop 0
    s_mul_i32 s49, s49, 384
    s_add_u32 s48, s48, s49
    s_add_u32 s92, s32, s48
    s_addc_u32 s93, s33, 0
    s_nop 0
    s_load_dword s94, s[92:93], 384
    s_load_dword s94, s[92:93], 1408
    s_load_dword s94, s[92:93], 2432
    s_bfe_u32 s69, s101, 0x40000
    s_lshl_b32 s64, s69, 15
    s_lshl_b32 s69, s69, 6
    s_mul_i32 s65, s69, 7168
    s_cmp_lg_u32 s7, 0
    s_cbranch_scc1 jt_103
    s_lshl_b32 s48, s2, 2
    s_add_u32 s48, s48, s6
    s_mul_i32 s49, s48, 7168
    s_add_u32 s90, s36, s49
    s_addc_u32 s91, s37, 0
    s_load_dword s94, s[90:91], 2240
    s_load_dword s94, s[90:91], 2304
    s_load_dword s94, s[90:91], 2368
    s_load_dword s94, s[90:91], 2432
    s_load_dword s94, s[90:91], 2496
    s_load_dword s94, s[90:91], 2560
    s_load_dword s94, s[90:91], 2624
jt_103:
    s_waitcnt vmcnt(11)
    s_barrier
    s_add_u32 s84, s47, 3
    s_cmp_lt_u32 s4, 8
    s_cselect_b32 s76, 0, -1
    s_cselect_b32 s77, -1, 0
    v_cmp_le_u32 vcc, s84, v38
    s_nop 0
    s_andn2_b64 s[78:79], s[76:77], vcc
    s_cbranch_scc1 fcc_105
fc_104:
    s_add_u32 m0, s66, 118784
    s_nop 0
    s_nop 0
    buffer_load_dwordx4 v4, s[8:11], s64 offen offset:0 sc1 lds
    buffer_load_dwordx4 v5, s[8:11], s64 offen offset:1024 sc1 lds
    buffer_load_dwordx4 v6, s[8:11], s64 offen offset:2048 sc1 lds
    buffer_load_dwordx4 v7, s[8:11], s64 offen offset:3072 sc1 lds
    s_add_u32 m0, s67, 57344
    s_nop 0
    s_nop 0
    buffer_load_dwordx4 v48, s[12:15], s65 offen offset:0 lds
    buffer_load_dwordx4 v49, s[12:15], s65 offen offset:1024 lds
    s_add_u32 m0, s67, 65536
    s_nop 0
    s_nop 0
    buffer_load_dwordx4 v50, s[12:15], s65 offen offset:0 lds
    buffer_load_dwordx4 v51, s[12:15], s65 offen offset:1024 lds
    s_add_u32 m0, s67, 73728
    s_nop 0
    s_nop 0
    buffer_load_dwordx4 v52, s[12:15], s65 offen offset:0 lds
    buffer_load_dwordx4 v53, s[12:15], s65 offen offset:1024 lds
    s_add_u32 m0, s68, 81920
    s_nop 0
    s_nop 0
    buffer_load_dwordx4 v54, s[12:15], s65 offen offset:0 lds
    s_bfe_u32 s48, s101, 0x40008
    s_lshl_b32 s48, s48, 6
    s_add_u32 s48, s48, s88
    s_mul_i32 s48, s48, 7168
    s_add_u32 s48, s48, s89
    s_add_u32 s90, s32, s48
    s_addc_u32 s91, s33, 0
    s_nop 0
    s_load_dword s94, s[90:91], 6528
    s_and_b32 s49, s4, 8
    s_nop 0
    s_mul_i32 s49, s49, 384
    s_add_u32 s48, s48, s49
    s_add_u32 s92, s32, s48
    s_addc_u32 s93, s33, 0
    s_nop 0
    s_load_dword s94, s[92:93], 384
    s_load_dword s94, s[92:93], 1408
    s_load_dword s94, s[92:93], 2432
    s_bfe_u32 s69, s101, 0x40004
    s_lshl_b32 s73, s69, 15
    s_lshl_b32 s69, s69, 6
    s_mul_i32 s74, s69, 7168
    s_cmp_lg_u32 s7, 0
    s_cbranch_scc1 jt_109
    s_lshl_b32 s48, s2, 2
    s_add_u32 s48, s48, s6
    s_mul_i32 s49, s48, 7168
    s_add_u32 s90, s36, s49
    s_addc_u32 s91, s37, 0
    s_load_dword s94, s[90:91], 2688
    s_load_dword s94, s[90:91], 2752
    s_load_dword s94, s[90:91], 2816
    s_load_dword s94, s[90:91], 2880
    s_load_dword s94, s[90:91], 2944
    s_load_dword s94, s[90:91], 3008
    s_load_dword s94, s[90:91], 3072
jt_109:
    s_waitcnt vmcnt(11)
    s_barrier
    s_add_u32 m0, s66, 86016
    s_nop 0
    s_nop 0
    buffer_load_dwordx4 v4, s[8:11], s73 offen offset:0 sc1 lds
    buffer_load_dwordx4 v5, s[8:11], s73 offen offset:1024 sc1 lds
    buffer_load_dwordx4 v6, s[8:11], s73 offen offset:2048 sc1 lds
    buffer_load_dwordx4 v7, s[8:11], s73 offen offset:3072 sc1 lds
    s_add_u32 m0, s67, 0
    s_nop 0
    buffer_load_dwordx4 v48, s[12:15], s74 offen offset:0 lds
    buffer_load_dwordx4 v49, s[12:15], s74 offen offset:1024 lds
    s_add_u32 m0, s67, 8192
    s_nop 0
    s_nop 0
    buffer_load_dwordx4 v50, s[12:15], s74 offen offset:0 lds
    buffer_load_dwordx4 v51, s[12:15], s74 offen offset:1024 lds
    s_add_u32 m0, s67, 16384
    s_nop 0
    s_nop 0
    buffer_load_dwordx4 v52, s[12:15], s74 offen offset:0 lds
    buffer_load_dwordx4 v53, s[12:15], s74 offen offset:1024 lds
    s_add_u32 m0, s68, 24576
    s_nop 0
    s_nop 0
    buffer_load_dwordx4 v54, s[12:15], s74 offen offset:0 lds
    s_bfe_u32 s48, s101, 0x4000c
    s_lshl_b32 s48, s48, 6
    s_add_u32 s48, s48, s88
    s_mul_i32 s48, s48, 7168
    s_add_u32 s48, s48, s89
    s_add_u32 s90, s32, s48
    s_addc_u32 s91, s33, 0
    s_nop 0
    s_load_dword s94, s[90:91], 6528
    s_and_b32 s49, s4, 8
    s_nop 0
    s_mul_i32 s49, s49, 384
    s_add_u32 s48, s48, s49
    s_add_u32 s92, s32, s48
    s_addc_u32 s93, s33, 0
    s_nop 0
    s_load_dword s94, s[92:93], 384
    s_load_dword s94, s[92:93], 1408
    s_load_dword s94, s[92:93], 2432
    s_bfe_u32 s69, s101, 0x40008
    s_lshl_b32 s64, s69, 15
    s_lshl_b32 s69, s69, 6
    s_mul_i32 s65, s69, 7168
    s_cmp_lg_u32 s7, 0
    s_cbranch_scc1 jt_110
    s_lshl_b32 s48, s2, 2
    s_add_u32 s48, s48, s6
    s_mul_i32 s49, s48, 7168
    s_add_u32 s90, s36, s49
    s_addc_u32 s91, s37, 0
    s_load_dword s94, s[90:91], 3136
    s_load_dword s94, s[90:91], 3200
    s_load_dword s94, s[90:91], 3264
    s_load_dword s94, s[90:91], 3328
    s_load_dword s94, s[90:91], 3392
    s_load_dword s94, s[90:91], 3456
    s_load_dword s94, s[90:91], 3520
jt_110:
    s_waitcnt vmcnt(11)
    s_barrier
    s_bfe_u32 s48, s101, 0x40000
    s_add_u32 s48, s48, s47
    s_cmp_lg_u32 s48, s61
    s_cbranch_scc1 csd_111
    s_cmp_eq_u32 s6, 3
    s_cbranch_scc1 csh_112
    s_lshl_b32 s48, s6, 13
    s_add_u32 s48, s48, 57344
    v_add_u32 v16, s48, v29
    v_xor_b32 v17, 0, v16
    ds_read_b64_tr_b16 v[64:65], v17 offset:0
    ds_read_b64_tr_b16 v[66:67], v17 offset:512
    ds_read_b64_tr_b16 v[68:69], v17 offset:4096
    ds_read_b64_tr_b16 v[70:71], v17 offset:4608
    v_xor_b32_e64 v17, 32, v16
    ds_read_b64_tr_b16 v[72:73], v17 offset:0
    ds_read_b64_tr_b16 v[74:75], v17 offset:512
    ds_read_b64_tr_b16 v[76:77], v17 offset:4096
    ds_read_b64_tr_b16 v[78:79], v17 offset:4608
    v_xor_b32_e64 v17, 64, v16
    ds_read_b64_tr_b16 v[80:81], v17 offset:0
    ds_read_b64_tr_b16 v[82:83], v17 offset:512
    ds_read_b64_tr_b16 v[84:85], v17 offset:4096
    ds_read_b64_tr_b16 v[86:87], v17 offset:4608
    v_xor_b32 v17, 96, v16
    ds_read_b64_tr_b16 v[88:89], v17 offset:0
    ds_read_b64_tr_b16 v[90:91], v17 offset:512
    ds_read_b64_tr_b16 v[92:93], v17 offset:4096
    ds_read_b64_tr_b16 v[94:95], v17 offset:4608
    s_branch csd_111
csh_112:
    s_nop 0
    v_add_u32 v16, 81920, v30
    v_xor_b32_e64 v17, 0, v16
    ds_read_b64_tr_b16 v[64:65], v17 offset:0
    ds_read_b64_tr_b16 v[66:67], v17 offset:256
    ds_read_b64_tr_b16 v[68:69], v17 offset:2048
    ds_read_b64_tr_b16 v[70:71], v17 offset:2304
    v_xor_b32_e64 v17, 32, v16
    ds_read_b64_tr_b16 v[72:73], v17 offset:0
    ds_read_b64_tr_b16 v[74:75], v17 offset:256
    ds_read_b64_tr_b16 v[76:77], v17 offset:2048
    ds_read_b64_tr_b16 v[78:79], v17 offset:2304
    v_mov_b64 v[80:81], 0
    v_mov_b64 v[82:83], 0
    v_mov_b64 v[84:85], 0
    v_mov_b64 v[86:87], 0
    v_mov_b64 v[88:89], 0
    v_mov_b64 v[90:91], 0
    v_mov_b64 v[92:93], 0
    v_mov_b64 v[94:95], 0
csd_111:
    s_add_u32 m0, s66, 102400
    s_nop 0
    s_nop 0
    buffer_load_dwordx4 v4, s[8:11], s64 offen offset:0 sc1 lds
    buffer_load_dwordx4 v5, s[8:11], s64 offen offset:1024 sc1 lds
    buffer_load_dwordx4 v6, s[8:11], s64 offen offset:2048 sc1 lds
    buffer_load_dwordx4 v7, s[8:11], s64 offen offset:3072 sc1 lds
    s_add_u32 m0, s67, 28672
    s_nop 0
    s_nop 0
    buffer_load_dwordx4 v48, s[12:15], s65 offen offset:0 lds
    buffer_load_dwordx4 v49, s[12:15], s65 offen offset:1024 lds
    s_add_u32 m0, s67, 36864
    s_nop 0
    s_nop 0
    buffer_load_dwordx4 v50, s[12:15], s65 offen offset:0 lds
    buffer_load_dwordx4 v51, s[12:15], s65 offen offset:1024 lds
    s_add_u32 m0, s67, 45056
    s_nop 0
    s_nop 0
    buffer_load_dwordx4 v52, s[12:15], s65 offen offset:0 lds
    buffer_load_dwordx4 v53, s[12:15], s65 offen offset:1024 lds
    s_add_u32 m0, s68, 53248
    s_nop 0
    s_nop 0
    buffer_load_dwordx4 v54, s[12:15], s65 offen offset:0 lds
    s_bfe_u32 s48, s101, 0x40000
    s_add_u32 s48, s48, s47
    s_cmp_lg_u32 s48, s61
    s_cbranch_scc1 csd_114
    s_waitcnt lgkmcnt(0)
csd_114:
    s_bfe_u32 s48, s101, 0x40010
    s_lshl_b32 s48, s48, 6
    s_add_u32 s48, s48, s88
    s_mul_i32 s48, s48, 7168
    s_add_u32 s48, s48, s89
    s_add_u32 s90, s32, s48
    s_addc_u32 s91, s33, 0
    s_nop 0
    s_load_dword s94, s[90:91], 6528
    s_and_b32 s49, s4, 8
    s_nop 0
    s_mul_i32 s49, s49, 384
    s_add_u32 s48, s48, s49
    s_add_u32 s92, s32, s48
    s_addc_u32 s93, s33, 0
    s_nop 0
    s_load_dword s94, s[92:93], 384
    s_load_dword s94, s[92:93], 1408
    s_load_dword s94, s[92:93], 2432
    s_bfe_u32 s69, s101, 0x4000c
    s_lshl_b32 s73, s69, 15
    s_lshl_b32 s69, s69, 6
    s_mul_i32 s74, s69, 7168
    s_cmp_lg_u32 s7, 0
    s_cbranch_scc1 jt_117
    s_lshl_b32 s48, s2, 2
    s_add_u32 s48, s48, s6
    s_mul_i32 s49, s48, 7168
    s_add_u32 s90, s36, s49
    s_addc_u32 s91, s37, 0
    s_load_dword s94, s[90:91], 3584
    s_load_dword s94, s[90:91], 3648
    s_load_dword s94, s[90:91], 3712
    s_load_dword s94, s[90:91], 3776
    s_load_dword s94, s[90:91], 3840
    s_load_dword s94, s[90:91], 3904
    s_load_dword s94, s[90:91], 3968
jt_117:
    s_waitcnt vmcnt(11)
    s_barrier
    s_bfe_u32 s48, s101, 0x40004
    s_add_u32 s48, s48, s47
    s_cmp_lg_u32 s48, s61
    s_cbranch_scc1 csd_118
    s_cmp_eq_u32 s6, 3
    s_cbranch_scc1 csh_119
    s_lshl_b32 s48, s6, 13
    s_add_u32 s48, s48, 0
    v_add_u32 v16, s48, v29
    v_xor_b32_e64 v17, 0, v16
    ds_read_b64_tr_b16 v[64:65], v17 offset:0
    ds_read_b64_tr_b16 v[66:67], v17 offset:512
    ds_read_b64_tr_b16 v[68:69], v17 offset:4096
    ds_read_b64_tr_b16 v[70:71], v17 offset:4608
    v_xor_b32_e64 v17, 32, v16
    ds_read_b64_tr_b16 v[72:73], v17 offset:0
    ds_read_b64_tr_b16 v[74:75], v17 offset:512
    ds_read_b64_tr_b16 v[76:77], v17 offset:4096
    ds_read_b64_tr_b16 v[78:79], v17 offset:4608
    v_xor_b32_e64 v17, 64, v16
    ds_read_b64_tr_b16 v[80:81], v17 offset:0
    ds_read_b64_tr_b16 v[82:83], v17 offset:512
    ds_read_b64_tr_b16 v[84:85], v17 offset:4096
    ds_read_b64_tr_b16 v[86:87], v17 offset:4608
    v_xor_b32 v17, 96, v16
    ds_read_b64_tr_b16 v[88:89], v17 offset:0
    ds_read_b64_tr_b16 v[90:91], v17 offset:512
    ds_read_b64_tr_b16 v[92:93], v17 offset:4096
    ds_read_b64_tr_b16 v[94:95], v17 offset:4608
    s_branch csd_118
csh_119:
    s_nop 0
    v_add_u32 v16, 24576, v30
    v_xor_b32_e64 v17, 0, v16
    ds_read_b64_tr_b16 v[64:65], v17 offset:0
    ds_read_b64_tr_b16 v[66:67], v17 offset:256
    ds_read_b64_tr_b16 v[68:69], v17 offset:2048
    ds_read_b64_tr_b16 v[70:71], v17 offset:2304
    v_xor_b32_e64 v17, 32, v16
    ds_read_b64_tr_b16 v[72:73], v17 offset:0
    ds_read_b64_tr_b16 v[74:75], v17 offset:256
    ds_read_b64_tr_b16 v[76:77], v17 offset:2048
    ds_read_b64_tr_b16 v[78:79], v17 offset:2304
    v_mov_b64 v[80:81], 0
    v_mov_b64 v[82:83], 0
    v_mov_b64 v[84:85], 0
    v_mov_b64 v[86:87], 0
    v_mov_b64 v[88:89], 0
    v_mov_b64 v[90:91], 0
    v_mov_b64 v[92:93], 0
    v_mov_b64 v[94:95], 0
csd_118:
    s_add_u32 m0, s66, 118784
    s_nop 0
    s_nop 0
    buffer_load_dwordx4 v4, s[8:11], s73 offen offset:0 sc1 lds
    buffer_load_dwordx4 v5, s[8:11], s73 offen offset:1024 sc1 lds
    buffer_load_dwordx4 v6, s[8:11], s73 offen offset:2048 sc1 lds
    buffer_load_dwordx4 v7, s[8:11], s73 offen offset:3072 sc1 lds
    s_add_u32 m0, s67, 57344
    s_nop 0
    s_nop 0
    buffer_load_dwordx4 v48, s[12:15], s74 offen offset:0 lds
    buffer_load_dwordx4 v49, s[12:15], s74 offen offset:1024 lds
    s_add_u32 m0, s67, 65536
    s_nop 0
    s_nop 0
    buffer_load_dwordx4 v50, s[12:15], s74 offen offset:0 lds
    buffer_load_dwordx4 v51, s[12:15], s74 offen offset:1024 lds
    s_add_u32 m0, s67, 73728
    s_nop 0
    s_nop 0
    buffer_load_dwordx4 v52, s[12:15], s74 offen offset:0 lds
    buffer_load_dwordx4 v53, s[12:15], s74 offen offset:1024 lds
    s_add_u32 m0, s68, 81920
    s_nop 0
    s_nop 0
    buffer_load_dwordx4 v54, s[12:15], s74 offen offset:0 lds
    s_bfe_u32 s48, s101, 0x40004
    s_add_u32 s48, s48, s47
    s_cmp_lg_u32 s48, s61
    s_cbranch_scc1 csd_121
    s_waitcnt lgkmcnt(0)
csd_121:
    s_bfe_u32 s48, s101, 0x40014
    s_lshl_b32 s48, s48, 6
    s_add_u32 s48, s48, s88
    s_mul_i32 s48, s48, 7168
    s_add_u32 s48, s48, s89
    s_add_u32 s90, s32, s48
    s_addc_u32 s91, s33, 0
    s_nop 0
    s_load_dword s94, s[90:91], 6528
    s_and_b32 s49, s4, 8
    s_nop 0
    s_mul_i32 s49, s49, 384
    s_add_u32 s48, s48, s49
    s_add_u32 s92, s32, s48
    s_addc_u32 s93, s33, 0
    s_nop 0
    s_load_dword s94, s[92:93], 384
    s_load_dword s94, s[92:93], 1408
    s_load_dword s94, s[92:93], 2432
    s_bfe_u32 s69, s101, 0x40010
    s_lshl_b32 s64, s69, 15
    s_lshl_b32 s69, s69, 6
    s_mul_i32 s65, s69, 7168
    s_bfe_u32 s48, s101, 0x40000
    s_add_u32 s48, s48, s47
    s_cmp_lg_u32 s48, s61
    s_cbranch_scc1 csd_124
    s_nop 0
    v_mov_b32 v112, 0x3f803f80
    v_mov_b32 v113, 0x3f803f80
    v_mov_b32 v114, 0x3f803f80
    v_mov_b32 v115, 0x3f803f80
    s_nop 1
    s_nop 0
    v_mfma_f32_16x16x32_bf16 v[96:99], v[112:115], v[64:67], 0
    v_mfma_f32_16x16x32_bf16 v[96:99], v[112:115], v[68:71], v[96:99]
    v_mfma_f32_16x16x32_bf16 v[100:103], v[112:115], v[72:75], 0
    v_mfma_f32_16x16x32_bf16 v[100:103], v[112:115], v[76:79], v[100:103]
    v_mfma_f32_16x16x32_bf16 v[104:107], v[112:115], v[80:83], 0
    v_mfma_f32_16x16x32_bf16 v[104:107], v[112:115], v[84:87], v[104:107]
    v_mfma_f32_16x16x32_bf16 v[108:111], v[112:115], v[88:91], 0
    v_mfma_f32_16x16x32_bf16 v[108:111], v[112:115], v[92:95], v[108:111]
    s_lshl_b32 s48, s4, 14
    s_lshl_b32 s49, s3, 10
    s_add_u32 s48, s48, s49
    s_nop 0
    s_add_u32 s48, s48, 2359296
    v_cmp_gt_u32 vcc, 16, v0
    s_nop 1
    v_cndmask_b32 v96, v100, v96, vcc
    v_cmp_gt_u32 vcc, 48, v0
    s_nop 1
    v_cndmask_b32 v104, v108, v104, vcc
    v_cmp_gt_u32 vcc, 32, v0
    s_nop 1
    v_cndmask_b32_e64 v96, v104, v96, vcc
    buffer_store_dword v96, v34, s[16:19], s48 offen sc1
csd_124:
    s_cmp_lg_u32 s7, 0
    s_cbranch_scc1 jt_127
    s_lshl_b32 s48, s2, 2
    s_add_u32 s48, s48, s6
    s_mul_i32 s49, s48, 7168
    s_add_u32 s90, s36, s49
    s_addc_u32 s91, s37, 0
    s_load_dword s94, s[90:91], 4032
    s_load_dword s94, s[90:91], 4096
    s_load_dword s94, s[90:91], 4160
    s_load_dword s94, s[90:91], 4224
    s_load_dword s94, s[90:91], 4288
    s_load_dword s94, s[90:91], 4352
    s_load_dword s94, s[90:91], 4416
jt_127:
    s_waitcnt vmcnt(11)
    s_barrier
    s_add_u32 m0, s66, 86016
    s_nop 0
    s_nop 0
    buffer_load_dwordx4 v4, s[8:11], s64 offen offset:0 sc1 lds
    buffer_load_dwordx4 v5, s[8:11], s64 offen offset:1024 sc1 lds
    buffer_load_dwordx4 v6, s[8:11], s64 offen offset:2048 sc1 lds
    buffer_load_dwordx4 v7, s[8:11], s64 offen offset:3072 sc1 lds
    s_add_u32 m0, s67, 0
    s_nop 0
    buffer_load_dwordx4 v48, s[12:15], s65 offen offset:0 lds
    buffer_load_dwordx4 v49, s[12:15], s65 offen offset:1024 lds
    s_add_u32 m0, s67, 8192
    s_nop 0
    s_nop 0
    buffer_load_dwordx4 v50, s[12:15], s65 offen offset:0 lds
    buffer_load_dwordx4 v51, s[12:15], s65 offen offset:1024 lds
    s_add_u32 m0, s67, 16384
    s_nop 0
    s_nop 0
    buffer_load_dwordx4 v52, s[12:15], s65 offen offset:0 lds
    buffer_load_dwordx4 v53, s[12:15], s65 offen offset:1024 lds
    s_add_u32 m0, s68, 24576
    s_nop 0
    s_nop 0
    buffer_load_dwordx4 v54, s[12:15], s65 offen offset:0 lds
    s_bfe_u32 s48, s101, 0x40018
    s_lshl_b32 s48, s48, 6
    s_add_u32 s48, s48, s88
    s_mul_i32 s48, s48, 7168
    s_add_u32 s48, s48, s89
    s_add_u32 s90, s32, s48
    s_addc_u32 s91, s33, 0
    s_nop 0
    s_load_dword s94, s[90:91], 6528
    s_and_b32 s49, s4, 8
    s_nop 0
    s_mul_i32 s49, s49, 384
    s_add_u32 s48, s48, s49
    s_add_u32 s92, s32, s48
    s_addc_u32 s93, s33, 0
    s_nop 0
    s_load_dword s94, s[92:93], 384
    s_load_dword s94, s[92:93], 1408
    s_load_dword s94, s[92:93], 2432
    s_bfe_u32 s69, s101, 0x40014
    s_lshl_b32 s73, s69, 15
    s_lshl_b32 s69, s69, 6
    s_mul_i32 s74, s69, 7168
    s_bfe_u32 s48, s101, 0x40004
    s_add_u32 s48, s48, s47
    s_cmp_lg_u32 s48, s61
    s_cbranch_scc1 csd_128
    s_nop 0
    v_mov_b32 v112, 0x3f803f80
    v_mov_b32 v113, 0x3f803f80
    v_mov_b32 v114, 0x3f803f80
    v_mov_b32 v115, 0x3f803f80
    s_nop 1
    s_nop 0
    v_mfma_f32_16x16x32_bf16 v[96:99], v[112:115], v[64:67], 0
    v_mfma_f32_16x16x32_bf16 v[96:99], v[112:115], v[68:71], v[96:99]
    v_mfma_f32_16x16x32_bf16 v[100:103], v[112:115], v[72:75], 0
    v_mfma_f32_16x16x32_bf16 v[100:103], v[112:115], v[76:79], v[100:103]
    v_mfma_f32_16x16x32_bf16 v[104:107], v[112:115], v[80:83], 0
    v_mfma_f32_16x16x32_bf16 v[104:107], v[112:115], v[84:87], v[104:107]
    v_mfma_f32_16x16x32_bf16 v[108:111], v[112:115], v[88:91], 0
    v_mfma_f32_16x16x32_bf16 v[108:111], v[112:115], v[92:95], v[108:111]
    s_lshl_b32 s48, s4, 14
    s_lshl_b32 s49, s3, 10
    s_add_u32 s48, s48, s49
    s_nop 0
    s_add_u32 s48, s48, 2359296
    v_cmp_gt_u32 vcc, 16, v0
    s_nop 1
    v_cndmask_b32 v96, v100, v96, vcc
    v_cmp_gt_u32 vcc, 48, v0
    s_nop 1
    v_cndmask_b32 v104, v108, v104, vcc
    v_cmp_gt_u32 vcc, 32, v0
    s_nop 1
    v_cndmask_b32_e64 v96, v104, v96, vcc
    buffer_store_dword v96, v34, s[16:19], s48 offen sc1
csd_128:
    s_cmp_lg_u32 s7, 0
    s_cbranch_scc1 jt_131
    s_lshl_b32 s48, s2, 2
    s_add_u32 s48, s48, s6
    s_mul_i32 s49, s48, 7168
    s_add_u32 s90, s36, s49
    s_addc_u32 s91, s37, 0
    s_load_dword s94, s[90:91], 4480
    s_load_dword s94, s[90:91], 4544
    s_load_dword s94, s[90:91], 4608
    s_load_dword s94, s[90:91], 4672
    s_load_dword s94, s[90:91], 4736
    s_load_dword s94, s[90:91], 4800
    s_load_dword s94, s[90:91], 4864
jt_131:
    s_waitcnt vmcnt(11)
    s_barrier
    s_add_u32 m0, s66, 102400
    s_nop 0
    s_nop 0
    buffer_load_dwordx4 v4, s[8:11], s73 offen offset:0 sc1 lds
    buffer_load_dwordx4 v5, s[8:11], s73 offen offset:1024 sc1 lds
    buffer_load_dwordx4 v6, s[8:11], s73 offen offset:2048 sc1 lds
    buffer_load_dwordx4 v7, s[8:11], s73 offen offset:3072 sc1 lds
    s_add_u32 m0, s67, 28672
    s_nop 0
    s_nop 0
    buffer_load_dwordx4 v48, s[12:15], s74 offen offset:0 lds
    buffer_load_dwordx4 v49, s[12:15], s74 offen offset:1024 lds
    s_add_u32 m0, s67, 36864
    s_nop 0
    s_nop 0
    buffer_load_dwordx4 v50, s[12:15], s74 offen offset:0 lds
    buffer_load_dwordx4 v51, s[12:15], s74 offen offset:1024 lds
    s_add_u32 m0, s67, 45056
    s_nop 0
    s_nop 0
    buffer_load_dwordx4 v52, s[12:15], s74 offen offset:0 lds
    buffer_load_dwordx4 v53, s[12:15], s74 offen offset:1024 lds
    s_add_u32 m0, s68, 53248
    s_nop 0
    s_nop 0
    buffer_load_dwordx4 v54, s[12:15], s74 offen offset:0 lds
    s_bfe_u32 s48, s101, 0x4001c
    s_lshl_b32 s48, s48, 6
    s_add_u32 s48, s48, s88
    s_mul_i32 s48, s48, 7168
    s_add_u32 s48, s48, s89
    s_add_u32 s90, s32, s48
    s_addc_u32 s91, s33, 0
    s_nop 0
    s_load_dword s94, s[90:91], 6528
    s_and_b32 s49, s4, 8
    s_nop 0
    s_mul_i32 s49, s49, 384
    s_add_u32 s48, s48, s49
    s_add_u32 s92, s32, s48
    s_addc_u32 s93, s33, 0
    s_nop 0
    s_load_dword s94, s[92:93], 384
    s_load_dword s94, s[92:93], 1408
    s_load_dword s94, s[92:93], 2432
    s_bfe_u32 s69, s101, 0x40018
    s_lshl_b32 s64, s69, 15
    s_lshl_b32 s69, s69, 6
    s_mul_i32 s65, s69, 7168
    s_cmp_lg_u32 s7, 0
    s_cbranch_scc1 jt_132
    s_lshl_b32 s48, s2, 2
    s_add_u32 s48, s48, s6
    s_mul_i32 s49, s48, 7168
    s_add_u32 s90, s36, s49
    s_addc_u32 s91, s37, 0
    s_load_dword s94, s[90:91], 4928
    s_load_dword s94, s[90:91], 4992
    s_load_dword s94, s[90:91], 5056
    s_load_dword s94, s[90:91], 5120
    s_load_dword s94, s[90:91], 5184
    s_load_dword s94, s[90:91], 5248
    s_load_dword s94, s[90:91], 5312
jt_132:
    s_waitcnt vmcnt(11)
    s_barrier
    s_add_u32 m0, s66, 118784
    s_nop 0
    s_nop 0
    buffer_load_dwordx4 v4, s[8:11], s64 offen offset:0 sc1 lds
    buffer_load_dwordx4 v5, s[8:11], s64 offen offset:1024 sc1 lds
    buffer_load_dwordx4 v6, s[8:11], s64 offen offset:2048 sc1 lds
    buffer_load_dwordx4 v7, s[8:11], s64 offen offset:3072 sc1 lds
    s_add_u32 m0, s67, 57344
    s_nop 0
    s_nop 0
    buffer_load_dwordx4 v48, s[12:15], s65 offen offset:0 lds
    buffer_load_dwordx4 v49, s[12:15], s65 offen offset:1024 lds
    s_add_u32 m0, s67, 65536
    s_nop 0
    s_nop 0
    buffer_load_dwordx4 v50, s[12:15], s65 offen offset:0 lds
    buffer_load_dwordx4 v51, s[12:15], s65 offen offset:1024 lds
    s_add_u32 m0, s67, 73728
    s_nop 0
    s_nop 0
    buffer_load_dwordx4 v52, s[12:15], s65 offen offset:0 lds
    buffer_load_dwordx4 v53, s[12:15], s65 offen offset:1024 lds
    s_add_u32 m0, s68, 81920
    s_nop 0
    s_nop 0
    buffer_load_dwordx4 v54, s[12:15], s65 offen offset:0 lds
    s_bfe_u32 s69, s101, 0x4001c
    s_lshl_b32 s73, s69, 15
    s_lshl_b32 s69, s69, 6
    s_mul_i32 s74, s69, 7168
    s_cmp_lg_u32 s7, 0
    s_cbranch_scc1 jt_133
    s_lshl_b32 s48, s2, 2
    s_add_u32 s48, s48, s6
    s_mul_i32 s49, s48, 7168
    s_add_u32 s90, s36, s49
    s_addc_u32 s91, s37, 0
    s_load_dword s94, s[90:91], 5376
    s_load_dword s94, s[90:91], 5440
    s_load_dword s94, s[90:91], 5504
    s_load_dword s94, s[90:91], 5568
    s_load_dword s94, s[90:91], 5632
    s_load_dword s94, s[90:91], 5696
    s_load_dword s94, s[90:91], 5760
jt_133:
    s_waitcnt vmcnt(11)
    s_barrier
    s_lshl_b32 s48, s7, 19
    s_lshl_b32 s49, s3, 14
    s_add_u32 s48, s48, s49
    s_nop 0
    s_add_u32 s48, s48, 1310720
    buffer_load_dwordx4 v[64:67], v35, s[16:19], s48 offen offset:0 sc1
    buffer_load_dwordx4 v[68:71], v35, s[16:19], s48 offen offset:1024 sc1
    buffer_load_dwordx4 v[72:75], v35, s[16:19], s48 offen offset:2048 sc1
    buffer_load_dwordx4 v[76:79], v35, s[16:19], s48 offen offset:3072 sc1
    s_add_u32 m0, s66, 86016
    s_nop 0
    s_nop 0
    buffer_load_dwordx4 v4, s[8:11], s73 offen offset:0 sc1 lds
    buffer_load_dwordx4 v5, s[8:11], s73 offen offset:1024 sc1 lds
    buffer_load_dwordx4 v6, s[8:11], s73 offen offset:2048 sc1 lds
    buffer_load_dwordx4 v7, s[8:11], s73 offen offset:3072 sc1 lds
    s_add_u32 m0, s67, 0
    s_nop 0
    buffer_load_dwordx4 v48, s[12:15], s74 offen offset:0 lds
    buffer_load_dwordx4 v49, s[12:15], s74 offen offset:1024 lds
    s_add_u32 m0, s67, 8192
    s_nop 0
    s_nop 0
    buffer_load_dwordx4 v50, s[12:15], s74 offen offset:0 lds
    buffer_load_dwordx4 v51, s[12:15], s74 offen offset:1024 lds
    s_add_u32 m0, s67, 16384
    s_nop 0
    s_nop 0
    buffer_load_dwordx4 v52, s[12:15], s74 offen offset:0 lds
    buffer_load_dwordx4 v53, s[12:15], s74 offen offset:1024 lds
    s_add_u32 m0, s68, 24576
    s_nop 0
    s_nop 0
    buffer_load_dwordx4 v54, s[12:15], s74 offen offset:0 lds
    s_cmp_lg_u32 s7, 0
    s_cbranch_scc1 jt_134
    s_lshl_b32 s48, s2, 2
    s_add_u32 s48, s48, s6
    s_mul_i32 s49, s48, 7168
    s_add_u32 s90, s36, s49
    s_addc_u32 s91, s37, 0
    s_load_dword s94, s[90:91], 5824
    s_load_dword s94, s[90:91], 5888
    s_load_dword s94, s[90:91], 5952
    s_load_dword s94, s[90:91], 6016
    s_load_dword s94, s[90:91], 6080
    s_load_dword s94, s[90:91], 6144
    s_load_dword s94, s[90:91], 6208
jt_134:
    s_waitcnt vmcnt(15)
    s_barrier
    s_cmp_lg_u32 s7, 0
    s_cbranch_scc1 jgc_135
    s_lshl_b32 s48, s4, 14
    s_nop 0
    s_add_u32 s48, s48, 2359296
    buffer_load_dwordx4 v[80:83], v35, s[16:19], s48 offen offset:0 sc1
    buffer_load_dwordx4 v[84:87], v35, s[16:19], s48 offen offset:1024 sc1
    buffer_load_dwordx4 v[88:91], v35, s[16:19], s48 offen offset:2048 sc1
    buffer_load_dwordx4 v[92:95], v35, s[16:19], s48 offen offset:3072 sc1
jgc_135:
    s_cmp_lg_u32 s7, 0
    s_cbranch_scc1 jw_136
    s_mov_b32 s20, s36
    s_mov_b32 s21, s37
    s_mov_b32 s22, 7340032
    s_mov_b32 s23, 0x20000
    s_lshl_b32 s48, s2, 2
    s_add_u32 s48, s48, s6
    s_mul_i32 s48, s48, 7168
    s_add_u32 s48, s48, 6272
    v_min_u32 v16, 6, v0
    v_lshlrev_b32 v16, 7, v16
    buffer_load_dword v31, v16, s[20:23], s48 offen
jw_136:
    s_waitcnt vmcnt(16)
    s_cmp_eq_u32 s7, 0
    s_cbranch_scc1 jrc_138
    s_waitcnt vmcnt(11)
jrc_138:
    v_add_f32 v64, v64, v72
    v_add_f32 v65, v65, v73
    v_add_f32 v66, v66, v74
    v_add_f32 v67, v67, v75
    v_add_f32 v68, v68, v76
    v_add_f32 v69, v69, v77
    v_add_f32 v70, v70, v78
    v_add_f32 v71, v71, v79
    v_add_f32 v64, v64, v68
    v_add_f32 v65, v65, v69
    v_add_f32 v66, v66, v70
    v_add_f32 v67, v67, v71
    s_nop 0
    v_permlane32_swap_b32 v64, v66
    v_permlane32_swap_b32 v65, v67
    v_add_f32 v64, v64, v66
    v_add_f32 v65, v65, v67
    s_nop 1
    v_permlane16_swap_b32 v64, v65
    v_add_f32 v64, v64, v65
    v_cmp_u_f32 vcc, v64, v64
    s_cbranch_vccz rtd_139
    s_sub_u32 s85, s85, 1
    s_cbranch_scc0 jrr_137
    s_mov_b32 s85, 0
rtd_139:
    s_waitcnt vmcnt(5)
    s_cmp_eq_u32 s7, 0
    s_cbranch_scc1 wc_140
    s_waitcnt vmcnt(0)
wc_140:
    s_barrier
    v_mul_f32 v64, 0x3a800000, v64
    v_and_b32 v72, 15, v0
    v_mov_b32 v65, v64
    v_lshrrev_b32_e64 v73, 5, v0
    v_lshl_add_u32 v72, v72, 1, v73
    v_permlane16_swap_b32 v64, v65
    s_lshl_b32 s48, s6, 7
    s_add_u32 s48, s48, 151552
    v_fma_f32 v68, -v64, v64, v65
    v_max_f32_e64 v68, 0, v68
    v_add_f32 v68, 0x3727c5ac, v68
    v_rsq_f32_e64 v68, v68
    v_lshl_add_u32 v73, v72, 2, s48
    v_mul_f32 v70, -v64, v68
    ds_write2_b32 v73, v68, v70 offset0:0 offset1:128
    s_cmp_lg_u32 s7, 0
    s_cbranch_scc1 jre_141
    s_waitcnt vmcnt(1)
jrc_143:
    v_add_f32 v80, v80, v88
    v_add_f32 v81, v81, v89
    v_add_f32 v82, v82, v90
    v_add_f32 v83, v83, v91
    v_add_f32 v84, v84, v92
    v_add_f32 v85, v85, v93
    v_add_f32 v86, v86, v94
    v_add_f32 v87, v87, v95
    v_add_f32 v80, v80, v84
    v_add_f32 v81, v81, v85
    v_add_f32 v82, v82, v86
    v_add_f32 v83, v83, v87
    s_nop 0
    v_permlane32_swap_b32 v80, v82
    v_permlane32_swap_b32 v81, v83
    v_add_f32 v80, v80, v82
    v_add_f32 v81, v81, v83
    s_nop 1
    v_permlane16_swap_b32 v80, v81
    v_add_f32 v80, v80, v81
    v_cmp_u_f32 vcc, v80, v80
    s_cbranch_vccz rtd_144
    s_sub_u32 s85, s85, 1
    s_cbranch_scc0 jrr_142
    s_mov_b32 s85, 0
rtd_144:
    v_and_b32 v72, 15, v0
    s_lshl_b32 s48, s6, 8
    s_add_u32 s48, s48, 153600
    v_lshl_add_u32 v73, v72, 4, s48
    v_lshrrev_b32_e64 v72, 4, v0
    v_lshl_add_u32 v73, v72, 2, v73
    ds_write_b32 v73, v80
    v_add_u32 v71, 154624, v34
    v_lshlrev_b32_e64 v56, 16, v56
    ds_write_b32 v71, v56
    v_lshlrev_b32_e64 v57, 16, v57
    v_add_u32 v71, 155648, v32
    ds_write_b32 v71, v57
jre_141:
    s_waitcnt lgkmcnt(0)
    s_barrier
    s_mov_b32 s12, s36
    s_mov_b32 s13, s37
    s_mov_b32 s14, 7340032
    s_mov_b32 s15, 0x20000
    s_add_u32 s69, s62, 1
    s_and_b32 s69, s69, 7
    s_add_u32 s69, s69, s63
    s_lshl_b32 s69, s69, 6
    s_mul_i32 s74, s69, 2048
    s_add_u32 m0, s67, 32768
    s_nop 0
    s_nop 0
    buffer_load_dwordx4 v44, s[12:15], s74 offen offset:0 lds
    buffer_load_dwordx4 v45, s[12:15], s74 offen offset:1024 lds
    s_add_u32 m0, s67, 40960
    s_nop 0
    s_nop 0
    buffer_load_dwordx4 v46, s[12:15], s74 offen offset:0 lds
    buffer_load_dwordx4 v47, s[12:15], s74 offen offset:1024 lds
    s_add_u32 s69, s62, 2
    s_and_b32 s69, s69, 7
    s_add_u32 s69, s69, s63
    s_lshl_b32 s69, s69, 6
    s_mul_i32 s65, s69, 2048
    s_add_u32 m0, s67, 65536
    s_nop 0
    s_nop 0
    buffer_load_dwordx4 v44, s[12:15], s65 offen offset:0 lds
    buffer_load_dwordx4 v45, s[12:15], s65 offen offset:1024 lds
    s_add_u32 m0, s67, 73728
    s_nop 0
    s_nop 0
    buffer_load_dwordx4 v46, s[12:15], s65 offen offset:0 lds
    buffer_load_dwordx4 v47, s[12:15], s65 offen offset:1024 lds
    s_add_u32 s69, s62, 0
    s_and_b32 s69, s69, 7
    s_add_u32 s69, s69, s63
    s_lshl_b32 s69, s69, 6
    s_mul_i32 s65, s69, 2048
    s_add_u32 m0, s67, 0
    s_nop 0
    buffer_load_dwordx4 v44, s[12:15], s65 offen offset:0 lds
    buffer_load_dwordx4 v45, s[12:15], s65 offen offset:1024 lds
    s_add_u32 m0, s67, 8192
    s_nop 0
    s_nop 0
    buffer_load_dwordx4 v46, s[12:15], s65 offen offset:0 lds
    buffer_load_dwordx4 v47, s[12:15], s65 offen offset:1024 lds
    s_add_u32 s48, s62, 3
    s_and_b32 s48, s48, 7
    s_add_u32 s48, s48, s63
    s_lshl_b32 s48, s48, 6
    s_add_u32 s48, s48, s88
    s_nop 0
    s_mul_i32 s48, s48, 2048
    s_add_u32 s48, s48, s89
    s_add_u32 s90, s36, s48
    s_addc_u32 s91, s37, 0
    s_nop 0
    s_load_dword s94, s[90:91], 384
    s_load_dword s94, s[90:91], 1408
    s_add_u32 s48, s62, 4
    s_and_b32 s48, s48, 7
    s_add_u32 s48, s48, s63
    s_lshl_b32 s48, s48, 6
    s_add_u32 s48, s48, s88
    s_nop 0
    s_mul_i32 s48, s48, 2048
    s_add_u32 s48, s48, s89
    s_add_u32 s90, s36, s48
    s_addc_u32 s91, s37, 0
    s_nop 0
    s_load_dword s94, s[90:91], 384
    s_load_dword s94, s[90:91], 1408
    s_add_u32 s48, s62, 5
    s_and_b32 s48, s48, 7
    s_add_u32 s48, s48, s63
    s_lshl_b32 s48, s48, 6
    s_add_u32 s48, s48, s88
    s_nop 0
    s_mul_i32 s48, s48, 2048
    s_add_u32 s48, s48, s89
    s_add_u32 s90, s36, s48
    s_addc_u32 s91, s37, 0
    s_nop 0
    s_load_dword s94, s[90:91], 384
    s_load_dword s94, s[90:91], 1408
    s_mul_i32 s48, s3, 1835008
    s_add_u32 s48, s48, 33554432
    s_add_u32 s8, s16, s48
    s_addc_u32 s9, s17, 0
    s_mov_b32 s10, 1835008
    s_mov_b32 s11, 0x20000
    s_lshl_b32 s82, s4, 7
    s_nop 0
    s_add_u32 s80, s82, 2048
    s_add_u32 s81, s82, 4096
    s_mov_b32 s49, 6144
    v_mul_lo_u32 v16, v25, s49
    v_add_u32 v16, v16, v27
    v_xor_b32 v17, 64, v16
    v_add_u32 v17, 23552, v17
    v_add_u32 v8, s80, v16
    v_add_u32 v9, s80, v17
    v_add_u32 v10, s81, v16
    v_add_u32 v11, s81, v17
    v_add_u32 v12, s82, v16
    v_add_u32 v13, s82, v17
    s_add_u32 s84, s47, 5
    s_cmp_ge_u32 s4, 8
    s_cselect_b32 s76, 0, -1
    s_cselect_b32 s77, -1, 0
poll_145:
    buffer_load_dword v38, v36, s[16:19], 0 offen sc1
    s_waitcnt vmcnt(0)
pollc_146:
    v_cmp_le_u32 vcc, s84, v38
    s_nop 0
    s_andn2_b64 s[78:79], s[76:77], vcc
    s_cbranch_scc0 polld_147
    s_sub_u32 s85, s85, 1
    s_cbranch_scc0 poll_145
    s_mov_b32 s85, 0
polld_147:
    s_add_u32 s69, s62, 0
    s_and_b32 s69, s69, 7
    s_add_u32 s69, s69, s63
    s_lshl_b32 s64, s69, 15
    s_add_u32 m0, s66, 16384
    s_nop 0
    s_nop 0
    buffer_load_dwordx4 v4, s[8:11], s64 offen offset:0 sc1 lds
    buffer_load_dwordx4 v5, s[8:11], s64 offen offset:1024 sc1 lds
    buffer_load_dwordx4 v6, s[8:11], s64 offen offset:2048 sc1 lds
    buffer_load_dwordx4 v7, s[8:11], s64 offen offset:3072 sc1 lds
    s_add_u32 s69, s62, 1
    s_and_b32 s69, s69, 7
    s_add_u32 s69, s69, s63
    s_lshl_b32 s73, s69, 15
    s_add_u32 m0, s66, 49152
    s_nop 0
    s_nop 0
    buffer_load_dwordx4 v4, s[8:11], s73 offen offset:0 sc1 lds
    buffer_load_dwordx4 v5, s[8:11], s73 offen offset:1024 sc1 lds
    buffer_load_dwordx4 v6, s[8:11], s73 offen offset:2048 sc1 lds
    buffer_load_dwordx4 v7, s[8:11], s73 offen offset:3072 sc1 lds
    s_add_u32 s69, s62, 2
    s_and_b32 s69, s69, 7
    s_add_u32 s69, s69, s63
    s_lshl_b32 s64, s69, 15
    s_add_u32 m0, s66, 81920
    s_nop 0
    s_nop 0
    buffer_load_dwordx4 v4, s[8:11], s64 offen offset:0 sc1 lds
    buffer_load_dwordx4 v5, s[8:11], s64 offen offset:1024 sc1 lds
    buffer_load_dwordx4 v6, s[8:11], s64 offen offset:2048 sc1 lds
    buffer_load_dwordx4 v7, s[8:11], s64 offen offset:3072 sc1 lds
    s_add_u32 s69, s62, 3
    s_and_b32 s69, s69, 7
    s_add_u32 s69, s69, s63
    s_lshl_b32 s73, s69, 15
    s_lshl_b32 s69, s69, 6
    s_nop 0
    s_mul_i32 s74, s69, 2048
    s_add_u32 m0, s66, 114688
    s_nop 0
    s_nop 0
    buffer_load_dwordx4 v4, s[8:11], s73 offen offset:0 sc1 lds
    buffer_load_dwordx4 v5, s[8:11], s73 offen offset:1024 sc1 lds
    buffer_load_dwordx4 v6, s[8:11], s73 offen offset:2048 sc1 lds
    buffer_load_dwordx4 v7, s[8:11], s73 offen offset:3072 sc1 lds
    s_add_u32 m0, s67, 98304
    s_nop 0
    s_nop 0
    buffer_load_dwordx4 v44, s[12:15], s74 offen offset:0 lds
    buffer_load_dwordx4 v45, s[12:15], s74 offen offset:1024 lds
    s_add_u32 m0, s67, 106496
    s_nop 0
    s_nop 0
    buffer_load_dwordx4 v46, s[12:15], s74 offen offset:0 lds
    buffer_load_dwordx4 v47, s[12:15], s74 offen offset:1024 lds
    s_waitcnt vmcnt(16)
    s_barrier
    s_add_u32 s48, s62, 6
    s_and_b32 s48, s48, 7
    s_add_u32 s48, s48, s63
    s_lshl_b32 s48, s48, 6
    s_add_u32 s48, s48, s88
    s_nop 0
    s_mul_i32 s48, s48, 2048
    s_add_u32 s48, s48, s89
    s_add_u32 s90, s36, s48
    s_addc_u32 s91, s37, 0
    s_nop 0
    s_load_dword s94, s[90:91], 384
    s_load_dword s94, s[90:91], 1408
    s_add_u32 s69, s62, 4
    s_and_b32 s69, s69, 7
    s_add_u32 s69, s69, s63
    s_lshl_b32 s64, s69, 15
    s_lshl_b32 s69, s69, 6
    s_nop 0
    s_mul_i32 s65, s69, 2048
    s_waitcnt vmcnt(12)
    s_barrier
    s_add_u32 m0, s66, 16384
    s_nop 0
    s_nop 0
    buffer_load_dwordx4 v4, s[8:11], s64 offen offset:0 sc1 lds
    buffer_load_dwordx4 v5, s[8:11], s64 offen offset:1024 sc1 lds
    buffer_load_dwordx4 v6, s[8:11], s64 offen offset:2048 sc1 lds
    buffer_load_dwordx4 v7, s[8:11], s64 offen offset:3072 sc1 lds
    s_add_u32 m0, s67, 0
    s_nop 0
    buffer_load_dwordx4 v44, s[12:15], s65 offen offset:0 lds
    buffer_load_dwordx4 v45, s[12:15], s65 offen offset:1024 lds
    s_add_u32 m0, s67, 8192
    s_nop 0
    s_nop 0
    buffer_load_dwordx4 v46, s[12:15], s65 offen offset:0 lds
    buffer_load_dwordx4 v47, s[12:15], s65 offen offset:1024 lds
    s_add_u32 s48, s62, 7
    s_and_b32 s48, s48, 7
    s_add_u32 s48, s48, s63
    s_lshl_b32 s48, s48, 6
    s_add_u32 s48, s48, s88
    s_nop 0
    s_mul_i32 s48, s48, 2048
    s_add_u32 s48, s48, s89
    s_add_u32 s90, s36, s48
    s_addc_u32 s91, s37, 0
    s_nop 0
    s_load_dword s94, s[90:91], 384
    s_load_dword s94, s[90:91], 1408
    s_add_u32 s69, s62, 5
    s_and_b32 s69, s69, 7
    s_add_u32 s69, s69, s63
    s_lshl_b32 s73, s69, 15
    s_lshl_b32 s69, s69, 6
    s_nop 0
    s_mul_i32 s74, s69, 2048
    s_waitcnt vmcnt(16)
    s_barrier
    buffer_load_dword v38, v36, s[16:19], 0 offen sc1
    s_add_u32 m0, s66, 49152
    s_nop 0
    s_nop 0
    buffer_load_dwordx4 v4, s[8:11], s73 offen offset:0 sc1 lds
    buffer_load_dwordx4 v5, s[8:11], s73 offen offset:1024 sc1 lds
    buffer_load_dwordx4 v6, s[8:11], s73 offen offset:2048 sc1 lds
    buffer_load_dwordx4 v7, s[8:11], s73 offen offset:3072 sc1 lds
    s_add_u32 m0, s67, 32768
    s_nop 0
    s_nop 0
    buffer_load_dwordx4 v44, s[12:15], s74 offen offset:0 lds
    buffer_load_dwordx4 v45, s[12:15], s74 offen offset:1024 lds
    s_add_u32 m0, s67, 40960
    s_nop 0
    s_nop 0
    buffer_load_dwordx4 v46, s[12:15], s74 offen offset:0 lds
    buffer_load_dwordx4 v47, s[12:15], s74 offen offset:1024 lds
    s_add_u32 s48, s62, 8
    s_and_b32 s48, s48, 7
    s_add_u32 s48, s48, s63
    s_add_u32 s48, s48, 8
    s_lshl_b32 s48, s48, 6
    s_add_u32 s48, s48, s88
    s_mul_i32 s48, s48, 2048
    s_add_u32 s48, s48, s89
    s_add_u32 s90, s36, s48
    s_addc_u32 s91, s37, 0
    s_nop 0
    s_load_dword s94, s[90:91], 384
    s_load_dword s94, s[90:91], 1408
    s_add_u32 s69, s62, 6
    s_and_b32 s69, s69, 7
    s_add_u32 s69, s69, s63
    s_lshl_b32 s64, s69, 15
    s_lshl_b32 s69, s69, 6
    s_nop 0
    s_mul_i32 s65, s69, 2048
    s_waitcnt vmcnt(17)
    s_barrier
    s_add_u32 m0, s66, 81920
    s_nop 0
    s_nop 0
    buffer_load_dwordx4 v4, s[8:11], s64 offen offset:0 sc1 lds
    buffer_load_dwordx4 v5, s[8:11], s64 offen offset:1024 sc1 lds
    buffer_load_dwordx4 v6, s[8:11], s64 offen offset:2048 sc1 lds
    buffer_load_dwordx4 v7, s[8:11], s64 offen offset:3072 sc1 lds
    s_add_u32 m0, s67, 65536
    s_nop 0
    s_nop 0
    buffer_load_dwordx4 v44, s[12:15], s65 offen offset:0 lds
    buffer_load_dwordx4 v45, s[12:15], s65 offen offset:1024 lds
    s_add_u32 m0, s67, 73728
    s_nop 0
    s_nop 0
    buffer_load_dwordx4 v46, s[12:15], s65 offen offset:0 lds
    buffer_load_dwordx4 v47, s[12:15], s65 offen offset:1024 lds
    s_add_u32 s48, s62, 9
    s_and_b32 s48, s48, 7
    s_add_u32 s48, s48, s63
    s_add_u32 s48, s48, 8
    s_lshl_b32 s48, s48, 6
    s_add_u32 s48, s48, s88
    s_mul_i32 s48, s48, 2048
    s_add_u32 s48, s48, s89
    s_add_u32 s90, s36, s48
    s_addc_u32 s91, s37, 0
    s_nop 0
    s_load_dword s94, s[90:91], 384
    s_load_dword s94, s[90:91], 1408
    s_add_u32 s69, s62, 7
    s_and_b32 s69, s69, 7
    s_add_u32 s69, s69, s63
    s_lshl_b32 s73, s69, 15
    s_lshl_b32 s69, s69, 6
    s_nop 0
    s_mul_i32 s74, s69, 2048
    s_waitcnt vmcnt(16)
    s_barrier
    s_add_u32 m0, s66, 114688
    s_nop 0
    s_nop 0
    buffer_load_dwordx4 v4, s[8:11], s73 offen offset:0 sc1 lds
    buffer_load_dwordx4 v5, s[8:11], s73 offen offset:1024 sc1 lds
    buffer_load_dwordx4 v6, s[8:11], s73 offen offset:2048 sc1 lds
    buffer_load_dwordx4 v7, s[8:11], s73 offen offset:3072 sc1 lds
    s_add_u32 m0, s67, 98304
    s_nop 0
    s_nop 0
    buffer_load_dwordx4 v44, s[12:15], s74 offen offset:0 lds
    buffer_load_dwordx4 v45, s[12:15], s74 offen offset:1024 lds
    s_add_u32 m0, s67, 106496
    s_nop 0
    s_nop 0
    buffer_load_dwordx4 v46, s[12:15], s74 offen offset:0 lds
    buffer_load_dwordx4 v47, s[12:15], s74 offen offset:1024 lds
    s_add_u32 s84, s47, 6
    s_cmp_ge_u32 s4, 8
    s_cselect_b32 s76, 0, -1
    s_cselect_b32 s77, -1, 0
    v_cmp_le_u32 vcc, s84, v38
    s_nop 0
    s_andn2_b64 s[78:79], s[76:77], vcc
    s_cbranch_scc1 fcc_149
fc_148:
    s_add_u32 s48, s62, 10
    s_and_b32 s48, s48, 7
    s_add_u32 s48, s48, s63
    s_add_u32 s48, s48, 8
    s_lshl_b32 s48, s48, 6
    s_add_u32 s48, s48, s88
    s_mul_i32 s48, s48, 2048
    s_add_u32 s48, s48, s89
    s_add_u32 s90, s36, s48
    s_addc_u32 s91, s37, 0
    s_nop 0
    s_load_dword s94, s[90:91], 384
    s_load_dword s94, s[90:91], 1408
    s_add_u32 s69, s62, 8
    s_and_b32 s69, s69, 7
    s_add_u32 s69, s69, s63
    s_add_u32 s69, s69, 8
    s_lshl_b32 s64, s69, 15
    s_lshl_b32 s69, s69, 6
    s_mul_i32 s65, s69, 2048
    s_waitcnt vmcnt(16)
    s_barrier
    s_add_u32 m0, s66, 16384
    s_nop 0
    s_nop 0
    buffer_load_dwordx4 v4, s[8:11], s64 offen offset:0 sc1 lds
    buffer_load_dwordx4 v5, s[8:11], s64 offen offset:1024 sc1 lds
    buffer_load_dwordx4 v6, s[8:11], s64 offen offset:2048 sc1 lds
    buffer_load_dwordx4 v7, s[8:11], s64 offen offset:3072 sc1 lds
    s_add_u32 m0, s67, 0
    s_nop 0
    buffer_load_dwordx4 v44, s[12:15], s65 offen offset:0 lds
    buffer_load_dwordx4 v45, s[12:15], s65 offen offset:1024 lds
    s_add_u32 m0, s67, 8192
    s_nop 0
    s_nop 0
    buffer_load_dwordx4 v46, s[12:15], s65 offen offset:0 lds
    buffer_load_dwordx4 v47, s[12:15], s65 offen offset:1024 lds
    s_add_u32 s48, s62, 11
    s_and_b32 s48, s48, 7
    s_add_u32 s48, s48, s63
    s_add_u32 s48, s48, 8
    s_lshl_b32 s48, s48, 6
    s_add_u32 s48, s48, s88
    s_mul_i32 s48, s48, 2048
    s_add_u32 s48, s48, s89
    s_add_u32 s90, s36, s48
    s_addc_u32 s91, s37, 0
    s_nop 0
    s_load_dword s94, s[90:91], 384
    s_load_dword s94, s[90:91], 1408
    s_add_u32 s69, s62, 9
    s_and_b32 s69, s69, 7
    s_add_u32 s69, s69, s63
    s_add_u32 s69, s69, 8
    s_lshl_b32 s73, s69, 15
    s_lshl_b32 s69, s69, 6
    s_mul_i32 s74, s69, 2048
    s_waitcnt vmcnt(16)
    s_barrier
    s_add_u32 m0, s66, 49152
    s_nop 0
    s_nop 0
    buffer_load_dwordx4 v4, s[8:11], s73 offen offset:0 sc1 lds
    buffer_load_dwordx4 v5, s[8:11], s73 offen offset:1024 sc1 lds
    buffer_load_dwordx4 v6, s[8:11], s73 offen offset:2048 sc1 lds
    buffer_load_dwordx4 v7, s[8:11], s73 offen offset:3072 sc1 lds
    s_add_u32 m0, s67, 32768
    s_nop 0
    s_nop 0
    buffer_load_dwordx4 v44, s[12:15], s74 offen offset:0 lds
    buffer_load_dwordx4 v45, s[12:15], s74 offen offset:1024 lds
    s_add_u32 m0, s67, 40960
    s_nop 0
    s_nop 0
    buffer_load_dwordx4 v46, s[12:15], s74 offen offset:0 lds
    buffer_load_dwordx4 v47, s[12:15], s74 offen offset:1024 lds
    s_add_u32 s48, s62, 12
    s_and_b32 s48, s48, 7
    s_add_u32 s48, s48, s63
    s_add_u32 s48, s48, 8
    s_lshl_b32 s48, s48, 6
    s_add_u32 s48, s48, s88
    s_mul_i32 s48, s48, 2048
    s_add_u32 s48, s48, s89
    s_add_u32 s90, s36, s48
    s_addc_u32 s91, s37, 0
    s_nop 0
    s_load_dword s94, s[90:91], 384
    s_load_dword s94, s[90:91], 1408
    s_add_u32 s69, s62, 10
    s_and_b32 s69, s69, 7
    s_add_u32 s69, s69, s63
    s_add_u32 s69, s69, 8
    s_lshl_b32 s64, s69, 15
    s_lshl_b32 s69, s69, 6
    s_mul_i32 s65, s69, 2048
    s_waitcnt vmcnt(16)
    s_barrier
    s_add_u32 m0, s66, 81920
    s_nop 0
    s_nop 0
    buffer_load_dwordx4 v4, s[8:11], s64 offen offset:0 sc1 lds
    buffer_load_dwordx4 v5, s[8:11], s64 offen offset:1024 sc1 lds
    buffer_load_dwordx4 v6, s[8:11], s64 offen offset:2048 sc1 lds
    buffer_load_dwordx4 v7, s[8:11], s64 offen offset:3072 sc1 lds
    s_add_u32 m0, s67, 65536
    s_nop 0
    s_nop 0
    buffer_load_dwordx4 v44, s[12:15], s65 offen offset:0 lds
    buffer_load_dwordx4 v45, s[12:15], s65 offen offset:1024 lds
    s_add_u32 m0, s67, 73728
    s_nop 0
    s_nop 0
    buffer_load_dwordx4 v46, s[12:15], s65 offen offset:0 lds
    buffer_load_dwordx4 v47, s[12:15], s65 offen offset:1024 lds
    s_add_u32 s48, s62, 13
    s_and_b32 s48, s48, 7
    s_add_u32 s48, s48, s63
    s_add_u32 s48, s48, 8
    s_lshl_b32 s48, s48, 6
    s_add_u32 s48, s48, s88
    s_mul_i32 s48, s48, 2048
    s_add_u32 s48, s48, s89
    s_add_u32 s90, s36, s48
    s_addc_u32 s91, s37, 0
    s_nop 0
    s_load_dword s94, s[90:91], 384
    s_load_dword s94, s[90:91], 1408
    s_add_u32 s69, s62, 11
    s_and_b32 s69, s69, 7
    s_add_u32 s69, s69, s63
    s_add_u32 s69, s69, 8
    s_lshl_b32 s73, s69, 15
    s_lshl_b32 s69, s69, 6
    s_mul_i32 s74, s69, 2048
    s_waitcnt vmcnt(16)
    s_barrier
    buffer_load_dword v38, v36, s[16:19], 0 offen sc1
    s_add_u32 m0, s66, 114688
    s_nop 0
    s_nop 0
    buffer_load_dwordx4 v4, s[8:11], s73 offen offset:0 sc1 lds
    buffer_load_dwordx4 v5, s[8:11], s73 offen offset:1024 sc1 lds
    buffer_load_dwordx4 v6, s[8:11], s73 offen offset:2048 sc1 lds
    buffer_load_dwordx4 v7, s[8:11], s73 offen offset:3072 sc1 lds
    s_add_u32 m0, s67, 98304
    s_nop 0
    s_nop 0
    buffer_load_dwordx4 v44, s[12:15], s74 offen offset:0 lds
    buffer_load_dwordx4 v45, s[12:15], s74 offen offset:1024 lds
    s_add_u32 m0, s67, 106496
    s_nop 0
    s_nop 0
    buffer_load_dwordx4 v46, s[12:15], s74 offen offset:0 lds
    buffer_load_dwordx4 v47, s[12:15], s74 offen offset:1024 lds
    s_add_u32 s48, s62, 32
    s_and_b32 s48, s48, 6
    s_lshr_b32 s48, s48, 1
    s_add_u32 s48, s48, s63
    s_add_u32 s48, s48, 20
    s_lshl_b32 s48, s48, 6
    s_add_u32 s48, s48, s88
    s_nop 0
    s_mul_i32 s48, s48, 2048
    s_add_u32 s48, s48, s89
    s_add_u32 s90, s36, s48
    s_addc_u32 s91, s37, 0
    s_nop 0
    s_load_dword s94, s[90:91], 384
    s_load_dword s94, s[90:91], 1408
    s_add_u32 s69, s62, 12
    s_and_b32 s69, s69, 7
    s_add_u32 s69, s69, s63
    s_add_u32 s69, s69, 8
    s_lshl_b32 s64, s69, 15
    s_lshl_b32 s69, s69, 6
    s_mul_i32 s65, s69, 2048
    s_waitcnt vmcnt(17)
    s_barrier
    s_add_u32 m0, s66, 16384
    s_nop 0
    s_nop 0
    buffer_load_dwordx4 v4, s[8:11], s64 offen offset:0 sc1 lds
    buffer_load_dwordx4 v5, s[8:11], s64 offen offset:1024 sc1 lds
    buffer_load_dwordx4 v6, s[8:11], s64 offen offset:2048 sc1 lds
    buffer_load_dwordx4 v7, s[8:11], s64 offen offset:3072 sc1 lds
    s_add_u32 m0, s67, 0
    s_nop 0
    buffer_load_dwordx4 v44, s[12:15], s65 offen offset:0 lds
    buffer_load_dwordx4 v45, s[12:15], s65 offen offset:1024 lds
    s_add_u32 m0, s67, 8192
    s_nop 0
    s_nop 0
    buffer_load_dwordx4 v46, s[12:15], s65 offen offset:0 lds
    buffer_load_dwordx4 v47, s[12:15], s65 offen offset:1024 lds
    s_add_u32 s48, s62, 34
    s_and_b32 s48, s48, 6
    s_lshr_b32 s48, s48, 1
    s_add_u32 s48, s48, s63
    s_add_u32 s48, s48, 20
    s_lshl_b32 s48, s48, 6
    s_add_u32 s48, s48, s88
    s_nop 0
    s_mul_i32 s48, s48, 2048
    s_add_u32 s48, s48, s89
    s_add_u32 s90, s36, s48
    s_addc_u32 s91, s37, 0
    s_nop 0
    s_load_dword s94, s[90:91], 384
    s_load_dword s94, s[90:91], 1408
    s_add_u32 s69, s62, 13
    s_and_b32 s69, s69, 7
    s_add_u32 s69, s69, s63
    s_add_u32 s69, s69, 8
    s_lshl_b32 s73, s69, 15
    s_lshl_b32 s69, s69, 6
    s_mul_i32 s74, s69, 2048
    s_waitcnt vmcnt(16)
    s_barrier
    s_add_u32 m0, s66, 49152
    s_nop 0
    s_nop 0
    buffer_load_dwordx4 v4, s[8:11], s73 offen offset:0 sc1 lds
    buffer_load_dwordx4 v5, s[8:11], s73 offen offset:1024 sc1 lds
    buffer_load_dwordx4 v6, s[8:11], s73 offen offset:2048 sc1 lds
    buffer_load_dwordx4 v7, s[8:11], s73 offen offset:3072 sc1 lds
    s_add_u32 m0, s67, 32768
    s_nop 0
    s_nop 0
    buffer_load_dwordx4 v44, s[12:15], s74 offen offset:0 lds
    buffer_load_dwordx4 v45, s[12:15], s74 offen offset:1024 lds
    s_add_u32 m0, s67, 40960
    s_nop 0
    s_nop 0
    buffer_load_dwordx4 v46, s[12:15], s74 offen offset:0 lds
    buffer_load_dwordx4 v47, s[12:15], s74 offen offset:1024 lds
    s_add_u32 s84, s47, 7
    s_cmp_ge_u32 s4, 8
    s_cselect_b32 s76, 0, -1
    s_cselect_b32 s77, -1, 0
    v_cmp_le_u32 vcc, s84, v38
    s_nop 0
    s_andn2_b64 s[78:79], s[76:77], vcc
    s_cbranch_scc1 fcc_154
fc_153:
    s_add_u32 s48, s62, 36
    s_and_b32 s48, s48, 6
    s_lshr_b32 s48, s48, 1
    s_add_u32 s48, s48, s63
    s_add_u32 s48, s48, 20
    s_lshl_b32 s48, s48, 6
    s_add_u32 s48, s48, s88
    s_nop 0
    s_mul_i32 s48, s48, 2048
    s_add_u32 s48, s48, s89
    s_add_u32 s90, s36, s48
    s_addc_u32 s91, s37, 0
    s_nop 0
    s_load_dword s94, s[90:91], 384
    s_load_dword s94, s[90:91], 1408
    s_add_u32 s69, s62, 32
    s_and_b32 s69, s69, 6
    s_lshr_b32 s69, s69, 1
    s_add_u32 s69, s69, s63
    s_add_u32 s69, s69, 20
    s_lshl_b32 s64, s69, 15
    s_lshl_b32 s69, s69, 6
    s_nop 0
    s_mul_i32 s65, s69, 2048
    s_waitcnt vmcnt(16)
    s_barrier
    s_add_u32 m0, s66, 81920
    s_nop 0
    s_nop 0
    buffer_load_dwordx4 v4, s[8:11], s64 offen offset:0 sc1 lds
    buffer_load_dwordx4 v5, s[8:11], s64 offen offset:1024 sc1 lds
    buffer_load_dwordx4 v6, s[8:11], s64 offen offset:2048 sc1 lds
    buffer_load_dwordx4 v7, s[8:11], s64 offen offset:3072 sc1 lds
    s_add_u32 m0, s67, 65536
    s_nop 0
    s_nop 0
    buffer_load_dwordx4 v44, s[12:15], s65 offen offset:0 lds
    buffer_load_dwordx4 v45, s[12:15], s65 offen offset:1024 lds
    s_add_u32 m0, s67, 73728
    s_nop 0
    s_nop 0
    buffer_load_dwordx4 v46, s[12:15], s65 offen offset:0 lds
    buffer_load_dwordx4 v47, s[12:15], s65 offen offset:1024 lds
    s_add_u32 s48, s62, 38
    s_and_b32 s48, s48, 6
    s_lshr_b32 s48, s48, 1
    s_add_u32 s48, s48, s63
    s_add_u32 s48, s48, 20
    s_lshl_b32 s48, s48, 6
    s_add_u32 s48, s48, s88
    s_nop 0
    s_mul_i32 s48, s48, 2048
    s_add_u32 s48, s48, s89
    s_add_u32 s90, s36, s48
    s_addc_u32 s91, s37, 0
    s_nop 0
    s_load_dword s94, s[90:91], 384
    s_load_dword s94, s[90:91], 1408
    s_add_u32 s69, s62, 34
    s_and_b32 s69, s69, 6
    s_lshr_b32 s69, s69, 1
    s_add_u32 s69, s69, s63
    s_add_u32 s69, s69, 20
    s_lshl_b32 s73, s69, 15
    s_lshl_b32 s69, s69, 6
    s_nop 0
    s_mul_i32 s74, s69, 2048
    s_waitcnt vmcnt(16)
    s_barrier
    s_add_u32 m0, s66, 114688
    s_nop 0
    s_nop 0
    buffer_load_dwordx4 v4, s[8:11], s73 offen offset:0 sc1 lds
    buffer_load_dwordx4 v5, s[8:11], s73 offen offset:1024 sc1 lds
    buffer_load_dwordx4 v6, s[8:11], s73 offen offset:2048 sc1 lds
    buffer_load_dwordx4 v7, s[8:11], s73 offen offset:3072 sc1 lds
    s_add_u32 m0, s67, 98304
    s_nop 0
    s_nop 0
    buffer_load_dwordx4 v44, s[12:15], s74 offen offset:0 lds
    buffer_load_dwordx4 v45, s[12:15], s74 offen offset:1024 lds
    s_add_u32 m0, s67, 106496
    s_nop 0
    s_nop 0
    buffer_load_dwordx4 v46, s[12:15], s74 offen offset:0 lds
    buffer_load_dwordx4 v47, s[12:15], s74 offen offset:1024 lds
    s_add_u32 s48, s62, 40
    s_and_b32 s48, s48, 6
    s_lshl_b32 s48, s48, 6
    s_and_b32 s49, s4, 8
    s_lshl_b32 s49, s49, 2
    s_add_u32 s48, s48, s49
    s_add_u32 s48, s48, 3072
    s_add_u32 s48, s48, s88
    s_and_b32 s49, s88, 32
    s_add_u32 s48, s48, s49
    s_nop 0
    s_mul_i32 s48, s48, 2048
    s_add_u32 s48, s48, s89
    s_add_u32 s90, s36, s48
    s_addc_u32 s91, s37, 0
    s_nop 0
    s_load_dword s94, s[90:91], 384
    s_load_dword s94, s[90:91], 1408
    s_add_u32 s69, s62, 36
    s_and_b32 s69, s69, 6
    s_lshr_b32 s69, s69, 1
    s_add_u32 s69, s69, s63
    s_add_u32 s69, s69, 20
    s_lshl_b32 s64, s69, 15
    s_lshl_b32 s69, s69, 6
    s_nop 0
    s_mul_i32 s65, s69, 2048
    s_waitcnt vmcnt(16)
    s_barrier
    s_add_u32 m0, s66, 16384
    s_nop 0
    s_nop 0
    buffer_load_dwordx4 v4, s[8:11], s64 offen offset:0 sc1 lds
    buffer_load_dwordx4 v5, s[8:11], s64 offen offset:1024 sc1 lds
    buffer_load_dwordx4 v6, s[8:11], s64 offen offset:2048 sc1 lds
    buffer_load_dwordx4 v7, s[8:11], s64 offen offset:3072 sc1 lds
    s_add_u32 m0, s67, 0
    s_nop 0
    buffer_load_dwordx4 v44, s[12:15], s65 offen offset:0 lds
    buffer_load_dwordx4 v45, s[12:15], s65 offen offset:1024 lds
    s_add_u32 m0, s67, 8192
    s_nop 0
    s_nop 0
    buffer_load_dwordx4 v46, s[12:15], s65 offen offset:0 lds
    buffer_load_dwordx4 v47, s[12:15], s65 offen offset:1024 lds
    s_add_u32 s48, s62, 42
    s_and_b32 s48, s48, 6
    s_lshl_b32 s48, s48, 6
    s_and_b32 s49, s4, 8
    s_lshl_b32 s49, s49, 2
    s_add_u32 s48, s48, s49
    s_add_u32 s48, s48, 3072
    s_add_u32 s48, s48, s88
    s_and_b32 s49, s88, 32
    s_add_u32 s48, s48, s49
    s_nop 0
    s_mul_i32 s48, s48, 2048
    s_add_u32 s48, s48, s89
    s_add_u32 s90, s36, s48
    s_addc_u32 s91, s37, 0
    s_nop 0
    s_load_dword s94, s[90:91], 384
    s_load_dword s94, s[90:91], 1408
    s_add_u32 s69, s62, 38
    s_and_b32 s69, s69, 6
    s_lshr_b32 s69, s69, 1
    s_add_u32 s69, s69, s63
    s_add_u32 s69, s69, 20
    s_lshl_b32 s73, s69, 15
    s_lshl_b32 s69, s69, 6
    s_nop 0
    s_mul_i32 s74, s69, 2048
    s_waitcnt vmcnt(16)
    s_barrier
    buffer_load_dword v38, v37, s[16:19], 0 offen sc1
    s_add_u32 m0, s66, 49152
    s_nop 0
    s_nop 0
    buffer_load_dwordx4 v4, s[8:11], s73 offen offset:0 sc1 lds
    buffer_load_dwordx4 v5, s[8:11], s73 offen offset:1024 sc1 lds
    buffer_load_dwordx4 v6, s[8:11], s73 offen offset:2048 sc1 lds
    buffer_load_dwordx4 v7, s[8:11], s73 offen offset:3072 sc1 lds
    s_add_u32 m0, s67, 32768
    s_nop 0
    s_nop 0
    buffer_load_dwordx4 v44, s[12:15], s74 offen offset:0 lds
    buffer_load_dwordx4 v45, s[12:15], s74 offen offset:1024 lds
    s_add_u32 m0, s67, 40960
    s_nop 0
    s_nop 0
    buffer_load_dwordx4 v46, s[12:15], s74 offen offset:0 lds
    buffer_load_dwordx4 v47, s[12:15], s74 offen offset:1024 lds
    s_add_u32 s48, s62, 44
    s_and_b32 s48, s48, 6
    s_lshl_b32 s48, s48, 6
    s_and_b32 s49, s4, 8
    s_lshl_b32 s49, s49, 2
    s_add_u32 s48, s48, s49
    s_add_u32 s48, s48, 3072
    s_add_u32 s48, s48, s88
    s_and_b32 s49, s88, 32
    s_add_u32 s48, s48, s49
    s_nop 0
    s_mul_i32 s48, s48, 2048
    s_add_u32 s48, s48, s89
    s_add_u32 s90, s36, s48
    s_addc_u32 s91, s37, 0
    s_nop 0
    s_load_dword s94, s[90:91], 384
    s_load_dword s94, s[90:91], 1408
    s_add_u32 s69, s62, 40
    s_and_b32 s69, s69, 6
    s_and_b32 s49, s4, 8
    s_add_u32 s64, s69, s49
    s_lshl_b32 s64, s64, 14
    s_nop 0
    s_add_u32 s64, s64, 1572864
    s_lshl_b32 s69, s69, 6
    s_and_b32 s49, s4, 8
    s_lshl_b32 s49, s49, 2
    s_add_u32 s69, s69, s49
    s_add_u32 s69, s69, 3072
    s_and_b32 s49, s6, 2
    s_lshl_b32 s49, s49, 4
    s_add_u32 s69, s69, s49
    s_nop 0
    s_mul_i32 s65, s69, 2048
    s_waitcnt vmcnt(17)
    s_barrier
    s_add_u32 m0, s66, 81920
    s_nop 0
    s_nop 0
    buffer_load_dwordx4 v4, s[8:11], s64 offen offset:0 sc1 lds
    buffer_load_dwordx4 v5, s[8:11], s64 offen offset:1024 sc1 lds
    buffer_load_dwordx4 v6, s[8:11], s64 offen offset:2048 sc1 lds
    buffer_load_dwordx4 v7, s[8:11], s64 offen offset:3072 sc1 lds
    s_add_u32 m0, s67, 65536
    s_nop 0
    s_nop 0
    buffer_load_dwordx4 v44, s[12:15], s65 offen offset:0 lds
    buffer_load_dwordx4 v45, s[12:15], s65 offen offset:1024 lds
    s_add_u32 m0, s67, 73728
    s_nop 0
    s_nop 0
    buffer_load_dwordx4 v46, s[12:15], s65 offen offset:0 lds
    buffer_load_dwordx4 v47, s[12:15], s65 offen offset:1024 lds
    s_add_u32 s48, s62, 46
    s_and_b32 s48, s48, 6
    s_lshl_b32 s48, s48, 6
    s_and_b32 s49, s4, 8
    s_lshl_b32 s49, s49, 2
    s_add_u32 s48, s48, s49
    s_add_u32 s48, s48, 3072
    s_add_u32 s48, s48, s88
    s_and_b32 s49, s88, 32
    s_add_u32 s48, s48, s49
    s_nop 0
    s_mul_i32 s48, s48, 2048
    s_add_u32 s48, s48, s89
    s_add_u32 s90, s36, s48
    s_addc_u32 s91, s37, 0
    s_nop 0
    s_load_dword s94, s[90:91], 384
    s_load_dword s94, s[90:91], 1408
    s_add_u32 s69, s62, 42
    s_and_b32 s69, s69, 6
    s_and_b32 s49, s4, 8
    s_add_u32 s73, s69, s49
    s_lshl_b32 s73, s73, 14
    s_nop 0
    s_add_u32 s73, s73, 1572864
    s_lshl_b32 s69, s69, 6
    s_and_b32 s49, s4, 8
    s_lshl_b32 s49, s49, 2
    s_add_u32 s69, s69, s49
    s_add_u32 s69, s69, 3072
    s_and_b32 s49, s6, 2
    s_lshl_b32 s49, s49, 4
    s_add_u32 s69, s69, s49
    s_nop 0
    s_mul_i32 s74, s69, 2048
    s_waitcnt vmcnt(16)
    s_barrier
    s_add_u32 m0, s66, 114688
    s_nop 0
    s_nop 0
    buffer_load_dwordx4 v4, s[8:11], s73 offen offset:0 sc1 lds
    buffer_load_dwordx4 v5, s[8:11], s73 offen offset:1024 sc1 lds
    buffer_load_dwordx4 v6, s[8:11], s73 offen offset:2048 sc1 lds
    buffer_load_dwordx4 v7, s[8:11], s73 offen offset:3072 sc1 lds
    s_add_u32 m0, s67, 98304
    s_nop 0
    s_nop 0
    buffer_load_dwordx4 v44, s[12:15], s74 offen offset:0 lds
    buffer_load_dwordx4 v45, s[12:15], s74 offen offset:1024 lds
    s_add_u32 m0, s67, 106496
    s_nop 0
    s_nop 0
    buffer_load_dwordx4 v46, s[12:15], s74 offen offset:0 lds
    buffer_load_dwordx4 v47, s[12:15], s74 offen offset:1024 lds
    s_add_u32 s84, s47, 7
    s_cmp_lt_u32 s4, 8
    s_cselect_b32 s76, 0, -1
    s_cselect_b32 s77, -1, 0
    v_cmp_le_u32 vcc, s84, v38
    s_nop 0
    s_andn2_b64 s[78:79], s[76:77], vcc
    s_cbranch_scc1 fcc_159
fc_158:
    s_add_u32 s48, s62, 14
    s_and_b32 s48, s48, 7
    s_add_u32 s48, s48, s75
    s_add_u32 s48, s48, 8
    s_lshl_b32 s48, s48, 6
    s_add_u32 s48, s48, s88
    s_mul_i32 s48, s48, 2048
    s_add_u32 s48, s48, s89
    s_add_u32 s90, s36, s48
    s_addc_u32 s91, s37, 0
    s_nop 0
    s_load_dword s94, s[90:91], 384
    s_load_dword s94, s[90:91], 1408
    s_add_u32 s69, s62, 44
    s_and_b32 s69, s69, 6
    s_and_b32 s49, s4, 8
    s_add_u32 s64, s69, s49
    s_lshl_b32 s64, s64, 14
    s_nop 0
    s_add_u32 s64, s64, 1572864
    s_lshl_b32 s69, s69, 6
    s_and_b32 s49, s4, 8
    s_lshl_b32 s49, s49, 2
    s_add_u32 s69, s69, s49
    s_add_u32 s69, s69, 3072
    s_and_b32 s49, s6, 2
    s_lshl_b32 s49, s49, 4
    s_add_u32 s69, s69, s49
    s_nop 0
    s_mul_i32 s65, s69, 2048
    s_waitcnt vmcnt(16)
    s_barrier
    s_add_u32 m0, s66, 16384
    s_nop 0
    s_nop 0
    buffer_load_dwordx4 v4, s[8:11], s64 offen offset:0 sc1 lds
    buffer_load_dwordx4 v5, s[8:11], s64 offen offset:1024 sc1 lds
    buffer_load_dwordx4 v6, s[8:11], s64 offen offset:2048 sc1 lds
    buffer_load_dwordx4 v7, s[8:11], s64 offen offset:3072 sc1 lds
    s_add_u32 m0, s67, 0
    s_nop 0
    buffer_load_dwordx4 v44, s[12:15], s65 offen offset:0 lds
    buffer_load_dwordx4 v45, s[12:15], s65 offen offset:1024 lds
    s_add_u32 m0, s67, 8192
    s_nop 0
    s_nop 0
    buffer_load_dwordx4 v46, s[12:15], s65 offen offset:0 lds
    buffer_load_dwordx4 v47, s[12:15], s65 offen offset:1024 lds
    s_add_u32 s48, s62, 15
    s_and_b32 s48, s48, 7
    s_add_u32 s48, s48, s75
    s_add_u32 s48, s48, 8
    s_lshl_b32 s48, s48, 6
    s_add_u32 s48, s48, s88
    s_mul_i32 s48, s48, 2048
    s_add_u32 s48, s48, s89
    s_add_u32 s90, s36, s48
    s_addc_u32 s91, s37, 0
    s_nop 0
    s_load_dword s94, s[90:91], 384
    s_load_dword s94, s[90:91], 1408
    s_add_u32 s69, s62, 46
    s_and_b32 s69, s69, 6
    s_and_b32 s49, s4, 8
    s_add_u32 s73, s69, s49
    s_lshl_b32 s73, s73, 14
    s_nop 0
    s_add_u32 s73, s73, 1572864
    s_lshl_b32 s69, s69, 6
    s_and_b32 s49, s4, 8
    s_lshl_b32 s49, s49, 2
    s_add_u32 s69, s69, s49
    s_add_u32 s69, s69, 3072
    s_and_b32 s49, s6, 2
    s_lshl_b32 s49, s49, 4
    s_add_u32 s69, s69, s49
    s_nop 0
    s_mul_i32 s74, s69, 2048
    s_waitcnt vmcnt(16)
    s_barrier
    s_add_u32 m0, s66, 49152
    s_nop 0
    s_nop 0
    buffer_load_dwordx4 v4, s[8:11], s73 offen offset:0 sc1 lds
    buffer_load_dwordx4 v5, s[8:11], s73 offen offset:1024 sc1 lds
    buffer_load_dwordx4 v6, s[8:11], s73 offen offset:2048 sc1 lds
    buffer_load_dwordx4 v7, s[8:11], s73 offen offset:3072 sc1 lds
    s_add_u32 m0, s67, 32768
    s_nop 0
    s_nop 0
    buffer_load_dwordx4 v44, s[12:15], s74 offen offset:0 lds
    buffer_load_dwordx4 v45, s[12:15], s74 offen offset:1024 lds
    s_add_u32 m0, s67, 40960
    s_nop 0
    s_nop 0
    buffer_load_dwordx4 v46, s[12:15], s74 offen offset:0 lds
    buffer_load_dwordx4 v47, s[12:15], s74 offen offset:1024 lds
    s_add_u32 s48, s62, 48
    s_and_b32 s48, s48, 6
    s_lshr_b32 s48, s48, 1
    s_add_u32 s48, s48, s63
    s_add_u32 s48, s48, 16
    s_lshl_b32 s48, s48, 6
    s_add_u32 s48, s48, s88
    s_nop 0
    s_mul_i32 s48, s48, 2048
    s_add_u32 s48, s48, s89
    s_and_b32 s49, s4, 8
    s_mul_i32 s49, s49, 128
    s_add_u32 s48, s48, s49
    s_add_u32 s92, s36, s48
    s_addc_u32 s93, s37, 0
    s_nop 0
    s_load_dword s94, s[92:93], 384
    s_cmp_eq_u32 s7, 0
    s_cselect_b32 s70, 1, s30
    s_cmp_eq_u32 s70, 0
    s_nop 0
    s_cselect_b32 s71, 0x10000, 0
    s_cbranch_scc1 L_l_moved
L_l_move:
    s_add_u32 s69, s62, 14
    s_and_b32 s69, s69, 7
    s_add_u32 s69, s69, s75
    s_add_u32 s69, s69, 8
    s_lshl_b32 s64, s69, 15
    s_lshl_b32 s69, s69, 6
    s_nop 0
    s_mul_i32 s65, s69, 2048
    s_waitcnt vmcnt(16)
    s_barrier
    s_add_u32 m0, s66, 81920
    s_xor_b32 m0, m0, s71
    s_nop 0
    buffer_load_dwordx4 v4, s[8:11], s64 offen offset:0 sc1 lds
    buffer_load_dwordx4 v5, s[8:11], s64 offen offset:1024 sc1 lds
    buffer_load_dwordx4 v6, s[8:11], s64 offen offset:2048 sc1 lds
    buffer_load_dwordx4 v7, s[8:11], s64 offen offset:3072 sc1 lds
    s_add_u32 m0, s67, 65536
    s_xor_b32 m0, m0, s71
    s_nop 0
    buffer_load_dwordx4 v44, s[12:15], s65 offen offset:0 lds
    buffer_load_dwordx4 v45, s[12:15], s65 offen offset:1024 lds
    s_add_u32 m0, s67, 73728
    s_xor_b32 m0, m0, s71
    s_nop 0
    buffer_load_dwordx4 v46, s[12:15], s65 offen offset:0 lds
    buffer_load_dwordx4 v47, s[12:15], s65 offen offset:1024 lds
    s_add_u32 s48, s62, 50
    s_and_b32 s48, s48, 6
    s_lshr_b32 s48, s48, 1
    s_add_u32 s48, s48, s63
    s_add_u32 s48, s48, 16
    s_lshl_b32 s48, s48, 6
    s_add_u32 s48, s48, s88
    s_nop 0
    s_mul_i32 s48, s48, 2048
    s_add_u32 s48, s48, s89
    s_and_b32 s49, s4, 8
    s_mul_i32 s49, s49, 128
    s_add_u32 s48, s48, s49
    s_add_u32 s92, s36, s48
    s_addc_u32 s93, s37, 0
    s_nop 0
    s_load_dword s94, s[92:93], 384
    s_add_u32 s69, s62, 15
    s_and_b32 s69, s69, 7
    s_add_u32 s69, s69, s75
    s_add_u32 s69, s69, 8
    s_lshl_b32 s73, s69, 15
    s_lshl_b32 s69, s69, 6
    s_mul_i32 s74, s69, 2048
    s_waitcnt vmcnt(16)
    s_barrier
    s_add_u32 m0, s66, 114688
    s_xor_b32 m0, m0, s71
    s_nop 0
    buffer_load_dwordx4 v4, s[8:11], s73 offen offset:0 sc1 lds
    buffer_load_dwordx4 v5, s[8:11], s73 offen offset:1024 sc1 lds
    buffer_load_dwordx4 v6, s[8:11], s73 offen offset:2048 sc1 lds
    buffer_load_dwordx4 v7, s[8:11], s73 offen offset:3072 sc1 lds
    s_add_u32 m0, s67, 98304
    s_xor_b32 m0, m0, s71
    s_nop 0
    buffer_load_dwordx4 v44, s[12:15], s74 offen offset:0 lds
    buffer_load_dwordx4 v45, s[12:15], s74 offen offset:1024 lds
    s_add_u32 m0, s67, 106496
    s_xor_b32 m0, m0, s71
    s_nop 0
    buffer_load_dwordx4 v46, s[12:15], s74 offen offset:0 lds
    buffer_load_dwordx4 v47, s[12:15], s74 offen offset:1024 lds
    s_add_u32 s48, s62, 52
    s_and_b32 s48, s48, 6
    s_lshr_b32 s48, s48, 1
    s_add_u32 s48, s48, s63
    s_add_u32 s48, s48, 16
    s_lshl_b32 s48, s48, 6
    s_add_u32 s48, s48, s88
    s_nop 0
    s_mul_i32 s48, s48, 2048
    s_add_u32 s48, s48, s89
    s_and_b32 s49, s4, 8
    s_mul_i32 s49, s49, 128
    s_add_u32 s48, s48, s49
    s_add_u32 s92, s36, s48
    s_addc_u32 s93, s37, 0
    s_nop 0
    s_load_dword s94, s[92:93], 384
    s_cmp_eq_u32 s70, 2
    s_cbranch_scc0 L_l_moved
    s_mov_b32 s70, 1
    s_nop 0
    s_mov_b32 s71, 0x10000
    s_sub_u32 s75, 24, s63
    s_branch L_l_move
L_l_moved:
    s_add_u32 s69, s62, 48
    s_and_b32 s69, s69, 6
    s_lshr_b32 s69, s69, 1
    s_add_u32 s69, s69, s63
    s_add_u32 s69, s69, 16
    s_lshl_b32 s64, s69, 15
    s_lshl_b32 s69, s69, 6
    s_nop 0
    s_mul_i32 s65, s69, 2048
    s_waitcnt vmcnt(16)
    s_barrier
    s_add_u32 m0, s66, 16384
    s_xor_b32 m0, m0, s71
    s_nop 0
    buffer_load_dwordx4 v4, s[8:11], s64 offen offset:0 sc1 lds
    buffer_load_dwordx4 v5, s[8:11], s64 offen offset:1024 sc1 lds
    buffer_load_dwordx4 v6, s[8:11], s64 offen offset:2048 sc1 lds
    buffer_load_dwordx4 v7, s[8:11], s64 offen offset:3072 sc1 lds
    s_add_u32 m0, s67, 0
    s_xor_b32 m0, m0, s71
    s_nop 0
    s_nop 0
    buffer_load_dwordx4 v44, s[12:15], s65 offen offset:0 lds
    buffer_load_dwordx4 v45, s[12:15], s65 offen offset:1024 lds
    s_add_u32 s48, s62, 54
    s_and_b32 s48, s48, 6
    s_lshr_b32 s48, s48, 1
    s_add_u32 s48, s48, s63
    s_add_u32 s48, s48, 16
    s_lshl_b32 s48, s48, 6
    s_add_u32 s48, s48, s88
    s_nop 0
    s_mul_i32 s48, s48, 2048
    s_add_u32 s48, s48, s89
    s_and_b32 s49, s4, 8
    s_mul_i32 s49, s49, 128
    s_add_u32 s48, s48, s49
    s_add_u32 s92, s36, s48
    s_addc_u32 s93, s37, 0
    s_nop 0
    s_load_dword s94, s[92:93], 384
    s_add_u32 s69, s62, 50
    s_and_b32 s69, s69, 6
    s_lshr_b32 s69, s69, 1
    s_add_u32 s69, s69, s63
    s_add_u32 s69, s69, 16
    s_lshl_b32 s73, s69, 15
    s_lshl_b32 s69, s69, 6
    s_nop 0
    s_mul_i32 s74, s69, 2048
    s_waitcnt vmcnt(14)
    s_barrier
    s_add_u32 m0, s66, 49152
    s_xor_b32 m0, m0, s71
    s_nop 0
    buffer_load_dwordx4 v4, s[8:11], s73 offen offset:0 sc1 lds
    buffer_load_dwordx4 v5, s[8:11], s73 offen offset:1024 sc1 lds
    buffer_load_dwordx4 v6, s[8:11], s73 offen offset:2048 sc1 lds
    buffer_load_dwordx4 v7, s[8:11], s73 offen offset:3072 sc1 lds
    s_add_u32 m0, s67, 32768
    s_xor_b32 m0, m0, s71
    s_nop 0
    buffer_load_dwordx4 v44, s[12:15], s74 offen offset:0 lds
    buffer_load_dwordx4 v45, s[12:15], s74 offen offset:1024 lds
    s_add_u32 s48, s62, 56
    s_and_b32 s48, s48, 6
    s_lshr_b32 s48, s48, 1
    s_sub_u32 s48, s48, s63
    s_add_u32 s48, s48, 40
    s_lshl_b32 s48, s48, 6
    s_add_u32 s48, s48, s88
    s_nop 0
    s_mul_i32 s48, s48, 2048
    s_add_u32 s48, s48, s89
    s_and_b32 s49, s4, 8
    s_mul_i32 s49, s49, 128
    s_add_u32 s48, s48, s49
    s_add_u32 s92, s36, s48
    s_addc_u32 s93, s37, 0
    s_nop 0
    s_load_dword s94, s[92:93], 384
    s_add_u32 s69, s62, 52
    s_and_b32 s69, s69, 6
    s_lshr_b32 s69, s69, 1
    s_add_u32 s69, s69, s63
    s_add_u32 s69, s69, 16
    s_lshl_b32 s64, s69, 15
    s_lshl_b32 s69, s69, 6
    s_nop 0
    s_mul_i32 s65, s69, 2048
    s_waitcnt vmcnt(12)
    s_barrier
    s_add_u32 m0, s66, 81920
    s_xor_b32 m0, m0, s71
    s_nop 0
    buffer_load_dwordx4 v4, s[8:11], s64 offen offset:0 sc1 lds
    buffer_load_dwordx4 v5, s[8:11], s64 offen offset:1024 sc1 lds
    buffer_load_dwordx4 v6, s[8:11], s64 offen offset:2048 sc1 lds
    buffer_load_dwordx4 v7, s[8:11], s64 offen offset:3072 sc1 lds
    s_add_u32 m0, s67, 65536
    s_xor_b32 m0, m0, s71
    s_nop 0
    buffer_load_dwordx4 v44, s[12:15], s65 offen offset:0 lds
    buffer_load_dwordx4 v45, s[12:15], s65 offen offset:1024 lds
    s_add_u32 s48, s62, 58
    s_and_b32 s48, s48, 6
    s_lshr_b32 s48, s48, 1
    s_sub_u32 s48, s48, s63
    s_add_u32 s48, s48, 40
    s_lshl_b32 s48, s48, 6
    s_add_u32 s48, s48, s88
    s_nop 0
    s_mul_i32 s48, s48, 2048
    s_add_u32 s48, s48, s89
    s_and_b32 s49, s4, 8
    s_mul_i32 s49, s49, 128
    s_add_u32 s48, s48, s49
    s_add_u32 s92, s36, s48
    s_addc_u32 s93, s37, 0
    s_nop 0
    s_load_dword s94, s[92:93], 384
    s_add_u32 s69, s62, 54
    s_and_b32 s69, s69, 6
    s_lshr_b32 s69, s69, 1
    s_add_u32 s69, s69, s63
    s_add_u32 s69, s69, 16
    s_lshl_b32 s73, s69, 15
    s_lshl_b32 s69, s69, 6
    s_nop 0
    s_mul_i32 s74, s69, 2048
    s_waitcnt vmcnt(12)
    s_barrier
    s_add_u32 m0, s66, 114688
    s_xor_b32 m0, m0, s71
    s_nop 0
    buffer_load_dwordx4 v4, s[8:11], s73 offen offset:0 sc1 lds
    buffer_load_dwordx4 v5, s[8:11], s73 offen offset:1024 sc1 lds
    buffer_load_dwordx4 v6, s[8:11], s73 offen offset:2048 sc1 lds
    buffer_load_dwordx4 v7, s[8:11], s73 offen offset:3072 sc1 lds
    s_add_u32 m0, s67, 98304
    s_xor_b32 m0, m0, s71
    s_nop 0
    buffer_load_dwordx4 v44, s[12:15], s74 offen offset:0 lds
    buffer_load_dwordx4 v45, s[12:15], s74 offen offset:1024 lds
    s_add_u32 s48, s62, 60
    s_and_b32 s48, s48, 6
    s_lshr_b32 s48, s48, 1
    s_sub_u32 s48, s48, s63
    s_add_u32 s48, s48, 40
    s_lshl_b32 s48, s48, 6
    s_add_u32 s48, s48, s88
    s_nop 0
    s_mul_i32 s48, s48, 2048
    s_add_u32 s48, s48, s89
    s_and_b32 s49, s4, 8
    s_mul_i32 s49, s49, 128
    s_add_u32 s48, s48, s49
    s_add_u32 s92, s36, s48
    s_addc_u32 s93, s37, 0
    s_nop 0
    s_load_dword s94, s[92:93], 384
    s_add_u32 s69, s62, 56
    s_and_b32 s69, s69, 6
    s_lshr_b32 s69, s69, 1
    s_sub_u32 s69, s69, s63
    s_add_u32 s69, s69, 40
    s_lshl_b32 s64, s69, 15
    s_lshl_b32 s69, s69, 6
    s_nop 0
    s_mul_i32 s65, s69, 2048
    s_waitcnt vmcnt(12)
    s_barrier
    s_add_u32 m0, s66, 16384
    s_xor_b32 m0, m0, s71
    s_nop 0
    buffer_load_dwordx4 v4, s[8:11], s64 offen offset:0 sc1 lds
    buffer_load_dwordx4 v5, s[8:11], s64 offen offset:1024 sc1 lds
    buffer_load_dwordx4 v6, s[8:11], s64 offen offset:2048 sc1 lds
    buffer_load_dwordx4 v7, s[8:11], s64 offen offset:3072 sc1 lds
    s_add_u32 m0, s67, 0
    s_xor_b32 m0, m0, s71
    s_nop 0
    s_nop 0
    buffer_load_dwordx4 v44, s[12:15], s65 offen offset:0 lds
    buffer_load_dwordx4 v45, s[12:15], s65 offen offset:1024 lds
    s_add_u32 s48, s62, 62
    s_and_b32 s48, s48, 6
    s_lshr_b32 s48, s48, 1
    s_sub_u32 s48, s48, s63
    s_add_u32 s48, s48, 40
    s_lshl_b32 s48, s48, 6
    s_add_u32 s48, s48, s88
    s_nop 0
    s_mul_i32 s48, s48, 2048
    s_add_u32 s48, s48, s89
    s_and_b32 s49, s4, 8
    s_mul_i32 s49, s49, 128
    s_add_u32 s48, s48, s49
    s_add_u32 s92, s36, s48
    s_addc_u32 s93, s37, 0
    s_nop 0
    s_load_dword s94, s[92:93], 384
    s_add_u32 s69, s62, 58
    s_and_b32 s69, s69, 6
    s_lshr_b32 s69, s69, 1
    s_sub_u32 s69, s69, s63
    s_add_u32 s69, s69, 40
    s_lshl_b32 s73, s69, 15
    s_lshl_b32 s69, s69, 6
    s_nop 0
    s_mul_i32 s74, s69, 2048
    s_waitcnt vmcnt(12)
    s_barrier
    s_add_u32 m0, s66, 49152
    s_xor_b32 m0, m0, s71
    s_nop 0
    buffer_load_dwordx4 v4, s[8:11], s73 offen offset:0 sc1 lds
    buffer_load_dwordx4 v5, s[8:11], s73 offen offset:1024 sc1 lds
    buffer_load_dwordx4 v6, s[8:11], s73 offen offset:2048 sc1 lds
    buffer_load_dwordx4 v7, s[8:11], s73 offen offset:3072 sc1 lds
    s_add_u32 m0, s67, 32768
    s_xor_b32 m0, m0, s71
    s_nop 0
    buffer_load_dwordx4 v44, s[12:15], s74 offen offset:0 lds
    buffer_load_dwordx4 v45, s[12:15], s74 offen offset:1024 lds
    s_bfe_u32 s48, s99, 0x40000
    s_lshl_b32 s48, s48, 6
    s_add_u32 s48, s48, s88
    s_mul_i32 s48, s48, 6144
    s_add_u32 s48, s48, s89
    s_and_b32 s49, s4, 8
    s_mul_i32 s49, s49, 128
    s_add_u32 s48, s48, s49
    s_add_u32 s92, s26, s48
    s_addc_u32 s93, s27, 0
    s_nop 0
    s_load_dword s94, s[92:93], 384
    s_load_dword s94, s[92:93], 2432
    s_load_dword s94, s[92:93], 4480
    s_add_u32 s69, s62, 60
    s_and_b32 s69, s69, 6
    s_lshr_b32 s69, s69, 1
    s_sub_u32 s69, s69, s63
    s_add_u32 s69, s69, 40
    s_lshl_b32 s64, s69, 15
    s_lshl_b32 s69, s69, 6
    s_nop 0
    s_mul_i32 s65, s69, 2048
    s_waitcnt vmcnt(12)
    s_barrier
    s_add_u32 m0, s66, 81920
    s_xor_b32 m0, m0, s71
    s_nop 0
    buffer_load_dwordx4 v4, s[8:11], s64 offen offset:0 sc1 lds
    buffer_load_dwordx4 v5, s[8:11], s64 offen offset:1024 sc1 lds
    buffer_load_dwordx4 v6, s[8:11], s64 offen offset:2048 sc1 lds
    buffer_load_dwordx4 v7, s[8:11], s64 offen offset:3072 sc1 lds
    s_add_u32 m0, s67, 65536
    s_xor_b32 m0, m0, s71
    s_nop 0
    buffer_load_dwordx4 v44, s[12:15], s65 offen offset:0 lds
    buffer_load_dwordx4 v45, s[12:15], s65 offen offset:1024 lds
    s_bfe_u32 s48, s99, 0x40004
    s_lshl_b32 s48, s48, 6
    s_add_u32 s48, s48, s88
    s_mul_i32 s48, s48, 6144
    s_add_u32 s48, s48, s89
    s_and_b32 s49, s4, 8
    s_mul_i32 s49, s49, 128
    s_add_u32 s48, s48, s49
    s_add_u32 s92, s26, s48
    s_addc_u32 s93, s27, 0
    s_nop 0
    s_load_dword s94, s[92:93], 384
    s_load_dword s94, s[92:93], 2432
    s_load_dword s94, s[92:93], 4480
    s_add_u32 s69, s62, 62
    s_and_b32 s69, s69, 6
    s_lshr_b32 s69, s69, 1
    s_sub_u32 s69, s69, s63
    s_add_u32 s69, s69, 40
    s_lshl_b32 s73, s69, 15
    s_lshl_b32 s69, s69, 6
    s_nop 0
    s_mul_i32 s74, s69, 2048
    s_waitcnt vmcnt(12)
    s_barrier
    s_add_u32 m0, s66, 114688
    s_xor_b32 m0, m0, s71
    s_nop 0
    buffer_load_dwordx4 v4, s[8:11], s73 offen offset:0 sc1 lds
    buffer_load_dwordx4 v5, s[8:11], s73 offen offset:1024 sc1 lds
    buffer_load_dwordx4 v6, s[8:11], s73 offen offset:2048 sc1 lds
    buffer_load_dwordx4 v7, s[8:11], s73 offen offset:3072 sc1 lds
    s_add_u32 m0, s67, 98304
    s_xor_b32 m0, m0, s71
    s_nop 0
    buffer_load_dwordx4 v44, s[12:15], s74 offen offset:0 lds
    buffer_load_dwordx4 v45, s[12:15], s74 offen offset:1024 lds
    s_waitcnt vmcnt(12)
    s_barrier
    s_cmp_lg_u32 s7, 0
    s_cbranch_scc1 ra_163
    s_mov_b32 s12, s26
    s_mov_b32 s13, s27
    s_mov_b32 s14, 6291456
    s_mov_b32 s15, 0x20000
    s_bfe_u32 s69, s100, 0x40000
    s_lshl_b32 s69, s69, 6
    s_nop 0
    s_mul_i32 s65, s69, 6144
    s_add_u32 m0, s67, 0
    s_nop 0
    buffer_load_dwordx4 v8, s[12:15], s65 offen offset:0 lds
    buffer_load_dwordx4 v9, s[12:15], s65 offen offset:1024 lds
    s_add_u32 m0, s67, 8192
    s_nop 0
    s_nop 0
    buffer_load_dwordx4 v10, s[12:15], s65 offen offset:0 lds
    buffer_load_dwordx4 v11, s[12:15], s65 offen offset:1024 lds
    s_add_u32 m0, s67, 16384
    s_nop 0
    s_nop 0
    buffer_load_dwordx4 v12, s[12:15], s65 offen offset:0 lds
    buffer_load_dwordx4 v13, s[12:15], s65 offen offset:1024 lds
ra_163:
    s_waitcnt vmcnt(12)
    s_cmp_eq_u32 s7, 0
    s_cbranch_scc1 wc_164
    s_waitcnt vmcnt(6)
wc_164:
    s_barrier
    s_cmp_lg_u32 s7, 0
    s_cbranch_scc1 ra_165
    s_nop 0
    s_bfe_u32 s69, s100, 0x40004
    s_lshl_b32 s69, s69, 6
    s_nop 0
    s_mul_i32 s74, s69, 6144
    s_add_u32 m0, s67, 28672
    s_nop 0
    s_nop 0
    buffer_load_dwordx4 v8, s[12:15], s74 offen offset:0 lds
    buffer_load_dwordx4 v9, s[12:15], s74 offen offset:1024 lds
    s_add_u32 m0, s67, 36864
    s_nop 0
    s_nop 0
    buffer_load_dwordx4 v10, s[12:15], s74 offen offset:0 lds
    buffer_load_dwordx4 v11, s[12:15], s74 offen offset:1024 lds
    s_add_u32 m0, s67, 45056
    s_nop 0
    s_nop 0
    buffer_load_dwordx4 v12, s[12:15], s74 offen offset:0 lds
    buffer_load_dwordx4 v13, s[12:15], s74 offen offset:1024 lds
ra_165:
    s_waitcnt vmcnt(12)
    s_cmp_eq_u32 s7, 0
    s_cbranch_scc1 wc_166
    s_waitcnt vmcnt(0)
wc_166:
    s_barrier
    s_waitcnt lgkmcnt(0)
    s_barrier
    s_cmp_lg_u32 s7, 0
    s_cbranch_scc1 ra_167
    s_nop 0
    s_bfe_u32 s48, s99, 0x40008
    s_lshl_b32 s48, s48, 6
    s_add_u32 s48, s48, s88
    s_mul_i32 s48, s48, 6144
    s_add_u32 s48, s48, s89
    s_and_b32 s49, s4, 8
    s_mul_i32 s49, s49, 128
    s_add_u32 s48, s48, s49
    s_add_u32 s92, s26, s48
    s_addc_u32 s93, s27, 0
    s_nop 0
    s_load_dword s94, s[92:93], 384
    s_load_dword s94, s[92:93], 2432
    s_load_dword s94, s[92:93], 4480
    s_bfe_u32 s48, s99, 0x4000c
    s_lshl_b32 s48, s48, 6
    s_add_u32 s48, s48, s88
    s_mul_i32 s48, s48, 6144
    s_add_u32 s48, s48, s89
    s_and_b32 s49, s4, 8
    s_mul_i32 s49, s49, 128
    s_add_u32 s48, s48, s49
    s_add_u32 s92, s26, s48
    s_addc_u32 s93, s27, 0
    s_nop 0
    s_load_dword s94, s[92:93], 384
    s_load_dword s94, s[92:93], 2432
    s_load_dword s94, s[92:93], 4480
ra_167:
    s_cmp_lg_u32 s7, 0
    s_cbranch_scc1 L_l_fin
    s_mul_i32 s48, s3, 524288
    s_add_u32 s48, s48, 8388608
    s_add_u32 s8, s16, s48
    s_addc_u32 s9, s17, 0
    s_mov_b32 s10, 524288
    s_mov_b32 s11, 0x20000
    s_mov_b32 s7, 1
    s_mov_b32 s47, 16
    s_waitcnt vmcnt(6)
    s_branch L_l_layer
L_l_fin:
    s_lshl_b32 s48, s3, 18
    s_lshl_b32 s49, s4, 7
    s_add_u32 s49, s49, s48
    s_add_u32 s50, s6, 4
    s_lshl_b32 s51, s50, 15
    s_add_u32 s49, s49, s51
    s_lshl_b32 s50, s50, 11
    s_nop 0
    s_add_u32 s50, s50, 135168
    s_mov_b32 s20, s40
    s_mov_b32 s21, s41
    s_mov_b32 s22, 4194304
    s_mov_b32 s23, 0x20000
    v_lshrrev_b32 v20, 3, v0
    v_and_b32 v21, 7, v0
    v_lshlrev_b32_e64 v22, 11, v20
    v_lshl_add_u32 v22, v21, 4, v22
    v_lshrrev_b32 v23, 4, v0
    v_xor_b32 v21, v21, v23
    v_lshlrev_b32_e64 v21, 4, v21
    v_lshl_add_u32 v21, v20, 7, v21
    v_add_u32 v21, s50, v21
    v_xor_b32 v20, 64, v21
    v_add_u32 v23, 16384, v22
    s_waitcnt lgkmcnt(0)
    s_barrier
    ds_read_b128 v[24:27], v21
    ds_read_b128 v[28:31], v20 offset:1024
    s_waitcnt lgkmcnt(1)
    s_nop 0
    buffer_store_dwordx4 v[24:27], v22, s[20:23], s49 offen
    s_waitcnt lgkmcnt(0)
    s_nop 0
    buffer_store_dwordx4 v[28:31], v23, s[20:23], s49 offen
    s_endpgm
    .p2align 3
L_compute:
    s_lshr_b32 s48, s2, 3
    s_lshl_b32 s48, s48, 2
    s_add_u32 s48, s48, s6
    s_and_b32 s49, s48, 1
    s_lshl_b32 s49, s49, 6
    s_and_b32 s50, s4, 8
    s_lshl_b32 s50, s50, 7
    s_add_u32 s49, s49, s50
    s_lshr_b32 s48, s48, 1
    s_and_b32 s50, s3, 12
    s_lshl_b32 s51, s50, 6
    s_add_u32 s51, s51, s48
    s_mul_i32 s51, s51, 6144
    s_add_u32 s51, s51, s49
    s_add_u32 s52, s26, s51
    s_addc_u32 s53, s27, 0
    s_nop 0
    s_add_u32 s54, s52, 786432
    s_addc_u32 s55, s53, 0
    s_lshl_b32 s50, s50, 7
    s_add_u32 s50, s50, s48
    s_lshl_b32 s50, s50, 11
    s_add_u32 s50, s50, s49
    s_add_u32 s56, s24, s50
    s_addc_u32 s57, s25, 0
    s_nop 0
    s_load_dword s59, s[52:53], 4480
    s_load_dword s59, s[52:53], 397696
    s_load_dword s59, s[54:55], 4480
    s_load_dword s59, s[54:55], 397696
    s_load_dword s59, s[52:53], 2432
    s_load_dword s59, s[52:53], 395648
    s_load_dword s59, s[54:55], 2432
    s_load_dword s59, s[54:55], 395648
    s_load_dword s59, s[52:53], 384
    s_load_dword s59, s[52:53], 393600
    s_load_dword s59, s[54:55], 384
    s_load_dword s59, s[54:55], 393600
    s_lshr_b32 s45, s6, 1
    s_and_b32 s46, s6, 1
    v_and_b32 v16, 15, v0
    v_lshrrev_b32 v17, 4, v0
    v_lshrrev_b32 v18, 1, v16
    v_xor_b32 v19, v18, v17
    v_lshlrev_b32_e64 v19, 4, v19
    v_lshl_add_u32 v19, v16, 7, v19
    s_lshl_b32 s48, s45, 13
    v_add_u32 v4, s48, v19
    v_add_u32 v4, 86016, v4
    v_xor_b32_e64 v5, 64, v4
    v_lshl_add_u32 v9, v0, 4, s48
    s_lshl_b32 s49, s46, 14
    v_add_u32 v1, s49, v9
    v_add_u32 v2, 128, v1
    v_cmp_gt_u32 vcc, 24, v0
    s_nop 1
    v_cndmask_b32 v1, v2, v1, vcc
    s_lshl_b32 s49, s46, 2
    v_lshrrev_b32 v19, 5, v0
    v_add_u32 v19, s49, v19
    v_xor_b32 v19, v19, v18
    v_lshlrev_b32 v19, 4, v19
    v_lshl_add_u32 v19, v16, 7, v19
    v_and_b32_e64 v18, 1, v17
    v_lshl_add_u32 v19, v18, 3, v19
    s_add_u32 s48, s48, 135168
    v_add_u32 v2, s48, v19
    v_xor_b32 v3, 32, v2
    v_bfe_u32 v16, v0, 2, 2
    v_lshl_add_u32 v16, v17, 3, v16
    v_bfe_u32 v18, v0, 3, 2
    v_and_b32 v19, 3, v0
    v_lshlrev_b32 v19, 3, v19
    s_lshl_b32 s48, s46, 1
    v_xor_b32 v10, s48, v18
    v_lshl_add_u32 v10, v10, 5, v19
    v_lshl_add_u32 v10, v16, 7, v10
    v_xor_b32 v11, 32, v10
    v_lshrrev_b32 v18, 1, v18
    v_xor_b32_e64 v18, s46, v18
    v_lshl_add_u32 v18, v18, 5, v19
    v_lshl_add_u32 v12, v16, 6, v18
    v_cmp_eq_u32_e64 vcc, 0, v0
    v_mov_b32 v16, 268435456
    s_nop 0
    s_nop 0
    v_cndmask_b32 v13, v16, 0, vcc
    s_lshl_b32 s48, s3, 8
    s_lshl_b32 s49, s4, 4
    s_add_u32 s48, s48, s49
    s_lshl_b32 s49, s6, 2
    s_add_u32 s48, s48, s49
    v_add_u32 v14, s48, v13
    v_lshlrev_b32 v15, 4, v0
    v_mov_b64 v[244:245], -1
    v_mov_b64 v[246:247], -1
    v_mov_b32 v252, 0
    s_lshl_b32 s83, s3, 4
    s_add_u32 s83, s83, s4
    s_lshl_b32 s83, s83, 7
    s_lshl_b32 s48, s6, 2
    s_add_u32 s83, s83, s48
    s_nop 0
    s_add_u32 s83, s83, 65536
    v_and_b32 v17, 31, v0
    v_lshlrev_b32 v17, 2, v17
    s_lshl_b32 s48, s3, 8
    s_lshl_b32 s49, s4, 4
    s_add_u32 s48, s48, s49
    s_and_b32 s49, s4, 7
    s_or_b32 s49, s49, s6
    s_nop 0
    s_cselect_b32 s48, 268435456, s48
    buffer_store_dword v252, v17, s[16:19], s48 offen sc1
    v_lshlrev_b32 v17, 2, v0
    s_lshl_b32 s48, s4, 14
    s_lshl_b32 s49, s3, 10
    s_add_u32 s48, s48, s49
    s_lshl_b32 s50, s6, 8
    s_add_u32 s48, s48, s50
    s_add_u32 s48, s48, 2359296
    buffer_store_dword v244, v17, s[16:19], s48 offen sc1
    v_lshlrev_b32 v16, 4, v0
    v_and_b32 v17, 15, v0
    v_lshlrev_b32 v17, 2, v17
    s_lshl_b32 s48, s4, 16
    s_lshl_b32 s49, s3, 10
    s_add_u32 s48, s48, s49
    s_lshl_b32 s49, s6, 14
    s_add_u32 s48, s48, s49
    s_lshr_b32 s49, s48, 4
    s_nop 0
    s_add_u32 s48, s48, 3145728
    s_add_u32 s49, s49, 5242880
    buffer_store_dwordx4 v[244:247], v16, s[16:19], s48 offen sc1
    buffer_store_dword v244, v17, s[16:19], s49 offen sc1
    s_getreg_b32 s48, hwreg(HW_REG_XCC_ID, 0, 4)
    s_and_b32 s48, s48, 7
    s_mul_i32 s49, s48, s48
    s_lshl_b32 s48, s48, 6
    s_lshl_b32 s49, s49, 14
    s_add_u32 s87, s48, s49
    s_add_u32 s87, s87, 1
    v_mov_b64 v[112:113], 0
    v_mov_b64 v[114:115], 0
    v_mov_b64 v[116:117], 0
    v_mov_b64 v[118:119], 0
    v_mov_b64 v[120:121], 0
    v_mov_b64 v[122:123], 0
    v_mov_b64 v[124:125], 0
    v_mov_b64 v[126:127], 0
    v_mov_b64 v[128:129], 0
    v_mov_b64 v[130:131], 0
    v_mov_b64 v[132:133], 0
    v_mov_b64 v[134:135], 0
    v_mov_b64 v[136:137], 0
    v_mov_b64 v[138:139], 0
    v_mov_b64 v[140:141], 0
    v_mov_b64 v[142:143], 0
    v_mov_b64 v[144:145], 0
    v_mov_b64 v[146:147], 0
    v_mov_b64 v[148:149], 0
    v_mov_b64 v[150:151], 0
    v_mov_b64 v[152:153], 0
    v_mov_b64 v[154:155], 0
    v_mov_b64 v[156:157], 0
    v_mov_b64 v[158:159], 0
    v_mov_b64 v[160:161], 0
    v_mov_b64 v[162:163], 0
    v_mov_b64 v[164:165], 0
    v_mov_b64 v[166:167], 0
    v_mov_b64 v[168:169], 0
    v_mov_b64 v[170:171], 0
    v_mov_b64 v[172:173], 0
    v_mov_b64 v[174:175], 0
    v_mov_b64 v[176:177], 0
    v_mov_b64 v[178:179], 0
    v_mov_b64 v[180:181], 0
    v_mov_b64 v[182:183], 0
    v_mov_b64 v[184:185], 0
    v_mov_b64 v[186:187], 0
    v_mov_b64 v[188:189], 0
    v_mov_b64 v[190:191], 0
    v_mov_b64 v[192:193], 0
    v_mov_b64 v[194:195], 0
    v_mov_b64 v[196:197], 0
    v_mov_b64 v[198:199], 0
    v_mov_b64 v[200:201], 0
    v_mov_b64 v[202:203], 0
    v_mov_b64 v[204:205], 0
    v_mov_b64 v[206:207], 0
    v_and_b32 v104, 48, v0
    v_and_b32 v105, 15, v0
    v_lshlrev_b32 v105, 2, v105
    s_lshl_b32 s48, s45, 8
    s_nop 0
    s_add_u32 s48, s48, 151552
    s_lshl_b32 s49, s46, 7
    s_nop 0
    s_add_u32 s49, s49, 152576
    v_add_u32 v106, s48, v104
    v_add_u32 v107, s49, v105
    v_add_u32 v108, s48, v105
    v_add_u32 v109, s49, v104
    v_mov_b32 v110, 155904
    s_waitcnt vmcnt(4) lgkmcnt(0)
    s_nop 0
    v_bfe_u32 v32, v0, 2, 2
    v_lshlrev_b32_e64 v32, 4, v32
    v_lshl_add_u32 v32, v0, 6, v32
    s_lshl_b32 s48, s6, 12
    s_nop 0
    s_add_u32 s48, s48, 135168
    v_add_u32 v32, s48, v32
    v_xor_b32 v33, 0, v32
    ds_read_b128 v[16:19], v33
    v_xor_b32_e64 v33, 16, v32
    ds_read_b128 v[20:23], v33
    v_xor_b32_e64 v33, 32, v32
    ds_read_b128 v[24:27], v33
    v_xor_b32_e64 v33, 48, v32
    ds_read_b128 v[28:31], v33
    v_mov_b32 v36, 0
    v_mov_b32 v37, 0
    v_mov_b32 v38, 0
    v_mov_b32 v39, 0
    s_mov_b32 s50, 0x3f803f80
    s_lshl_b32 s48, 0, 18
    s_lshl_b32 s49, s3, 14
    s_add_u32 s48, s48, s49
    s_lshl_b32 s49, s4, 10
    s_add_u32 s48, s48, s49
    s_lshl_b32 s49, s6, 8
    s_add_u32 s48, s48, s49
    s_nop 0
    s_add_u32 s48, s48, 1048576
    s_waitcnt lgkmcnt(3)
    v_dot2c_f32_bf16 v36, s50, v16
    v_dot2c_f32_bf16 v38, v16, v16
    v_dot2c_f32_bf16 v37, s50, v17
    v_dot2c_f32_bf16 v39, v17, v17
    v_dot2c_f32_bf16 v36, s50, v18
    v_dot2c_f32_bf16 v38, v18, v18
    v_dot2c_f32_bf16 v37, s50, v19
    v_dot2c_f32_bf16 v39, v19, v19
    s_waitcnt lgkmcnt(2)
    v_dot2c_f32_bf16 v36, s50, v20
    v_dot2c_f32_bf16 v38, v20, v20
    v_dot2c_f32_bf16 v37, s50, v21
    v_dot2c_f32_bf16 v39, v21, v21
    v_dot2c_f32_bf16 v36, s50, v22
    v_dot2c_f32_bf16 v38, v22, v22
    v_dot2c_f32_bf16 v37, s50, v23
    v_dot2c_f32_bf16 v39, v23, v23
    s_waitcnt lgkmcnt(1)
    v_dot2c_f32_bf16 v36, s50, v24
    v_dot2c_f32_bf16 v38, v24, v24
    v_dot2c_f32_bf16 v37, s50, v25
    v_dot2c_f32_bf16 v39, v25, v25
    v_dot2c_f32_bf16 v36, s50, v26
    v_dot2c_f32_bf16 v38, v26, v26
    v_dot2c_f32_bf16 v37, s50, v27
    v_dot2c_f32_bf16 v39, v27, v27
    s_waitcnt lgkmcnt(0)
    v_dot2c_f32_bf16 v36, s50, v28
    v_dot2c_f32_bf16 v38, v28, v28
    v_dot2c_f32_bf16 v37, s50, v29
    v_dot2c_f32_bf16 v39, v29, v29
    v_dot2c_f32_bf16 v36, s50, v30
    v_dot2c_f32_bf16 v38, v30, v30
    v_dot2c_f32_bf16 v37, s50, v31
    v_dot2c_f32_bf16 v39, v31, v31
    v_and_b32 v32, 1, v0
    v_cmp_eq_u32 vcc, 0, v32
    v_add_f32 v36, v36, v37
    v_add_f32 v38, v38, v39
    s_nop 0
    s_nop 0
    v_add_f32_dpp v37, v36, v36 quad_perm:[1,0,3,2] row_mask:0xf bank_mask:0xf
    v_add_f32_dpp v39, v38, v38 quad_perm:[1,0,3,2] row_mask:0xf bank_mask:0xf
    v_cndmask_b32 v253, v39, v37, vcc
    s_mov_b32 s61, s48
    v_mov_b32 v254, 0
    s_mov_b32 s75, 3
    s_mov_b64 vcc, 0
L_c_layer:
    v_mov_b32 v6, v10
    v_mov_b32 v7, v11
    s_mov_b32 s99, 6
    s_mov_b32 s70, 1
    s_mov_b32 s71, 0
    s_mov_b32 s64, 0xffff8000
    s_mov_b32 s65, 0xffff2000
    s_waitcnt lgkmcnt(0)
    s_barrier
    ds_read_b64_tr_b16 v[80:81], v6 offset:0
    ds_read_b64_tr_b16 v[82:83], v6 offset:512
    ds_read_b64_tr_b16 v[84:85], v6 offset:4096
    ds_read_b64_tr_b16 v[86:87], v6 offset:4608
    ds_read_b128 v[16:19], v4 offset:0
    ds_read_b128 v[20:23], v5 offset:0
    ds_read_b128 v[24:27], v4 offset:2048
    ds_read_b128 v[28:31], v5 offset:2048
    ds_read_b128 v[32:35], v4 offset:4096
    ds_read_b128 v[36:39], v5 offset:4096
    ds_read_b128 v[40:43], v4 offset:6144
    ds_read_b128 v[44:47], v5 offset:6144
    ds_read_b64_tr_b16 v[88:89], v7 offset:0
    ds_read_b64_tr_b16 v[90:91], v7 offset:512
    ds_read_b64_tr_b16 v[92:93], v7 offset:4096
    ds_read_b64_tr_b16 v[94:95], v7 offset:4608
    s_cmp_eq_u32 s7, 0
    s_cbranch_scc1 z0_170
    v_mov_b64 v[112:113], 0
    v_mov_b64 v[114:115], 0
    v_mov_b64 v[116:117], 0
    v_mov_b64 v[118:119], 0
    v_mov_b64 v[120:121], 0
    v_mov_b64 v[122:123], 0
    v_mov_b64 v[124:125], 0
    v_mov_b64 v[126:127], 0
    v_mov_b64 v[128:129], 0
    v_mov_b64 v[130:131], 0
    v_mov_b64 v[132:133], 0
    v_mov_b64 v[134:135], 0
    v_mov_b64 v[136:137], 0
    v_mov_b64 v[138:139], 0
    v_mov_b64 v[140:141], 0
    v_mov_b64 v[142:143], 0
    v_mov_b64 v[144:145], 0
    v_mov_b64 v[146:147], 0
    v_mov_b64 v[148:149], 0
    v_mov_b64 v[150:151], 0
    v_mov_b64 v[152:153], 0
    v_mov_b64 v[154:155], 0
    v_mov_b64 v[156:157], 0
    v_mov_b64 v[158:159], 0
    v_mov_b64 v[160:161], 0
    v_mov_b64 v[162:163], 0
    v_mov_b64 v[164:165], 0
    v_mov_b64 v[166:167], 0
    v_mov_b64 v[168:169], 0
    v_mov_b64 v[170:171], 0
    v_mov_b64 v[172:173], 0
    v_mov_b64 v[174:175], 0
    v_mov_b64 v[176:177], 0
    v_mov_b64 v[178:179], 0
    v_mov_b64 v[180:181], 0
    v_mov_b64 v[182:183], 0
    v_mov_b64 v[184:185], 0
    v_mov_b64 v[186:187], 0
    v_mov_b64 v[188:189], 0
    v_mov_b64 v[190:191], 0
    v_mov_b64 v[192:193], 0
    v_mov_b64 v[194:195], 0
    v_mov_b64 v[196:197], 0
    v_mov_b64 v[198:199], 0
    v_mov_b64 v[200:201], 0
    v_mov_b64 v[202:203], 0
    v_mov_b64 v[204:205], 0
    v_mov_b64 v[206:207], 0
    v_and_b32 v104, 48, v0
    v_and_b32 v105, 15, v0
    v_lshlrev_b32 v105, 2, v105
    s_lshl_b32 s48, s45, 8
    s_add_u32 s48, s48, 151552
    s_lshl_b32 s49, s46, 7
    s_nop 0
    s_add_u32 s49, s49, 152576
    v_add_u32 v106, s48, v104
    v_add_u32 v107, s49, v105
    v_add_u32 v108, s48, v105
    v_add_u32 v109, s49, v104
    v_mov_b32 v110, 155904
z0_170:
    s_branch cl_171
mid_173:
    s_add_u32 s48, s47, -7
    v_mov_b32 v254, s48
    s_cmp_eq_u32 s44, 0
    s_waitcnt vmcnt(0)
    s_cbranch_scc0 sigs_3175
    buffer_store_dword v254, v14, s[16:19], 0 offen
sigd_3176:
    s_branch midr_174
    .p2align 5
cl_171:
    s_waitcnt lgkmcnt(4)
    s_nop 0
    v_mfma_f32_16x16x32_bf16 v[112:115], v[16:19], v[80:83], v[112:115]
    ds_read_b64_tr_b16 v[96:97], v6 offset:8192
    v_mfma_f32_16x16x32_bf16 v[112:115], v[20:23], v[84:87], v[112:115]
    ds_read_b64_tr_b16 v[98:99], v6 offset:8704
    v_mfma_f32_16x16x32_bf16 v[116:119], v[28:31], v[84:87], v[116:119]
    ds_read_b64_tr_b16 v[100:101], v6 offset:12288
    v_mfma_f32_16x16x32_bf16 v[116:119], v[24:27], v[80:83], v[116:119]
    ds_read_b64_tr_b16 v[102:103], v6 offset:12800
    v_mfma_f32_16x16x32_bf16 v[120:123], v[32:35], v[80:83], v[120:123]
    s_add_u32 s71, s71, 1
    s_cmp_eq_u32 s71, 3
    v_mfma_f32_16x16x32_bf16 v[120:123], v[36:39], v[84:87], v[120:123]
    s_cselect_b32 s73, s64, 16384
    v_mfma_f32_16x16x32_bf16 v[124:127], v[44:47], v[84:87], v[124:127]
    s_cselect_b32 s74, s65, 28672
    v_mfma_f32_16x16x32_bf16 v[124:127], v[40:43], v[80:83], v[124:127]
    s_cselect_b32 s71, 0, s71
    s_waitcnt lgkmcnt(4)
    v_mfma_f32_16x16x32_bf16 v[140:143], v[40:43], v[88:91], v[140:143]
    ds_read_b64_tr_b16 v[80:81], v7 offset:8192
    v_mfma_f32_16x16x32_bf16 v[140:143], v[44:47], v[92:95], v[140:143]
    ds_read_b64_tr_b16 v[82:83], v7 offset:8704
    v_mfma_f32_16x16x32_bf16 v[136:139], v[36:39], v[92:95], v[136:139]
    ds_read_b64_tr_b16 v[84:85], v7 offset:12288
    v_mfma_f32_16x16x32_bf16 v[136:139], v[32:35], v[88:91], v[136:139]
    ds_read_b64_tr_b16 v[86:87], v7 offset:12800
    v_mfma_f32_16x16x32_bf16 v[132:135], v[24:27], v[88:91], v[132:135]
    v_mfma_f32_16x16x32_bf16 v[132:135], v[28:31], v[92:95], v[132:135]
    v_mfma_f32_16x16x32_bf16 v[128:131], v[20:23], v[92:95], v[128:131]
    v_mfma_f32_16x16x32_bf16 v[128:131], v[16:19], v[88:91], v[128:131]
    s_cbranch_vccnz mid_173
midr_174:
    s_waitcnt lgkmcnt(4)
    v_mfma_f32_16x16x32_bf16 v[144:147], v[16:19], v[96:99], v[144:147]
    ds_read_b64_tr_b16 v[88:89], v6 offset:16384
    v_mfma_f32_16x16x32_bf16 v[144:147], v[20:23], v[100:103], v[144:147]
    ds_read_b64_tr_b16 v[90:91], v6 offset:16896
    v_mfma_f32_16x16x32_bf16 v[148:151], v[28:31], v[100:103], v[148:151]
    ds_read_b64_tr_b16 v[92:93], v6 offset:20480
    v_mfma_f32_16x16x32_bf16 v[148:151], v[24:27], v[96:99], v[148:151]
    ds_read_b64_tr_b16 v[94:95], v6 offset:20992
    v_mfma_f32_16x16x32_bf16 v[152:155], v[32:35], v[96:99], v[152:155]
    v_mfma_f32_16x16x32_bf16 v[152:155], v[36:39], v[100:103], v[152:155]
    v_mfma_f32_16x16x32_bf16 v[156:159], v[44:47], v[100:103], v[156:159]
    v_mfma_f32_16x16x32_bf16 v[156:159], v[40:43], v[96:99], v[156:159]
    s_waitcnt lgkmcnt(4)
    s_nop 0
    v_mfma_f32_16x16x32_bf16 v[172:175], v[40:43], v[80:83], v[172:175]
    ds_read_b64_tr_b16 v[96:97], v7 offset:16384
    v_mfma_f32_16x16x32_bf16 v[172:175], v[44:47], v[84:87], v[172:175]
    ds_read_b64_tr_b16 v[98:99], v7 offset:16896
    v_mfma_f32_16x16x32_bf16 v[168:171], v[36:39], v[84:87], v[168:171]
    ds_read_b64_tr_b16 v[100:101], v7 offset:20480
    v_mfma_f32_16x16x32_bf16 v[168:171], v[32:35], v[80:83], v[168:171]
    ds_read_b64_tr_b16 v[102:103], v7 offset:20992
    v_mfma_f32_16x16x32_bf16 v[164:167], v[24:27], v[80:83], v[164:167]
    v_add_u32 v4, s73, v4
    v_add_u32 v5, s73, v5
    v_mfma_f32_16x16x32_bf16 v[164:167], v[28:31], v[84:87], v[164:167]
    v_add_u32 v6, s74, v6
    v_add_u32 v7, s74, v7
    v_mfma_f32_16x16x32_bf16 v[160:163], v[20:23], v[84:87], v[160:163]
    s_cbranch_vccnz mid_175
midr_176:
    s_nop 0
    v_mfma_f32_16x16x32_bf16 v[160:163], v[16:19], v[80:83], v[160:163]
    s_waitcnt lgkmcnt(0)
    s_barrier
    v_mfma_f32_16x16x32_bf16 v[176:179], v[88:91], v[16:19], v[176:179]
    ds_read_b64_tr_b16 v[80:81], v6 offset:0
    v_mfma_f32_16x16x32_bf16 v[176:179], v[92:95], v[20:23], v[176:179]
    ds_read_b64_tr_b16 v[82:83], v6 offset:512
    v_mfma_f32_16x16x32_bf16 v[180:183], v[92:95], v[28:31], v[180:183]
    ds_read_b64_tr_b16 v[84:85], v6 offset:4096
    v_mfma_f32_16x16x32_bf16 v[180:183], v[88:91], v[24:27], v[180:183]
    ds_read_b64_tr_b16 v[86:87], v6 offset:4608
    v_mfma_f32_16x16x32_bf16 v[184:187], v[88:91], v[32:35], v[184:187]
    ds_read_b128 v[48:51], v4 offset:0
    v_mfma_f32_16x16x32_bf16 v[184:187], v[92:95], v[36:39], v[184:187]
    ds_read_b128 v[52:55], v5 offset:0
    v_mfma_f32_16x16x32_bf16 v[188:191], v[92:95], v[44:47], v[188:191]
    ds_read_b128 v[56:59], v4 offset:2048
    v_mfma_f32_16x16x32_bf16 v[188:191], v[88:91], v[40:43], v[188:191]
    ds_read_b128 v[60:63], v5 offset:2048
    v_mfma_f32_16x16x32_bf16 v[204:207], v[96:99], v[40:43], v[204:207]
    ds_read_b128 v[64:67], v4 offset:4096
    v_mfma_f32_16x16x32_bf16 v[204:207], v[100:103], v[44:47], v[204:207]
    ds_read_b128 v[68:71], v5 offset:4096
    v_mfma_f32_16x16x32_bf16 v[200:203], v[100:103], v[36:39], v[200:203]
    ds_read_b128 v[72:75], v4 offset:6144
    v_mfma_f32_16x16x32_bf16 v[200:203], v[96:99], v[32:35], v[200:203]
    ds_read_b128 v[76:79], v5 offset:6144
    v_mfma_f32_16x16x32_bf16 v[196:199], v[96:99], v[24:27], v[196:199]
    ds_read_b64_tr_b16 v[88:89], v7 offset:0
    v_mfma_f32_16x16x32_bf16 v[196:199], v[100:103], v[28:31], v[196:199]
    ds_read_b64_tr_b16 v[90:91], v7 offset:512
    v_mfma_f32_16x16x32_bf16 v[192:195], v[100:103], v[20:23], v[192:195]
    ds_read_b64_tr_b16 v[92:93], v7 offset:4096
    v_mfma_f32_16x16x32_bf16 v[192:195], v[96:99], v[16:19], v[192:195]
    ds_read_b64_tr_b16 v[94:95], v7 offset:4608
    s_waitcnt lgkmcnt(4)
    s_nop 0
    v_mfma_f32_16x16x32_bf16 v[112:115], v[48:51], v[80:83], v[112:115]
    ds_read_b64_tr_b16 v[96:97], v6 offset:8192
    v_mfma_f32_16x16x32_bf16 v[112:115], v[52:55], v[84:87], v[112:115]
    ds_read_b64_tr_b16 v[98:99], v6 offset:8704
    v_mfma_f32_16x16x32_bf16 v[116:119], v[60:63], v[84:87], v[116:119]
    ds_read_b64_tr_b16 v[100:101], v6 offset:12288
    v_mfma_f32_16x16x32_bf16 v[116:119], v[56:59], v[80:83], v[116:119]
    ds_read_b64_tr_b16 v[102:103], v6 offset:12800
    v_mfma_f32_16x16x32_bf16 v[120:123], v[64:67], v[80:83], v[120:123]
    s_add_u32 s71, s71, 1
    s_cmp_eq_u32 s71, 3
    v_mfma_f32_16x16x32_bf16 v[120:123], v[68:71], v[84:87], v[120:123]
    s_cselect_b32 s73, s64, 16384
    v_mfma_f32_16x16x32_bf16 v[124:127], v[76:79], v[84:87], v[124:127]
    s_cselect_b32 s74, s65, 28672
    v_mfma_f32_16x16x32_bf16 v[124:127], v[72:75], v[80:83], v[124:127]
    s_cselect_b32 s71, 0, s71
    s_waitcnt lgkmcnt(4)
    v_mfma_f32_16x16x32_bf16 v[140:143], v[72:75], v[88:91], v[140:143]
    ds_read_b64_tr_b16 v[80:81], v7 offset:8192
    v_mfma_f32_16x16x32_bf16 v[140:143], v[76:79], v[92:95], v[140:143]
    ds_read_b64_tr_b16 v[82:83], v7 offset:8704
    v_mfma_f32_16x16x32_bf16 v[136:139], v[68:71], v[92:95], v[136:139]
    ds_read_b64_tr_b16 v[84:85], v7 offset:12288
    v_mfma_f32_16x16x32_bf16 v[136:139], v[64:67], v[88:91], v[136:139]
    ds_read_b64_tr_b16 v[86:87], v7 offset:12800
    v_mfma_f32_16x16x32_bf16 v[132:135], v[56:59], v[88:91], v[132:135]
    v_mfma_f32_16x16x32_bf16 v[132:135], v[60:63], v[92:95], v[132:135]
    v_mfma_f32_16x16x32_bf16 v[128:131], v[52:55], v[92:95], v[128:131]
    v_mfma_f32_16x16x32_bf16 v[128:131], v[48:51], v[88:91], v[128:131]
    s_waitcnt lgkmcnt(4)
    s_nop 0
    v_mfma_f32_16x16x32_bf16 v[144:147], v[48:51], v[96:99], v[144:147]
    ds_read_b64_tr_b16 v[88:89], v6 offset:16384
    v_mfma_f32_16x16x32_bf16 v[144:147], v[52:55], v[100:103], v[144:147]
    ds_read_b64_tr_b16 v[90:91], v6 offset:16896
    v_mfma_f32_16x16x32_bf16 v[148:151], v[60:63], v[100:103], v[148:151]
    ds_read_b64_tr_b16 v[92:93], v6 offset:20480
    v_mfma_f32_16x16x32_bf16 v[148:151], v[56:59], v[96:99], v[148:151]
    ds_read_b64_tr_b16 v[94:95], v6 offset:20992
    v_mfma_f32_16x16x32_bf16 v[152:155], v[64:67], v[96:99], v[152:155]
    v_mfma_f32_16x16x32_bf16 v[152:155], v[68:71], v[100:103], v[152:155]
    v_mfma_f32_16x16x32_bf16 v[156:159], v[76:79], v[100:103], v[156:159]
    v_mfma_f32_16x16x32_bf16 v[156:159], v[72:75], v[96:99], v[156:159]
    s_waitcnt lgkmcnt(4)
    s_nop 0
    v_mfma_f32_16x16x32_bf16 v[172:175], v[72:75], v[80:83], v[172:175]
    ds_read_b64_tr_b16 v[96:97], v7 offset:16384
    v_mfma_f32_16x16x32_bf16 v[172:175], v[76:79], v[84:87], v[172:175]
    ds_read_b64_tr_b16 v[98:99], v7 offset:16896
    v_mfma_f32_16x16x32_bf16 v[168:171], v[68:71], v[84:87], v[168:171]
    ds_read_b64_tr_b16 v[100:101], v7 offset:20480
    v_mfma_f32_16x16x32_bf16 v[168:171], v[64:67], v[80:83], v[168:171]
    ds_read_b64_tr_b16 v[102:103], v7 offset:20992
    v_mfma_f32_16x16x32_bf16 v[164:167], v[56:59], v[80:83], v[164:167]
    v_add_u32 v4, s73, v4
    v_add_u32 v5, s73, v5
    v_mfma_f32_16x16x32_bf16 v[164:167], v[60:63], v[84:87], v[164:167]
    v_add_u32 v6, s74, v6
    v_add_u32 v7, s74, v7
    v_mfma_f32_16x16x32_bf16 v[160:163], v[52:55], v[84:87], v[160:163]
    v_mfma_f32_16x16x32_bf16 v[160:163], v[48:51], v[80:83], v[160:163]
    s_sub_u32 s99, s99, 1
    s_waitcnt lgkmcnt(0)
    s_barrier
    s_cbranch_scc1 tail_172
    v_mfma_f32_16x16x32_bf16 v[176:179], v[88:91], v[48:51], v[176:179]
    ds_read_b64_tr_b16 v[80:81], v6 offset:0
    v_mfma_f32_16x16x32_bf16 v[176:179], v[92:95], v[52:55], v[176:179]
    ds_read_b64_tr_b16 v[82:83], v6 offset:512
    v_mfma_f32_16x16x32_bf16 v[180:183], v[92:95], v[60:63], v[180:183]
    ds_read_b64_tr_b16 v[84:85], v6 offset:4096
    v_mfma_f32_16x16x32_bf16 v[180:183], v[88:91], v[56:59], v[180:183]
    ds_read_b64_tr_b16 v[86:87], v6 offset:4608
    v_mfma_f32_16x16x32_bf16 v[184:187], v[88:91], v[64:67], v[184:187]
    ds_read_b128 v[16:19], v4 offset:0
    v_mfma_f32_16x16x32_bf16 v[184:187], v[92:95], v[68:71], v[184:187]
    ds_read_b128 v[20:23], v5 offset:0
    v_mfma_f32_16x16x32_bf16 v[188:191], v[92:95], v[76:79], v[188:191]
    ds_read_b128 v[24:27], v4 offset:2048
    v_mfma_f32_16x16x32_bf16 v[188:191], v[88:91], v[72:75], v[188:191]
    ds_read_b128 v[28:31], v5 offset:2048
    v_mfma_f32_16x16x32_bf16 v[204:207], v[96:99], v[72:75], v[204:207]
    ds_read_b128 v[32:35], v4 offset:4096
    v_mfma_f32_16x16x32_bf16 v[204:207], v[100:103], v[76:79], v[204:207]
    ds_read_b128 v[36:39], v5 offset:4096
    v_mfma_f32_16x16x32_bf16 v[200:203], v[100:103], v[68:71], v[200:203]
    ds_read_b128 v[40:43], v4 offset:6144
    v_mfma_f32_16x16x32_bf16 v[200:203], v[96:99], v[64:67], v[200:203]
    ds_read_b128 v[44:47], v5 offset:6144
    v_mfma_f32_16x16x32_bf16 v[196:199], v[96:99], v[56:59], v[196:199]
    ds_read_b64_tr_b16 v[88:89], v7 offset:0
    v_mfma_f32_16x16x32_bf16 v[196:199], v[100:103], v[60:63], v[196:199]
    ds_read_b64_tr_b16 v[90:91], v7 offset:512
    v_mfma_f32_16x16x32_bf16 v[192:195], v[100:103], v[52:55], v[192:195]
    ds_read_b64_tr_b16 v[92:93], v7 offset:4096
    s_sub_u32 s70, s70, 1
    s_cmp_lg_u32 s70, 0
    v_mfma_f32_16x16x32_bf16 v[192:195], v[96:99], v[48:51], v[192:195]
    ds_read_b64_tr_b16 v[94:95], v7 offset:4608
    s_cbranch_scc1 cl_171
    s_sub_u32 s75, s75, 1
    s_cmp_lt_u32 s75, 2
    s_cbranch_scc1 hka_168
    s_mul_i32 s70, s7, 8
    s_add_u32 s70, s70, 1
    buffer_store_dword v254, v13, s[16:19], s83 offen sc1
    v_lshlrev_b32_e64 v252, 2, v0
    buffer_store_dword v253, v252, s[16:19], s61 offen sc1
    s_branch cl_171
hka_168:
    s_cmp_eq_u32 s75, 0
    s_cbranch_scc1 hkb_169
    s_mov_b32 s70, 1
    s_waitcnt vmcnt(0)
    s_branch cl_171
hkb_169:
    s_mov_b32 s70, 8
    s_cmp_lg_u32 s6, 0
    s_cbranch_scc1 cl_171
    s_mov_b32 s20, s42
    s_mov_b32 s21, s43
    s_nop 0
    s_mov_b32 s22, 256
    s_mov_b32 s23, 0x20000
    s_lshl_b32 s48, s5, 5
    v_mov_b32 v254, s87
    buffer_atomic_add v254, v13, s[20:23], s48 offen sc1
    s_branch cl_171
    .p2align 5
tail_172:
    v_mfma_f32_16x16x32_bf16 v[176:179], v[88:91], v[48:51], v[176:179]
    ds_read_b64_tr_b16 v[80:81], v6 offset:0
    v_mfma_f32_16x16x32_bf16 v[176:179], v[92:95], v[52:55], v[176:179]
    ds_read_b64_tr_b16 v[82:83], v6 offset:512
    v_mfma_f32_16x16x32_bf16 v[180:183], v[92:95], v[60:63], v[180:183]
    ds_read_b64_tr_b16 v[84:85], v6 offset:4096
    v_mfma_f32_16x16x32_bf16 v[180:183], v[88:91], v[56:59], v[180:183]
    ds_read_b64_tr_b16 v[86:87], v6 offset:4608
    v_mfma_f32_16x16x32_bf16 v[184:187], v[88:91], v[64:67], v[184:187]
    ds_read_b128 v[16:19], v4 offset:0
    v_mfma_f32_16x16x32_bf16 v[184:187], v[92:95], v[68:71], v[184:187]
    ds_read_b128 v[20:23], v5 offset:0
    v_mfma_f32_16x16x32_bf16 v[188:191], v[92:95], v[76:79], v[188:191]
    ds_read_b128 v[24:27], v4 offset:2048
    v_mfma_f32_16x16x32_bf16 v[188:191], v[88:91], v[72:75], v[188:191]
    ds_read_b128 v[28:31], v5 offset:2048
    v_mfma_f32_16x16x32_bf16 v[204:207], v[96:99], v[72:75], v[204:207]
    ds_read_b128 v[32:35], v4 offset:4096
    v_mfma_f32_16x16x32_bf16 v[204:207], v[100:103], v[76:79], v[204:207]
    ds_read_b128 v[36:39], v5 offset:4096
    v_mfma_f32_16x16x32_bf16 v[200:203], v[100:103], v[68:71], v[200:203]
    ds_read_b128 v[40:43], v4 offset:6144
    v_mfma_f32_16x16x32_bf16 v[200:203], v[96:99], v[64:67], v[200:203]
    ds_read_b128 v[44:47], v5 offset:6144
    v_mfma_f32_16x16x32_bf16 v[196:199], v[96:99], v[56:59], v[196:199]
    ds_read_b64_tr_b16 v[88:89], v7 offset:0
    v_mfma_f32_16x16x32_bf16 v[196:199], v[100:103], v[60:63], v[196:199]
    ds_read_b64_tr_b16 v[90:91], v7 offset:512
    v_mfma_f32_16x16x32_bf16 v[192:195], v[100:103], v[52:55], v[192:195]
    ds_read_b64_tr_b16 v[92:93], v7 offset:4096
    v_mfma_f32_16x16x32_bf16 v[192:195], v[96:99], v[48:51], v[192:195]
    ds_read_b64_tr_b16 v[94:95], v7 offset:4608
    s_waitcnt lgkmcnt(4)
    s_nop 0
    v_mfma_f32_16x16x32_bf16 v[112:115], v[16:19], v[80:83], v[112:115]
    ds_read_b64_tr_b16 v[96:97], v6 offset:8192
    v_mfma_f32_16x16x32_bf16 v[112:115], v[20:23], v[84:87], v[112:115]
    ds_read_b64_tr_b16 v[98:99], v6 offset:8704
    v_mfma_f32_16x16x32_bf16 v[116:119], v[28:31], v[84:87], v[116:119]
    ds_read_b64_tr_b16 v[100:101], v6 offset:12288
    v_mfma_f32_16x16x32_bf16 v[116:119], v[24:27], v[80:83], v[116:119]
    ds_read_b64_tr_b16 v[102:103], v6 offset:12800
    v_mfma_f32_16x16x32_bf16 v[120:123], v[32:35], v[80:83], v[120:123]
    v_mfma_f32_16x16x32_bf16 v[120:123], v[36:39], v[84:87], v[120:123]
    v_mfma_f32_16x16x32_bf16 v[124:127], v[44:47], v[84:87], v[124:127]
    v_mfma_f32_16x16x32_bf16 v[124:127], v[40:43], v[80:83], v[124:127]
    s_waitcnt lgkmcnt(4)
    s_nop 0
    v_mfma_f32_16x16x32_bf16 v[140:143], v[40:43], v[88:91], v[140:143]
    ds_read_b64_tr_b16 v[80:81], v7 offset:8192
    v_mfma_f32_16x16x32_bf16 v[140:143], v[44:47], v[92:95], v[140:143]
    ds_read_b64_tr_b16 v[82:83], v7 offset:8704
    v_mfma_f32_16x16x32_bf16 v[136:139], v[36:39], v[92:95], v[136:139]
    ds_read_b64_tr_b16 v[84:85], v7 offset:12288
    v_mfma_f32_16x16x32_bf16 v[136:139], v[32:35], v[88:91], v[136:139]
    ds_read_b64_tr_b16 v[86:87], v7 offset:12800
    v_mfma_f32_16x16x32_bf16 v[132:135], v[24:27], v[88:91], v[132:135]
    v_add_u32 v4, s64, v4
    v_add_u32 v5, s64, v5
    v_mfma_f32_16x16x32_bf16 v[132:135], v[28:31], v[92:95], v[132:135]
    v_add_u32 v6, s65, v6
    v_add_u32 v7, s65, v7
    v_mfma_f32_16x16x32_bf16 v[128:131], v[20:23], v[92:95], v[128:131]
    v_mfma_f32_16x16x32_bf16 v[128:131], v[16:19], v[88:91], v[128:131]
    s_waitcnt lgkmcnt(0)
    s_barrier
    v_mfma_f32_16x16x32_bf16 v[144:147], v[16:19], v[96:99], v[144:147]
    ds_read_b64_tr_b16 v[88:89], v6 offset:0
    v_mfma_f32_16x16x32_bf16 v[144:147], v[20:23], v[100:103], v[144:147]
    ds_read_b64_tr_b16 v[90:91], v6 offset:512
    v_mfma_f32_16x16x32_bf16 v[148:151], v[28:31], v[100:103], v[148:151]
    ds_read_b64_tr_b16 v[92:93], v6 offset:4096
    v_mfma_f32_16x16x32_bf16 v[148:151], v[24:27], v[96:99], v[148:151]
    ds_read_b64_tr_b16 v[94:95], v6 offset:4608
    v_mfma_f32_16x16x32_bf16 v[152:155], v[32:35], v[96:99], v[152:155]
    ds_read_b128 v[48:51], v4 offset:0
    v_mfma_f32_16x16x32_bf16 v[152:155], v[36:39], v[100:103], v[152:155]
    ds_read_b128 v[52:55], v5 offset:0
    v_mfma_f32_16x16x32_bf16 v[156:159], v[44:47], v[100:103], v[156:159]
    ds_read_b128 v[56:59], v4 offset:2048
    v_mfma_f32_16x16x32_bf16 v[156:159], v[40:43], v[96:99], v[156:159]
    ds_read_b128 v[60:63], v5 offset:2048
    v_mfma_f32_16x16x32_bf16 v[172:175], v[40:43], v[80:83], v[172:175]
    ds_read_b128 v[64:67], v4 offset:4096
    v_mfma_f32_16x16x32_bf16 v[172:175], v[44:47], v[84:87], v[172:175]
    ds_read_b128 v[68:71], v5 offset:4096
    v_mfma_f32_16x16x32_bf16 v[168:171], v[36:39], v[84:87], v[168:171]
    ds_read_b128 v[72:75], v4 offset:6144
    v_mfma_f32_16x16x32_bf16 v[168:171], v[32:35], v[80:83], v[168:171]
    ds_read_b128 v[76:79], v5 offset:6144
    v_mfma_f32_16x16x32_bf16 v[164:167], v[24:27], v[80:83], v[164:167]
    ds_read_b64_tr_b16 v[96:97], v7 offset:0
    v_mfma_f32_16x16x32_bf16 v[164:167], v[28:31], v[84:87], v[164:167]
    ds_read_b64_tr_b16 v[98:99], v7 offset:512
    v_mfma_f32_16x16x32_bf16 v[160:163], v[20:23], v[84:87], v[160:163]
    ds_read_b64_tr_b16 v[100:101], v7 offset:4096
    v_mfma_f32_16x16x32_bf16 v[160:163], v[16:19], v[80:83], v[160:163]
    ds_read_b64_tr_b16 v[102:103], v7 offset:4608
    s_waitcnt lgkmcnt(4)
    s_nop 0
    v_mfma_f32_16x16x32_bf16 v[112:115], v[48:51], v[88:91], v[112:115]
    ds_read_b64_tr_b16 v[80:81], v6 offset:8192
    v_mfma_f32_16x16x32_bf16 v[112:115], v[52:55], v[92:95], v[112:115]
    ds_read_b64_tr_b16 v[82:83], v6 offset:8704
    v_mfma_f32_16x16x32_bf16 v[116:119], v[60:63], v[92:95], v[116:119]
    ds_read_b64_tr_b16 v[84:85], v6 offset:12288
    v_mfma_f32_16x16x32_bf16 v[116:119], v[56:59], v[88:91], v[116:119]
    ds_read_b64_tr_b16 v[86:87], v6 offset:12800
    v_mfma_f32_16x16x32_bf16 v[120:123], v[64:67], v[88:91], v[120:123]
    v_mfma_f32_16x16x32_bf16 v[120:123], v[68:71], v[92:95], v[120:123]
    v_mfma_f32_16x16x32_bf16 v[124:127], v[76:79], v[92:95], v[124:127]
    v_mfma_f32_16x16x32_bf16 v[124:127], v[72:75], v[88:91], v[124:127]
    s_waitcnt lgkmcnt(4)
    s_nop 0
    v_mfma_f32_16x16x32_bf16 v[140:143], v[72:75], v[96:99], v[140:143]
    ds_read_b64_tr_b16 v[88:89], v7 offset:8192
    v_mfma_f32_16x16x32_bf16 v[140:143], v[76:79], v[100:103], v[140:143]
    ds_read_b64_tr_b16 v[90:91], v7 offset:8704
    v_mfma_f32_16x16x32_bf16 v[136:139], v[68:71], v[100:103], v[136:139]
    ds_read_b64_tr_b16 v[92:93], v7 offset:12288
    v_mfma_f32_16x16x32_bf16 v[136:139], v[64:67], v[96:99], v[136:139]
    ds_read_b64_tr_b16 v[94:95], v7 offset:12800
    v_mfma_f32_16x16x32_bf16 v[132:135], v[56:59], v[96:99], v[132:135]
    v_mfma_f32_16x16x32_bf16 v[132:135], v[60:63], v[100:103], v[132:135]
    v_mfma_f32_16x16x32_bf16 v[128:131], v[52:55], v[100:103], v[128:131]
    v_mfma_f32_16x16x32_bf16 v[128:131], v[48:51], v[96:99], v[128:131]
    s_waitcnt lgkmcnt(0)
    s_barrier
    v_mfma_f32_16x16x32_bf16 v[144:147], v[48:51], v[80:83], v[144:147]
    ds_read_b32 v96, v107 offset:0
    ds_read_b32 v98, v107 offset:64
    ds_read_b32 v100, v107 offset:256
    ds_read_b32 v102, v107 offset:320
    v_mfma_f32_16x16x32_bf16 v[144:147], v[52:55], v[84:87], v[144:147]
    ds_read_b128 v[32:35], v106 offset:512
    ds_read_b128 v[16:19], v106 offset:0
    ds_read_b128 v[36:39], v106 offset:576
    ds_read_b128 v[20:23], v106 offset:64
    v_mfma_f32_16x16x32_bf16 v[148:151], v[60:63], v[84:87], v[148:151]
    ds_read_b128 v[40:43], v106 offset:640
    ds_read_b128 v[24:27], v106 offset:128
    ds_read_b128 v[44:47], v106 offset:704
    ds_read_b128 v[28:31], v106 offset:192
    v_mfma_f32_16x16x32_bf16 v[148:151], v[56:59], v[80:83], v[148:151]
    ds_read_b32 v111, v110
    s_mov_b32 s88, 0x3fb8aa3b
    s_mov_b32 s89, 0xb5c1a2a0
    s_mov_b32 s90, 0x358637bd
    v_mfma_f32_16x16x32_bf16 v[152:155], v[64:67], v[80:83], v[152:155]
    s_mov_b32 s91, 0
    s_nop 0
    s_mul_i32 s48, s6, 3072
    s_add_u32 s48, s48, 49152
    s_xor_b32 s49, s6, 2
    s_nop 0
    v_mfma_f32_16x16x32_bf16 v[152:155], v[68:71], v[84:87], v[152:155]
    s_mul_i32 s49, s49, 3072
    s_add_u32 s49, s49, 49152
    v_lshl_add_u32 v208, v0, 4, s48
    v_lshl_add_u32 v209, v0, 4, s49
    v_mfma_f32_16x16x32_bf16 v[156:159], v[76:79], v[84:87], v[156:159]
    s_lshl_b32 s48, s7, 20
    s_lshl_b32 s49, s4, 16
    v_lshlrev_b32 v210, 4, v0
    s_add_u32 s48, s48, s49
    v_mfma_f32_16x16x32_bf16 v[156:159], v[72:75], v[80:83], v[156:159]
    s_lshl_b32 s49, s46, 15
    v_and_b32 v211, 15, v0
    s_add_u32 s48, s48, s49
    s_lshl_b32 s49, s45, 14
    v_mfma_f32_16x16x32_bf16 v[172:175], v[72:75], v[88:91], v[172:175]
    v_cmp_eq_u32 vcc, 0, v211
    s_add_u32 s48, s48, s49
    s_lshl_b32 s49, s3, 10
    s_nop 0
    v_mov_b32 v211, 268435456
    v_mfma_f32_16x16x32_bf16 v[172:175], v[76:79], v[92:95], v[172:175]
    s_add_u32 s48, s48, s49
    s_lshr_b32 s49, s48, 4
    v_cndmask_b32_e64 v211, v211, v0, vcc
    s_add_u32 s48, s48, 3145728
    v_mfma_f32_16x16x32_bf16 v[168:171], v[68:71], v[92:95], v[168:171]
    s_add_u32 s49, s49, 5242880
    v_mov_b32 v248, 0x3f803f80
    v_mov_b32 v249, 0x3f803f80
    v_mov_b32 v250, 0x3f803f80
    v_mfma_f32_16x16x32_bf16 v[168:171], v[64:67], v[88:91], v[168:171]
    v_mov_b32 v251, 0x3f803f80
    v_mov_b32 v212, v108
    v_mov_b32 v213, v109
    v_mfma_f32_16x16x32_bf16 v[164:167], v[56:59], v[88:91], v[164:167]
    v_mfma_f32_16x16x32_bf16 v[164:167], v[60:63], v[92:95], v[164:167]
    v_mfma_f32_16x16x32_bf16 v[160:163], v[52:55], v[92:95], v[160:163]
    v_mfma_f32_16x16x32_bf16 v[160:163], v[48:51], v[88:91], v[160:163]
    s_waitcnt lgkmcnt(0)
    v_readfirstlane_b32 s30, v111
    s_nop 0
    s_and_b32 s44, s30, 1
    s_lshr_b32 s30, s30, 1
    s_nop 0
    v_pk_fma_f32 v[104:105], v[32:33], v[96:97], s[90:91] op_sel_hi:[1,0,0]
    v_pk_fma_f32 v[106:107], v[34:35], v[96:97], s[90:91] op_sel_hi:[1,0,0]
    v_pk_fma_f32 v[108:109], v[32:33], v[98:99], s[90:91] op_sel_hi:[1,0,0]
    v_pk_fma_f32 v[110:111], v[34:35], v[98:99], s[90:91] op_sel_hi:[1,0,0]
    v_pk_fma_f32 v[112:113], v[112:113], v[16:17], v[104:105]
    v_pk_fma_f32 v[114:115], v[114:115], v[18:19], v[106:107]
    v_pk_fma_f32 v[128:129], v[128:129], v[16:17], v[108:109]
    v_pk_fma_f32 v[130:131], v[130:131], v[18:19], v[110:111]
    v_pk_fma_f32 v[104:105], v[112:113], s[88:89], s[88:89] op_sel:[0,0,1] op_sel_hi:[1,0,1]
    v_pk_fma_f32 v[106:107], v[114:115], s[88:89], s[88:89] op_sel:[0,0,1] op_sel_hi:[1,0,1]
    v_pk_fma_f32 v[108:109], v[128:129], s[88:89], s[88:89] op_sel:[0,0,1] op_sel_hi:[1,0,1]
    v_pk_fma_f32 v[110:111], v[130:131], s[88:89], s[88:89] op_sel:[0,0,1] op_sel_hi:[1,0,1]
    v_max_f32 v112, s90, v112
    v_max_f32 v114, s90, v114
    v_max_f32 v128, s90, v128
    v_max_f32 v130, s90, v130
    v_max_f32 v113, s90, v113
    v_max_f32 v115, s90, v115
    v_max_f32 v129, s90, v129
    v_max_f32 v131, s90, v131
    v_exp_f32 v104, v104 clamp
    v_exp_f32 v106, v106 clamp
    v_exp_f32 v108, v108 clamp
    v_exp_f32 v110, v110 clamp
    v_exp_f32 v105, v105 clamp
    v_exp_f32 v107, v107 clamp
    v_exp_f32 v109, v109 clamp
    v_exp_f32 v111, v111 clamp
    v_pk_add_f32 v[112:113], v[112:113], v[104:105]
    v_pk_add_f32 v[114:115], v[114:115], v[106:107]
    v_pk_add_f32 v[128:129], v[128:129], v[108:109]
    v_pk_add_f32 v[130:131], v[130:131], v[110:111]
    v_cvt_pk_bf16_f32 v48, v112, v113
    v_cvt_pk_bf16_f32 v49, v114, v115
    v_cvt_pk_bf16_f32 v56, v128, v129
    v_cvt_pk_bf16_f32 v57, v130, v131
    v_pk_mul_f32 v[104:105], v[32:33], v[100:101] op_sel_hi:[1,0]
    v_pk_mul_f32 v[106:107], v[34:35], v[100:101] op_sel_hi:[1,0]
    v_pk_mul_f32 v[108:109], v[32:33], v[102:103] op_sel_hi:[1,0]
    v_pk_mul_f32 v[110:111], v[34:35], v[102:103] op_sel_hi:[1,0]
    v_pk_fma_f32 v[144:145], v[144:145], v[16:17], v[104:105]
    v_pk_fma_f32 v[146:147], v[146:147], v[18:19], v[106:107]
    v_pk_fma_f32 v[160:161], v[160:161], v[16:17], v[108:109]
    v_pk_fma_f32 v[162:163], v[162:163], v[18:19], v[110:111]
    v_cvt_pk_bf16_f32 v80, v144, v145
    v_cvt_pk_bf16_f32 v81, v146, v147
    v_cvt_pk_bf16_f32 v88, v160, v161
    v_cvt_pk_bf16_f32 v89, v162, v163
    v_pk_fma_f32 v[104:105], v[36:37], v[96:97], s[90:91] op_sel_hi:[1,0,0]
    v_pk_fma_f32 v[106:107], v[38:39], v[96:97], s[90:91] op_sel_hi:[1,0,0]
    v_pk_fma_f32 v[108:109], v[36:37], v[98:99], s[90:91] op_sel_hi:[1,0,0]
    v_pk_fma_f32 v[110:111], v[38:39], v[98:99], s[90:91] op_sel_hi:[1,0,0]
    v_pk_fma_f32 v[116:117], v[116:117], v[20:21], v[104:105]
    v_pk_fma_f32 v[118:119], v[118:119], v[22:23], v[106:107]
    v_pk_fma_f32 v[132:133], v[132:133], v[20:21], v[108:109]
    v_pk_fma_f32 v[134:135], v[134:135], v[22:23], v[110:111]
    v_pk_fma_f32 v[104:105], v[116:117], s[88:89], s[88:89] op_sel:[0,0,1] op_sel_hi:[1,0,1]
    v_pk_fma_f32 v[106:107], v[118:119], s[88:89], s[88:89] op_sel:[0,0,1] op_sel_hi:[1,0,1]
    v_pk_fma_f32 v[108:109], v[132:133], s[88:89], s[88:89] op_sel:[0,0,1] op_sel_hi:[1,0,1]
    v_pk_fma_f32 v[110:111], v[134:135], s[88:89], s[88:89] op_sel:[0,0,1] op_sel_hi:[1,0,1]
    v_max_f32 v116, s90, v116
    v_max_f32 v118, s90, v118
    v_max_f32 v132, s90, v132
    v_max_f32 v134, s90, v134
    v_max_f32 v117, s90, v117
    v_max_f32 v119, s90, v119
    v_max_f32 v133, s90, v133
    v_max_f32 v135, s90, v135
    v_exp_f32 v104, v104 clamp
    v_exp_f32 v106, v106 clamp
    v_exp_f32 v108, v108 clamp
    v_exp_f32 v110, v110 clamp
    v_exp_f32 v105, v105 clamp
    v_exp_f32 v107, v107 clamp
    v_exp_f32 v109, v109 clamp
    v_exp_f32 v111, v111 clamp
    v_pk_add_f32 v[116:117], v[116:117], v[104:105]
    v_pk_add_f32 v[118:119], v[118:119], v[106:107]
    v_pk_add_f32 v[132:133], v[132:133], v[108:109]
    v_pk_add_f32 v[134:135], v[134:135], v[110:111]
    v_cvt_pk_bf16_f32 v50, v116, v117
    v_cvt_pk_bf16_f32 v51, v118, v119
    v_cvt_pk_bf16_f32 v58, v132, v133
    v_cvt_pk_bf16_f32 v59, v134, v135
    v_pk_mul_f32 v[104:105], v[36:37], v[100:101] op_sel_hi:[1,0]
    v_pk_mul_f32 v[106:107], v[38:39], v[100:101] op_sel_hi:[1,0]
    v_pk_mul_f32 v[108:109], v[36:37], v[102:103] op_sel_hi:[1,0]
    v_pk_mul_f32 v[110:111], v[38:39], v[102:103] op_sel_hi:[1,0]
    v_pk_fma_f32 v[148:149], v[148:149], v[20:21], v[104:105]
    v_pk_fma_f32 v[150:151], v[150:151], v[22:23], v[106:107]
    v_pk_fma_f32 v[164:165], v[164:165], v[20:21], v[108:109]
    v_pk_fma_f32 v[166:167], v[166:167], v[22:23], v[110:111]
    v_cvt_pk_bf16_f32 v82, v148, v149
    v_cvt_pk_bf16_f32 v83, v150, v151
    v_cvt_pk_bf16_f32 v90, v164, v165
    v_cvt_pk_bf16_f32 v91, v166, v167
    v_pk_fma_f32 v[104:105], v[40:41], v[96:97], s[90:91] op_sel_hi:[1,0,0]
    v_pk_fma_f32 v[106:107], v[42:43], v[96:97], s[90:91] op_sel_hi:[1,0,0]
    v_pk_fma_f32 v[108:109], v[40:41], v[98:99], s[90:91] op_sel_hi:[1,0,0]
    v_pk_fma_f32 v[110:111], v[42:43], v[98:99], s[90:91] op_sel_hi:[1,0,0]
    v_mfma_f32_16x16x32_bf16 v[240:243], v[48:51], v[248:251], 0
    v_pk_fma_f32 v[120:121], v[120:121], v[24:25], v[104:105]
    v_pk_fma_f32 v[122:123], v[122:123], v[26:27], v[106:107]
    v_pk_fma_f32 v[136:137], v[136:137], v[24:25], v[108:109]
    v_pk_fma_f32 v[138:139], v[138:139], v[26:27], v[110:111]
    v_mfma_f32_16x16x32_bf16 v[244:247], v[56:59], v[248:251], 0
    v_pk_fma_f32 v[104:105], v[120:121], s[88:89], s[88:89] op_sel:[0,0,1] op_sel_hi:[1,0,1]
    v_pk_fma_f32 v[106:107], v[122:123], s[88:89], s[88:89] op_sel:[0,0,1] op_sel_hi:[1,0,1]
    v_pk_fma_f32 v[108:109], v[136:137], s[88:89], s[88:89] op_sel:[0,0,1] op_sel_hi:[1,0,1]
    v_pk_fma_f32 v[110:111], v[138:139], s[88:89], s[88:89] op_sel:[0,0,1] op_sel_hi:[1,0,1]
    v_mfma_f32_16x16x32_bf16 v[224:227], v[48:51], v[80:83], 0
    v_max_f32 v120, s90, v120
    v_max_f32 v122, s90, v122
    v_max_f32 v136, s90, v136
    v_max_f32 v138, s90, v138
    v_mfma_f32_16x16x32_bf16 v[228:231], v[56:59], v[80:83], 0
    v_max_f32 v121, s90, v121
    v_max_f32 v123, s90, v123
    v_max_f32 v137, s90, v137
    v_max_f32 v139, s90, v139
    v_mfma_f32_16x16x32_bf16 v[232:235], v[48:51], v[88:91], 0
    v_exp_f32 v104, v104 clamp
    v_exp_f32 v106, v106 clamp
    v_exp_f32 v108, v108 clamp
    v_exp_f32 v110, v110 clamp
    v_mfma_f32_16x16x32_bf16 v[236:239], v[56:59], v[88:91], 0
    v_exp_f32 v105, v105 clamp
    v_exp_f32 v107, v107 clamp
    v_exp_f32 v109, v109 clamp
    v_exp_f32 v111, v111 clamp
    v_pk_add_f32 v[120:121], v[120:121], v[104:105]
    v_pk_add_f32 v[122:123], v[122:123], v[106:107]
    v_pk_add_f32 v[136:137], v[136:137], v[108:109]
    v_pk_add_f32 v[138:139], v[138:139], v[110:111]
    v_cvt_pk_bf16_f32 v52, v120, v121
    v_cvt_pk_bf16_f32 v53, v122, v123
    v_cvt_pk_bf16_f32 v60, v136, v137
    v_cvt_pk_bf16_f32 v61, v138, v139
    v_pk_mul_f32 v[104:105], v[40:41], v[100:101] op_sel_hi:[1,0]
    v_pk_mul_f32 v[106:107], v[42:43], v[100:101] op_sel_hi:[1,0]
    v_pk_mul_f32 v[108:109], v[40:41], v[102:103] op_sel_hi:[1,0]
    v_pk_mul_f32 v[110:111], v[42:43], v[102:103] op_sel_hi:[1,0]
    v_pk_fma_f32 v[152:153], v[152:153], v[24:25], v[104:105]
    v_pk_fma_f32 v[154:155], v[154:155], v[26:27], v[106:107]
    v_pk_fma_f32 v[168:169], v[168:169], v[24:25], v[108:109]
    v_pk_fma_f32 v[170:171], v[170:171], v[26:27], v[110:111]
    v_cvt_pk_bf16_f32 v84, v152, v153
    v_cvt_pk_bf16_f32 v85, v154, v155
    v_cvt_pk_bf16_f32 v92, v168, v169
    v_cvt_pk_bf16_f32 v93, v170, v171
    v_pk_fma_f32 v[104:105], v[44:45], v[96:97], s[90:91] op_sel_hi:[1,0,0]
    v_pk_fma_f32 v[106:107], v[46:47], v[96:97], s[90:91] op_sel_hi:[1,0,0]
    v_pk_fma_f32 v[108:109], v[44:45], v[98:99], s[90:91] op_sel_hi:[1,0,0]
    v_pk_fma_f32 v[110:111], v[46:47], v[98:99], s[90:91] op_sel_hi:[1,0,0]
    v_pk_fma_f32 v[124:125], v[124:125], v[28:29], v[104:105]
    v_pk_fma_f32 v[126:127], v[126:127], v[30:31], v[106:107]
    v_pk_fma_f32 v[140:141], v[140:141], v[28:29], v[108:109]
    v_pk_fma_f32 v[142:143], v[142:143], v[30:31], v[110:111]
    v_pk_fma_f32 v[104:105], v[124:125], s[88:89], s[88:89] op_sel:[0,0,1] op_sel_hi:[1,0,1]
    v_pk_fma_f32 v[106:107], v[126:127], s[88:89], s[88:89] op_sel:[0,0,1] op_sel_hi:[1,0,1]
    v_pk_fma_f32 v[108:109], v[140:141], s[88:89], s[88:89] op_sel:[0,0,1] op_sel_hi:[1,0,1]
    v_pk_fma_f32 v[110:111], v[142:143], s[88:89], s[88:89] op_sel:[0,0,1] op_sel_hi:[1,0,1]
    v_max_f32 v124, s90, v124
    v_max_f32 v126, s90, v126
    v_max_f32 v140, s90, v140
    v_max_f32 v142, s90, v142
    v_max_f32 v125, s90, v125
    v_max_f32 v127, s90, v127
    v_max_f32 v141, s90, v141
    v_max_f32 v143, s90, v143
    v_exp_f32 v104, v104 clamp
    v_exp_f32 v106, v106 clamp
    v_exp_f32 v108, v108 clamp
    v_exp_f32 v110, v110 clamp
    v_exp_f32 v105, v105 clamp
    v_exp_f32 v107, v107 clamp
    v_exp_f32 v109, v109 clamp
    v_exp_f32 v111, v111 clamp
    v_pk_add_f32 v[124:125], v[124:125], v[104:105]
    v_pk_add_f32 v[126:127], v[126:127], v[106:107]
    v_pk_add_f32 v[140:141], v[140:141], v[108:109]
    v_pk_add_f32 v[142:143], v[142:143], v[110:111]
    v_cvt_pk_bf16_f32 v54, v124, v125
    v_cvt_pk_bf16_f32 v55, v126, v127
    v_cvt_pk_bf16_f32 v62, v140, v141
    v_cvt_pk_bf16_f32 v63, v142, v143
    v_pk_mul_f32 v[104:105], v[44:45], v[100:101] op_sel_hi:[1,0]
    v_pk_mul_f32 v[106:107], v[46:47], v[100:101] op_sel_hi:[1,0]
    v_pk_mul_f32 v[108:109], v[44:45], v[102:103] op_sel_hi:[1,0]
    v_pk_mul_f32 v[110:111], v[46:47], v[102:103] op_sel_hi:[1,0]
    v_mfma_f32_16x16x32_bf16 v[240:243], v[52:55], v[248:251], v[240:243]
    v_pk_fma_f32 v[156:157], v[156:157], v[28:29], v[104:105]
    v_pk_fma_f32 v[158:159], v[158:159], v[30:31], v[106:107]
    v_pk_fma_f32 v[172:173], v[172:173], v[28:29], v[108:109]
    v_pk_fma_f32 v[174:175], v[174:175], v[30:31], v[110:111]
    v_mfma_f32_16x16x32_bf16 v[244:247], v[60:63], v[248:251], v[244:247]
    v_cvt_pk_bf16_f32 v86, v156, v157
    v_cvt_pk_bf16_f32 v87, v158, v159
    v_cvt_pk_bf16_f32 v94, v172, v173
    v_cvt_pk_bf16_f32 v95, v174, v175
    s_cmp_eq_u32 s45, 0
    s_cbranch_scc0 kvw_177
    v_mfma_f32_16x16x32_bf16 v[232:235], v[52:55], v[92:95], v[232:235]
    v_mfma_f32_16x16x32_bf16 v[236:239], v[60:63], v[92:95], v[236:239]
    v_mfma_f32_16x16x32_bf16 v[224:227], v[52:55], v[84:87], v[224:227]
    v_mfma_f32_16x16x32_bf16 v[228:231], v[60:63], v[84:87], v[228:231]
    ds_write_b128 v208, v[244:247] offset:2048
    s_nop 3
    s_nop 0
    ds_write_b128 v208, v[232:235] offset:0
    ds_write_b128 v208, v[236:239] offset:1024
    s_waitcnt lgkmcnt(0)
    s_barrier
    ds_read_b128 v[16:19], v209 offset:0
    ds_read_b128 v[20:23], v209 offset:1024
    ds_read_b128 v[24:27], v209 offset:2048
    s_waitcnt lgkmcnt(2)
    s_nop 0
    v_pk_add_f32 v[16:17], v[16:17], v[224:225]
    v_pk_add_f32 v[18:19], v[18:19], v[226:227]
    s_waitcnt lgkmcnt(1)
    s_nop 0
    v_pk_add_f32 v[20:21], v[20:21], v[228:229]
    v_pk_add_f32 v[22:23], v[22:23], v[230:231]
    s_waitcnt lgkmcnt(0)
    s_nop 0
    v_pk_add_f32 v[24:25], v[24:25], v[240:241]
    v_pk_add_f32 v[26:27], v[26:27], v[242:243]
    s_branch kvx_178
kvw_177:
    s_nop 0
    v_mfma_f32_16x16x32_bf16 v[224:227], v[52:55], v[84:87], v[224:227]
    v_mfma_f32_16x16x32_bf16 v[228:231], v[60:63], v[84:87], v[228:231]
    v_mfma_f32_16x16x32_bf16 v[232:235], v[52:55], v[92:95], v[232:235]
    v_mfma_f32_16x16x32_bf16 v[236:239], v[60:63], v[92:95], v[236:239]
    ds_write_b128 v208, v[240:243] offset:2048
    s_nop 3
    s_nop 0
    ds_write_b128 v208, v[224:227] offset:0
    ds_write_b128 v208, v[228:231] offset:1024
    s_waitcnt lgkmcnt(0)
    s_barrier
    ds_read_b128 v[16:19], v209 offset:0
    ds_read_b128 v[20:23], v209 offset:1024
    ds_read_b128 v[24:27], v209 offset:2048
    s_waitcnt lgkmcnt(2)
    s_nop 0
    v_pk_add_f32 v[16:17], v[16:17], v[232:233]
    v_pk_add_f32 v[18:19], v[18:19], v[234:235]
    s_waitcnt lgkmcnt(1)
    s_nop 0
    v_pk_add_f32 v[20:21], v[20:21], v[236:237]
    v_pk_add_f32 v[22:23], v[22:23], v[238:239]
    s_waitcnt lgkmcnt(0)
    s_nop 0
    v_pk_add_f32 v[24:25], v[24:25], v[244:245]
    v_pk_add_f32 v[26:27], v[26:27], v[246:247]
kvx_178:
    v_cvt_pk_bf16_f32 v32, v16, v17
    v_cvt_pk_bf16_f32 v33, v18, v19
    v_cvt_pk_bf16_f32 v34, v20, v21
    v_cvt_pk_bf16_f32 v35, v22, v23
    buffer_store_dwordx4 v[32:35], v210, s[16:19], s48 offen sc1
    buffer_store_dwordx4 v[24:27], v211, s[16:19], s49 offen sc1
    s_barrier
    s_nop 0
    v_add_u32 v208, 57344, v6
    v_add_u32 v209, 57344, v7
    ds_read_b64_tr_b16 v[80:81], v208 offset:16384
    ds_read_b64_tr_b16 v[82:83], v208 offset:16896
    ds_read_b64_tr_b16 v[84:85], v208 offset:20480
    ds_read_b64_tr_b16 v[86:87], v208 offset:20992
    ds_read_b128 v[16:19], v4 offset:32768
    ds_read_b128 v[20:23], v5 offset:32768
    ds_read_b128 v[24:27], v4 offset:34816
    ds_read_b128 v[28:31], v5 offset:34816
    ds_read_b128 v[32:35], v4 offset:36864
    ds_read_b128 v[36:39], v5 offset:36864
    ds_read_b128 v[40:43], v4 offset:38912
    ds_read_b128 v[44:47], v5 offset:38912
    ds_read_b64_tr_b16 v[88:89], v209 offset:16384
    ds_read_b64_tr_b16 v[90:91], v209 offset:16896
    ds_read_b64_tr_b16 v[92:93], v209 offset:20480
    ds_read_b64_tr_b16 v[94:95], v209 offset:20992
    s_waitcnt lgkmcnt(0)
    s_nop 0
    v_mfma_f32_16x16x32_bf16 v[176:179], v[80:83], v[16:19], v[176:179]
    ds_read_b64_tr_b16 v[96:97], v6 offset:16384
    v_mfma_f32_16x16x32_bf16 v[176:179], v[84:87], v[20:23], v[176:179]
    ds_read_b64_tr_b16 v[98:99], v6 offset:16896
    v_mfma_f32_16x16x32_bf16 v[180:183], v[84:87], v[28:31], v[180:183]
    ds_read_b64_tr_b16 v[100:101], v6 offset:20480
    v_mfma_f32_16x16x32_bf16 v[180:183], v[80:83], v[24:27], v[180:183]
    ds_read_b64_tr_b16 v[102:103], v6 offset:20992
    v_mfma_f32_16x16x32_bf16 v[184:187], v[80:83], v[32:35], v[184:187]
    ds_read_b128 v[48:51], v4 offset:0
    v_mfma_f32_16x16x32_bf16 v[184:187], v[84:87], v[36:39], v[184:187]
    ds_read_b128 v[52:55], v5 offset:0
    v_mfma_f32_16x16x32_bf16 v[188:191], v[84:87], v[44:47], v[188:191]
    ds_read_b128 v[56:59], v4 offset:2048
    v_mfma_f32_16x16x32_bf16 v[188:191], v[80:83], v[40:43], v[188:191]
    ds_read_b128 v[60:63], v5 offset:2048
    v_mfma_f32_16x16x32_bf16 v[204:207], v[88:91], v[40:43], v[204:207]
    ds_read_b128 v[64:67], v4 offset:4096
    v_mfma_f32_16x16x32_bf16 v[204:207], v[92:95], v[44:47], v[204:207]
    ds_read_b128 v[68:71], v5 offset:4096
    v_mfma_f32_16x16x32_bf16 v[200:203], v[92:95], v[36:39], v[200:203]
    ds_read_b128 v[72:75], v4 offset:6144
    v_mfma_f32_16x16x32_bf16 v[200:203], v[88:91], v[32:35], v[200:203]
    ds_read_b128 v[76:79], v5 offset:6144
    v_mfma_f32_16x16x32_bf16 v[196:199], v[88:91], v[24:27], v[196:199]
    ds_read_b64_tr_b16 v[104:105], v7 offset:16384
    v_mfma_f32_16x16x32_bf16 v[196:199], v[92:95], v[28:31], v[196:199]
    ds_read_b64_tr_b16 v[106:107], v7 offset:16896
    v_mfma_f32_16x16x32_bf16 v[192:195], v[92:95], v[20:23], v[192:195]
    ds_read_b64_tr_b16 v[108:109], v7 offset:20480
    v_mfma_f32_16x16x32_bf16 v[192:195], v[88:91], v[16:19], v[192:195]
    ds_read_b64_tr_b16 v[110:111], v7 offset:20992
    s_waitcnt lgkmcnt(0)
    s_nop 0
    v_mfma_f32_16x16x32_bf16 v[176:179], v[96:99], v[48:51], v[176:179]
    ds_read2_b32 v[224:225], v212 offset0:0 offset1:128
    v_mfma_f32_16x16x32_bf16 v[176:179], v[100:103], v[52:55], v[176:179]
    ds_read2_b32 v[226:227], v212 offset0:16 offset1:144
    v_mfma_f32_16x16x32_bf16 v[180:183], v[100:103], v[60:63], v[180:183]
    ds_read2_b32 v[228:229], v212 offset0:32 offset1:160
    v_mfma_f32_16x16x32_bf16 v[180:183], v[96:99], v[56:59], v[180:183]
    ds_read2_b32 v[230:231], v212 offset0:48 offset1:176
    v_mfma_f32_16x16x32_bf16 v[184:187], v[96:99], v[64:67], v[184:187]
    ds_read_b128 v[232:235], v213 offset:512
    v_mfma_f32_16x16x32_bf16 v[184:187], v[100:103], v[68:71], v[184:187]
    ds_read_b128 v[236:239], v213 offset:576
    v_mfma_f32_16x16x32_bf16 v[188:191], v[100:103], v[76:79], v[188:191]
    v_mfma_f32_16x16x32_bf16 v[188:191], v[96:99], v[72:75], v[188:191]
    v_mfma_f32_16x16x32_bf16 v[204:207], v[104:107], v[72:75], v[204:207]
    v_mfma_f32_16x16x32_bf16 v[204:207], v[108:111], v[76:79], v[204:207]
    v_mfma_f32_16x16x32_bf16 v[200:203], v[108:111], v[68:71], v[200:203]
    v_mfma_f32_16x16x32_bf16 v[200:203], v[104:107], v[64:67], v[200:203]
    v_mfma_f32_16x16x32_bf16 v[196:199], v[104:107], v[56:59], v[196:199]
    v_mfma_f32_16x16x32_bf16 v[196:199], v[108:111], v[60:63], v[196:199]
    v_mfma_f32_16x16x32_bf16 v[192:195], v[108:111], v[52:55], v[192:195]
    v_mfma_f32_16x16x32_bf16 v[192:195], v[104:107], v[48:51], v[192:195]
    s_waitcnt lgkmcnt(0)
    s_nop 0
    v_pk_fma_f32 v[104:105], v[232:233], v[224:225], s[90:91] op_sel:[0,1,0] op_sel_hi:[1,1,0]
    v_pk_fma_f32 v[106:107], v[234:235], v[224:225], s[90:91] op_sel:[0,1,0] op_sel_hi:[1,1,0]
    v_pk_fma_f32 v[108:109], v[236:237], v[224:225], s[90:91] op_sel:[0,1,0] op_sel_hi:[1,1,0]
    v_pk_fma_f32 v[110:111], v[238:239], v[224:225], s[90:91] op_sel:[0,1,0] op_sel_hi:[1,1,0]
    v_pk_fma_f32 v[176:177], v[176:177], v[224:225], v[104:105] op_sel_hi:[1,0,1]
    v_pk_fma_f32 v[178:179], v[178:179], v[224:225], v[106:107] op_sel_hi:[1,0,1]
    s_nop 0
    s_nop 0
    v_pk_fma_f32 v[192:193], v[192:193], v[224:225], v[108:109] op_sel_hi:[1,0,1]
    v_pk_fma_f32 v[194:195], v[194:195], v[224:225], v[110:111] op_sel_hi:[1,0,1]
    v_pk_fma_f32 v[104:105], v[176:177], s[88:89], s[88:89] op_sel:[0,0,1] op_sel_hi:[1,0,1]
    v_pk_fma_f32 v[106:107], v[178:179], s[88:89], s[88:89] op_sel:[0,0,1] op_sel_hi:[1,0,1]
    v_pk_fma_f32 v[108:109], v[192:193], s[88:89], s[88:89] op_sel:[0,0,1] op_sel_hi:[1,0,1]
    v_pk_fma_f32 v[110:111], v[194:195], s[88:89], s[88:89] op_sel:[0,0,1] op_sel_hi:[1,0,1]
    v_max_f32 v176, s90, v176
    v_max_f32 v178, s90, v178
    v_max_f32 v192, s90, v192
    v_max_f32 v194, s90, v194
    v_max_f32 v177, s90, v177
    v_max_f32 v179, s90, v179
    v_max_f32 v193, s90, v193
    v_max_f32 v195, s90, v195
    v_exp_f32 v104, v104 clamp
    v_exp_f32 v106, v106 clamp
    v_exp_f32 v108, v108 clamp
    v_exp_f32 v110, v110 clamp
    v_exp_f32 v105, v105 clamp
    v_exp_f32 v107, v107 clamp
    v_exp_f32 v109, v109 clamp
    v_exp_f32 v111, v111 clamp
    v_pk_add_f32 v[176:177], v[176:177], v[104:105]
    v_pk_add_f32 v[178:179], v[178:179], v[106:107]
    v_pk_add_f32 v[192:193], v[192:193], v[108:109]
    v_pk_add_f32 v[194:195], v[194:195], v[110:111]
    v_cvt_pk_bf16_f32 v208, v176, v177
    v_cvt_pk_bf16_f32 v209, v178, v179
    v_cvt_pk_bf16_f32 v210, v192, v193
    v_cvt_pk_bf16_f32 v211, v194, v195
    v_pk_fma_f32 v[104:105], v[232:233], v[226:227], s[90:91] op_sel:[0,1,0] op_sel_hi:[1,1,0]
    v_pk_fma_f32 v[106:107], v[234:235], v[226:227], s[90:91] op_sel:[0,1,0] op_sel_hi:[1,1,0]
    v_pk_fma_f32 v[108:109], v[236:237], v[226:227], s[90:91] op_sel:[0,1,0] op_sel_hi:[1,1,0]
    v_pk_fma_f32 v[110:111], v[238:239], v[226:227], s[90:91] op_sel:[0,1,0] op_sel_hi:[1,1,0]
    v_pk_fma_f32 v[180:181], v[180:181], v[226:227], v[104:105] op_sel_hi:[1,0,1]
    v_pk_fma_f32 v[182:183], v[182:183], v[226:227], v[106:107] op_sel_hi:[1,0,1]
    v_pk_fma_f32 v[196:197], v[196:197], v[226:227], v[108:109] op_sel_hi:[1,0,1]
    v_pk_fma_f32 v[198:199], v[198:199], v[226:227], v[110:111] op_sel_hi:[1,0,1]
    v_pk_fma_f32 v[104:105], v[180:181], s[88:89], s[88:89] op_sel:[0,0,1] op_sel_hi:[1,0,1]
    v_pk_fma_f32 v[106:107], v[182:183], s[88:89], s[88:89] op_sel:[0,0,1] op_sel_hi:[1,0,1]
    v_pk_fma_f32 v[108:109], v[196:197], s[88:89], s[88:89] op_sel:[0,0,1] op_sel_hi:[1,0,1]
    v_pk_fma_f32 v[110:111], v[198:199], s[88:89], s[88:89] op_sel:[0,0,1] op_sel_hi:[1,0,1]
    v_max_f32 v180, s90, v180
    v_max_f32 v182, s90, v182
    v_max_f32 v196, s90, v196
    v_max_f32 v198, s90, v198
    v_max_f32 v181, s90, v181
    v_max_f32 v183, s90, v183
    v_max_f32 v197, s90, v197
    v_max_f32 v199, s90, v199
    v_exp_f32 v104, v104 clamp
    v_exp_f32 v106, v106 clamp
    v_exp_f32 v108, v108 clamp
    v_exp_f32 v110, v110 clamp
    v_exp_f32 v105, v105 clamp
    v_exp_f32 v107, v107 clamp
    v_exp_f32 v109, v109 clamp
    v_exp_f32 v111, v111 clamp
    v_pk_add_f32 v[180:181], v[180:181], v[104:105]
    v_pk_add_f32 v[182:183], v[182:183], v[106:107]
    v_pk_add_f32 v[196:197], v[196:197], v[108:109]
    v_pk_add_f32 v[198:199], v[198:199], v[110:111]
    v_cvt_pk_bf16_f32 v212, v180, v181
    v_cvt_pk_bf16_f32 v213, v182, v183
    v_cvt_pk_bf16_f32 v214, v196, v197
    v_cvt_pk_bf16_f32 v215, v198, v199
    v_pk_fma_f32 v[104:105], v[232:233], v[228:229], s[90:91] op_sel:[0,1,0] op_sel_hi:[1,1,0]
    v_pk_fma_f32 v[106:107], v[234:235], v[228:229], s[90:91] op_sel:[0,1,0] op_sel_hi:[1,1,0]
    v_pk_fma_f32 v[108:109], v[236:237], v[228:229], s[90:91] op_sel:[0,1,0] op_sel_hi:[1,1,0]
    v_pk_fma_f32 v[110:111], v[238:239], v[228:229], s[90:91] op_sel:[0,1,0] op_sel_hi:[1,1,0]
    v_pk_fma_f32 v[184:185], v[184:185], v[228:229], v[104:105] op_sel_hi:[1,0,1]
    v_pk_fma_f32 v[186:187], v[186:187], v[228:229], v[106:107] op_sel_hi:[1,0,1]
    v_pk_fma_f32 v[200:201], v[200:201], v[228:229], v[108:109] op_sel_hi:[1,0,1]
    v_pk_fma_f32 v[202:203], v[202:203], v[228:229], v[110:111] op_sel_hi:[1,0,1]
    v_pk_fma_f32 v[104:105], v[184:185], s[88:89], s[88:89] op_sel:[0,0,1] op_sel_hi:[1,0,1]
    v_pk_fma_f32 v[106:107], v[186:187], s[88:89], s[88:89] op_sel:[0,0,1] op_sel_hi:[1,0,1]
    v_pk_fma_f32 v[108:109], v[200:201], s[88:89], s[88:89] op_sel:[0,0,1] op_sel_hi:[1,0,1]
    v_pk_fma_f32 v[110:111], v[202:203], s[88:89], s[88:89] op_sel:[0,0,1] op_sel_hi:[1,0,1]
    v_max_f32 v184, s90, v184
    v_max_f32 v186, s90, v186
    v_max_f32 v200, s90, v200
    v_max_f32 v202, s90, v202
    v_max_f32 v185, s90, v185
    v_max_f32 v187, s90, v187
    v_max_f32 v201, s90, v201
    v_max_f32 v203, s90, v203
    v_exp_f32 v104, v104 clamp
    v_exp_f32 v106, v106 clamp
    v_exp_f32 v108, v108 clamp
    v_exp_f32 v110, v110 clamp
    v_exp_f32 v105, v105 clamp
    v_exp_f32 v107, v107 clamp
    v_exp_f32 v109, v109 clamp
    v_exp_f32 v111, v111 clamp
    v_pk_add_f32 v[184:185], v[184:185], v[104:105]
    v_pk_add_f32 v[186:187], v[186:187], v[106:107]
    v_pk_add_f32 v[200:201], v[200:201], v[108:109]
    v_pk_add_f32 v[202:203], v[202:203], v[110:111]
    v_cvt_pk_bf16_f32 v216, v184, v185
    v_cvt_pk_bf16_f32 v217, v186, v187
    v_cvt_pk_bf16_f32 v218, v200, v201
    v_cvt_pk_bf16_f32 v219, v202, v203
    v_pk_fma_f32 v[104:105], v[232:233], v[230:231], s[90:91] op_sel:[0,1,0] op_sel_hi:[1,1,0]
    v_pk_fma_f32 v[106:107], v[234:235], v[230:231], s[90:91] op_sel:[0,1,0] op_sel_hi:[1,1,0]
    v_pk_fma_f32 v[108:109], v[236:237], v[230:231], s[90:91] op_sel:[0,1,0] op_sel_hi:[1,1,0]
    v_pk_fma_f32 v[110:111], v[238:239], v[230:231], s[90:91] op_sel:[0,1,0] op_sel_hi:[1,1,0]
    v_pk_fma_f32 v[188:189], v[188:189], v[230:231], v[104:105] op_sel_hi:[1,0,1]
    v_pk_fma_f32 v[190:191], v[190:191], v[230:231], v[106:107] op_sel_hi:[1,0,1]
    v_pk_fma_f32 v[204:205], v[204:205], v[230:231], v[108:109] op_sel_hi:[1,0,1]
    v_pk_fma_f32 v[206:207], v[206:207], v[230:231], v[110:111] op_sel_hi:[1,0,1]
    v_pk_fma_f32 v[104:105], v[188:189], s[88:89], s[88:89] op_sel:[0,0,1] op_sel_hi:[1,0,1]
    v_pk_fma_f32 v[106:107], v[190:191], s[88:89], s[88:89] op_sel:[0,0,1] op_sel_hi:[1,0,1]
    v_pk_fma_f32 v[108:109], v[204:205], s[88:89], s[88:89] op_sel:[0,0,1] op_sel_hi:[1,0,1]
    v_pk_fma_f32 v[110:111], v[206:207], s[88:89], s[88:89] op_sel:[0,0,1] op_sel_hi:[1,0,1]
    v_max_f32 v188, s90, v188
    v_max_f32 v190, s90, v190
    v_max_f32 v204, s90, v204
    v_max_f32 v206, s90, v206
    v_max_f32 v189, s90, v189
    v_max_f32 v191, s90, v191
    v_max_f32 v205, s90, v205
    v_max_f32 v207, s90, v207
    v_exp_f32 v104, v104 clamp
    v_exp_f32 v106, v106 clamp
    v_exp_f32 v108, v108 clamp
    v_exp_f32 v110, v110 clamp
    v_exp_f32 v105, v105 clamp
    v_exp_f32 v107, v107 clamp
    v_exp_f32 v109, v109 clamp
    v_exp_f32 v111, v111 clamp
    v_pk_add_f32 v[188:189], v[188:189], v[104:105]
    v_pk_add_f32 v[190:191], v[190:191], v[106:107]
    v_pk_add_f32 v[204:205], v[204:205], v[108:109]
    v_pk_add_f32 v[206:207], v[206:207], v[110:111]
    v_cvt_pk_bf16_f32 v220, v188, v189
    v_cvt_pk_bf16_f32 v221, v190, v191
    v_cvt_pk_bf16_f32 v222, v204, v205
    v_cvt_pk_bf16_f32 v223, v206, v207
    s_lshl_b32 s48, s46, 11
    s_nop 0
    s_add_u32 s48, s48, 155968
    v_lshl_add_u32 v105, v0, 4, s48
    s_lshl_b32 s48, s46, 10
    v_add_u32 v107, s48, v9
    v_add_u32 v107, 16384, v107
    s_add_u32 s48, s48, 160064
    v_lshl_add_u32 v106, v0, 4, s48
    s_mul_i32 s48, s3, 1835008
    s_and_b32 s49, s4, 8
    s_lshl_b32 s49, s49, 1
    s_add_u32 s49, s49, s4
    s_lshl_b32 s49, s49, 15
    s_add_u32 s48, s48, s49
    s_nop 0
    s_add_u32 s50, s48, 33554432
    s_add_u32 s51, s50, 4096
    s_barrier
    s_nop 0
    ds_read_b128 v[24:27], v106
    ds_read_b128 v[16:19], v105
    ds_read_b128 v[20:23], v105 offset:1024
    s_waitcnt lgkmcnt(2)
    s_nop 0
    v_mfma_f32_16x16x32_bf16 v[144:147], v[24:27], v[208:211], 0
    v_mfma_f32_16x16x32_bf16 v[148:151], v[24:27], v[212:215], 0
    v_mfma_f32_16x16x32_bf16 v[152:155], v[24:27], v[216:219], 0
    v_mfma_f32_16x16x32_bf16 v[156:159], v[24:27], v[220:223], 0
    s_waitcnt lgkmcnt(0)
    s_nop 0
    v_mfma_f32_16x16x32_bf16 v[112:115], v[16:19], v[208:211], 0
    v_mfma_f32_16x16x32_bf16 v[128:131], v[20:23], v[208:211], 0
    v_mfma_f32_16x16x32_bf16 v[116:119], v[16:19], v[212:215], 0
    v_mfma_f32_16x16x32_bf16 v[132:135], v[20:23], v[212:215], 0
    v_mfma_f32_16x16x32_bf16 v[120:123], v[16:19], v[216:219], 0
    v_mfma_f32_16x16x32_bf16 v[136:139], v[20:23], v[216:219], 0
    v_mfma_f32_16x16x32_bf16 v[124:127], v[16:19], v[220:223], 0
    v_mfma_f32_16x16x32_bf16 v[140:143], v[20:23], v[220:223], 0
    v_add_f32 v144, s90, v144
    v_add_f32 v148, s90, v148
    v_add_f32 v152, s90, v152
    v_add_f32 v156, s90, v156
    v_rcp_f32 v144, v144
    v_rcp_f32 v148, v148
    v_rcp_f32 v152, v152
    v_rcp_f32 v156, v156
    v_pk_mul_f32 v[112:113], v[112:113], v[144:145] op_sel_hi:[1,0]
    v_pk_mul_f32 v[114:115], v[114:115], v[144:145] op_sel_hi:[1,0]
    v_pk_mul_f32 v[128:129], v[128:129], v[144:145] op_sel_hi:[1,0]
    v_pk_mul_f32 v[130:131], v[130:131], v[144:145] op_sel_hi:[1,0]
    v_cvt_pk_bf16_f32 v160, v112, v113
    v_cvt_pk_bf16_f32 v161, v114, v115
    v_cvt_pk_bf16_f32 v162, v128, v129
    v_cvt_pk_bf16_f32 v163, v130, v131
    buffer_store_dwordx4 v[160:163], v1, s[16:19], s50 offen offset:0 sc1
    ds_write_b128 v107, v[160:163] offset:0
    v_pk_mul_f32 v[116:117], v[116:117], v[148:149] op_sel_hi:[1,0]
    v_pk_mul_f32 v[118:119], v[118:119], v[148:149] op_sel_hi:[1,0]
    v_pk_mul_f32 v[132:133], v[132:133], v[148:149] op_sel_hi:[1,0]
    v_pk_mul_f32 v[134:135], v[134:135], v[148:149] op_sel_hi:[1,0]
    v_cvt_pk_bf16_f32 v164, v116, v117
    v_cvt_pk_bf16_f32 v165, v118, v119
    v_cvt_pk_bf16_f32 v166, v132, v133
    v_cvt_pk_bf16_f32 v167, v134, v135
    buffer_store_dwordx4 v[164:167], v1, s[16:19], s50 offen offset:2048 sc1
    ds_write_b128 v107, v[164:167] offset:2048
    v_pk_mul_f32 v[120:121], v[120:121], v[152:153] op_sel_hi:[1,0]
    v_pk_mul_f32 v[122:123], v[122:123], v[152:153] op_sel_hi:[1,0]
    v_pk_mul_f32 v[136:137], v[136:137], v[152:153] op_sel_hi:[1,0]
    v_pk_mul_f32 v[138:139], v[138:139], v[152:153] op_sel_hi:[1,0]
    v_cvt_pk_bf16_f32 v168, v120, v121
    v_cvt_pk_bf16_f32 v169, v122, v123
    v_cvt_pk_bf16_f32 v170, v136, v137
    v_cvt_pk_bf16_f32 v171, v138, v139
    buffer_store_dwordx4 v[168:171], v1, s[16:19], s51 offen offset:0 sc1
    ds_write_b128 v107, v[168:171] offset:4096
    v_pk_mul_f32 v[124:125], v[124:125], v[156:157] op_sel_hi:[1,0]
    v_pk_mul_f32 v[126:127], v[126:127], v[156:157] op_sel_hi:[1,0]
    v_pk_mul_f32 v[140:141], v[140:141], v[156:157] op_sel_hi:[1,0]
    v_pk_mul_f32 v[142:143], v[142:143], v[156:157] op_sel_hi:[1,0]
    v_cvt_pk_bf16_f32 v172, v124, v125
    v_cvt_pk_bf16_f32 v173, v126, v127
    v_cvt_pk_bf16_f32 v174, v140, v141
    v_cvt_pk_bf16_f32 v175, v142, v143
    buffer_store_dwordx4 v[172:175], v1, s[16:19], s51 offen offset:2048 sc1
    ds_write_b128 v107, v[172:175] offset:6144
    s_mov_b32 s86, 0
    s_nop 0
    s_mov_b32 s66, 8192
    s_mov_b32 s67, 24576
    v_add_u32 v4, 16384, v9
    v_add_u32 v5, 17408, v9
    v_mov_b32 v6, v10
    v_mov_b32 v7, v11
    s_mov_b32 s99, 7
    s_mov_b32 s70, 8
    s_mov_b32 s71, 0
    s_nop 0
    s_mov_b32 s64, 0xfffe8000
    s_mov_b32 s65, 0xfffe8000
    s_waitcnt lgkmcnt(0)
    s_barrier
    ds_read_b64_tr_b16 v[80:81], v6 offset:0
    ds_read_b64_tr_b16 v[82:83], v6 offset:512
    ds_read_b64_tr_b16 v[84:85], v6 offset:4096
    ds_read_b64_tr_b16 v[86:87], v6 offset:4608
    ds_read_b128 v[16:19], v4 offset:0
    ds_read_b128 v[20:23], v5 offset:0
    ds_read_b128 v[24:27], v4 offset:2048
    ds_read_b128 v[28:31], v5 offset:2048
    ds_read_b128 v[32:35], v4 offset:4096
    ds_read_b128 v[36:39], v5 offset:4096
    ds_read_b128 v[40:43], v4 offset:6144
    ds_read_b128 v[44:47], v5 offset:6144
    ds_read_b64_tr_b16 v[88:89], v7 offset:0
    ds_read_b64_tr_b16 v[90:91], v7 offset:512
    ds_read_b64_tr_b16 v[92:93], v7 offset:4096
    ds_read_b64_tr_b16 v[94:95], v7 offset:4608
    ds_read_b64 v[144:145], v2 offset:0
    ds_read_b64 v[146:147], v3 offset:0
    ds_read_b64 v[148:149], v2 offset:2048
    ds_read_b64 v[150:151], v3 offset:2048
    ds_read_b64 v[152:153], v2 offset:4096
    ds_read_b64 v[154:155], v3 offset:4096
    ds_read_b64 v[156:157], v2 offset:6144
    ds_read_b64 v[158:159], v3 offset:6144
    s_add_u32 s48, s47, 1
    v_mov_b32 v254, s48
    s_cmp_eq_u32 s44, 0
    s_waitcnt vmcnt(0)
    s_cbranch_scc0 sigs_179
    s_nop 0
    buffer_store_dword v254, v14, s[16:19], 0 offen
sigd_180:
    buffer_store_dword v254, v13, s[16:19], s83 offen sc1
    s_waitcnt lgkmcnt(0)
    v_lshlrev_b32 v112, 16, v144
    v_lshlrev_b32 v114, 16, v145
    v_lshlrev_b32 v128, 16, v146
    v_lshlrev_b32_e64 v130, 16, v147
    v_and_b32 v113, 0xffff0000, v144
    v_and_b32 v115, 0xffff0000, v145
    v_and_b32 v129, 0xffff0000, v146
    v_and_b32 v131, 0xffff0000, v147
    v_lshlrev_b32 v116, 16, v148
    v_lshlrev_b32 v118, 16, v149
    v_lshlrev_b32 v132, 16, v150
    v_lshlrev_b32 v134, 16, v151
    v_and_b32 v117, 0xffff0000, v148
    v_and_b32 v119, 0xffff0000, v149
    v_and_b32 v133, 0xffff0000, v150
    v_and_b32 v135, 0xffff0000, v151
    v_lshlrev_b32 v120, 16, v152
    v_lshlrev_b32 v122, 16, v153
    v_lshlrev_b32 v136, 16, v154
    v_lshlrev_b32 v138, 16, v155
    v_and_b32 v121, 0xffff0000, v152
    v_and_b32 v123, 0xffff0000, v153
    v_and_b32 v137, 0xffff0000, v154
    v_and_b32 v139, 0xffff0000, v155
    v_lshlrev_b32 v124, 16, v156
    v_lshlrev_b32 v126, 16, v157
    v_lshlrev_b32 v140, 16, v158
    v_lshlrev_b32 v142, 16, v159
    v_and_b32 v125, 0xffff0000, v156
    v_and_b32 v127, 0xffff0000, v157
    v_and_b32 v141, 0xffff0000, v158
    v_and_b32 v143, 0xffff0000, v159
L_c_nb2:
    s_lshl_b32 s69, s71, 15
    s_nop 0
    s_mov_b32 s80, 32768
    s_mov_b32 s81, 0x1ffff
    s_add_u32 s71, s71, 1
    s_cmp_eq_u32 s71, 4
    s_cselect_b32 s73, s64, s80
    s_cselect_b32 s71, 0, s71
    s_add_u32 s68, s69, s66
    s_and_b32 s68, s68, s81
    s_sub_u32 s74, s68, s69
    s_mov_b32 s69, s68
    v_add_u32 v4, s73, v4
    v_add_u32 v5, s73, v5
    v_add_u32 v6, s74, v6
    v_add_u32 v7, s74, v7
    .p2align 5
cl_182:
    s_waitcnt lgkmcnt(0)
    s_barrier
    v_mfma_f32_16x16x32_bf16 v[112:115], v[80:83], v[16:19], v[112:115]
    ds_read_b64_tr_b16 v[96:97], v6 offset:0
    ds_read_b64_tr_b16 v[98:99], v6 offset:512
    v_mfma_f32_16x16x32_bf16 v[112:115], v[84:87], v[20:23], v[112:115]
    ds_read_b64_tr_b16 v[100:101], v6 offset:4096
    ds_read_b64_tr_b16 v[102:103], v6 offset:4608
    v_mfma_f32_16x16x32_bf16 v[116:119], v[84:87], v[28:31], v[116:119]
    ds_read_b128 v[48:51], v4 offset:0
    s_add_u32 s71, s71, 1
    s_cmp_eq_u32 s71, 4
    v_mfma_f32_16x16x32_bf16 v[116:119], v[80:83], v[24:27], v[116:119]
    ds_read_b128 v[52:55], v5 offset:0
    v_mfma_f32_16x16x32_bf16 v[120:123], v[80:83], v[32:35], v[120:123]
    ds_read_b128 v[56:59], v4 offset:2048
    s_cselect_b32 s73, s64, s80
    s_cselect_b32 s71, 0, s71
    v_mfma_f32_16x16x32_bf16 v[120:123], v[84:87], v[36:39], v[120:123]
    ds_read_b128 v[60:63], v5 offset:2048
    v_mfma_f32_16x16x32_bf16 v[124:127], v[84:87], v[44:47], v[124:127]
    ds_read_b128 v[64:67], v4 offset:4096
    s_add_u32 s68, s69, s67
    s_and_b32 s68, s68, s81
    v_mfma_f32_16x16x32_bf16 v[124:127], v[80:83], v[40:43], v[124:127]
    ds_read_b128 v[68:71], v5 offset:4096
    v_mfma_f32_16x16x32_bf16 v[140:143], v[88:91], v[40:43], v[140:143]
    ds_read_b128 v[72:75], v4 offset:6144
    s_sub_u32 s74, s68, s69
    s_mov_b32 s69, s68
    v_mfma_f32_16x16x32_bf16 v[140:143], v[92:95], v[44:47], v[140:143]
    ds_read_b128 v[76:79], v5 offset:6144
    v_mfma_f32_16x16x32_bf16 v[136:139], v[92:95], v[36:39], v[136:139]
    ds_read_b64_tr_b16 v[104:105], v7 offset:0
    ds_read_b64_tr_b16 v[106:107], v7 offset:512
    v_mfma_f32_16x16x32_bf16 v[136:139], v[88:91], v[32:35], v[136:139]
    ds_read_b64_tr_b16 v[108:109], v7 offset:4096
    ds_read_b64_tr_b16 v[110:111], v7 offset:4608
    v_mfma_f32_16x16x32_bf16 v[132:135], v[88:91], v[24:27], v[132:135]
    v_add_u32 v4, s73, v4
    v_add_u32 v5, s73, v5
    v_mfma_f32_16x16x32_bf16 v[132:135], v[92:95], v[28:31], v[132:135]
    v_add_u32 v6, s74, v6
    v_add_u32 v7, s74, v7
    v_mfma_f32_16x16x32_bf16 v[128:131], v[92:95], v[20:23], v[128:131]
    v_mfma_f32_16x16x32_bf16 v[128:131], v[88:91], v[16:19], v[128:131]
    s_sub_u32 s99, s99, 1
    s_waitcnt lgkmcnt(0)
    s_barrier
    s_cbranch_scc1 tail_183
    v_mfma_f32_16x16x32_bf16 v[112:115], v[96:99], v[48:51], v[112:115]
    ds_read_b64_tr_b16 v[80:81], v6 offset:0
    ds_read_b64_tr_b16 v[82:83], v6 offset:512
    v_mfma_f32_16x16x32_bf16 v[112:115], v[100:103], v[52:55], v[112:115]
    ds_read_b64_tr_b16 v[84:85], v6 offset:4096
    ds_read_b64_tr_b16 v[86:87], v6 offset:4608
    v_mfma_f32_16x16x32_bf16 v[116:119], v[100:103], v[60:63], v[116:119]
    ds_read_b128 v[16:19], v4 offset:0
    s_add_u32 s71, s71, 1
    s_cmp_eq_u32 s71, 4
    v_mfma_f32_16x16x32_bf16 v[116:119], v[96:99], v[56:59], v[116:119]
    ds_read_b128 v[20:23], v5 offset:0
    v_mfma_f32_16x16x32_bf16 v[120:123], v[96:99], v[64:67], v[120:123]
    ds_read_b128 v[24:27], v4 offset:2048
    s_cselect_b32 s73, s64, s80
    s_cselect_b32 s71, 0, s71
    v_mfma_f32_16x16x32_bf16 v[120:123], v[100:103], v[68:71], v[120:123]
    ds_read_b128 v[28:31], v5 offset:2048
    v_mfma_f32_16x16x32_bf16 v[124:127], v[100:103], v[76:79], v[124:127]
    ds_read_b128 v[32:35], v4 offset:4096
    s_add_u32 s68, s69, s66
    s_and_b32 s68, s68, s81
    v_mfma_f32_16x16x32_bf16 v[124:127], v[96:99], v[72:75], v[124:127]
    ds_read_b128 v[36:39], v5 offset:4096
    v_mfma_f32_16x16x32_bf16 v[140:143], v[104:107], v[72:75], v[140:143]
    ds_read_b128 v[40:43], v4 offset:6144
    s_sub_u32 s74, s68, s69
    s_mov_b32 s69, s68
    v_mfma_f32_16x16x32_bf16 v[140:143], v[108:111], v[76:79], v[140:143]
    ds_read_b128 v[44:47], v5 offset:6144
    v_mfma_f32_16x16x32_bf16 v[136:139], v[108:111], v[68:71], v[136:139]
    ds_read_b64_tr_b16 v[88:89], v7 offset:0
    ds_read_b64_tr_b16 v[90:91], v7 offset:512
    v_mfma_f32_16x16x32_bf16 v[136:139], v[104:107], v[64:67], v[136:139]
    ds_read_b64_tr_b16 v[92:93], v7 offset:4096
    ds_read_b64_tr_b16 v[94:95], v7 offset:4608
    v_mfma_f32_16x16x32_bf16 v[132:135], v[104:107], v[56:59], v[132:135]
    v_add_u32 v4, s73, v4
    v_add_u32 v5, s73, v5
    v_mfma_f32_16x16x32_bf16 v[132:135], v[108:111], v[60:63], v[132:135]
    v_add_u32 v6, s74, v6
    v_add_u32 v7, s74, v7
    v_mfma_f32_16x16x32_bf16 v[128:131], v[108:111], v[52:55], v[128:131]
    s_sub_u32 s70, s70, 1
    s_cmp_lg_u32 s70, 0
    v_mfma_f32_16x16x32_bf16 v[128:131], v[104:107], v[48:51], v[128:131]
    s_cbranch_scc1 cl_182
    s_nop 0
    buffer_load_dwordx4 v[192:195], v15, s[16:19], s55 offen offset:0 sc1
    buffer_load_dwordx4 v[196:199], v15, s[16:19], s55 offen offset:1024 sc1
    buffer_load_dwordx4 v[200:203], v15, s[16:19], s55 offen offset:2048 sc1
    buffer_load_dwordx4 v[204:207], v15, s[16:19], s55 offen offset:3072 sc1
    s_branch cl_182
    .p2align 5
tail_183:
    v_mfma_f32_16x16x32_bf16 v[112:115], v[96:99], v[48:51], v[112:115]
    s_lshl_b32 s49, s3, 19
    s_nop 0
    v_mfma_f32_16x16x32_bf16 v[112:115], v[100:103], v[52:55], v[112:115]
    s_lshl_b32 s50, s4, 15
    s_nop 0
    v_mfma_f32_16x16x32_bf16 v[116:119], v[100:103], v[60:63], v[116:119]
    s_add_u32 s50, s50, s49
    s_nop 0
    v_mfma_f32_16x16x32_bf16 v[116:119], v[96:99], v[56:59], v[116:119]
    s_add_u32 s50, s50, 8388608
    v_mfma_f32_16x16x32_bf16 v[120:123], v[96:99], v[64:67], v[120:123]
    s_add_u32 s51, s50, 4096
    v_mfma_f32_16x16x32_bf16 v[120:123], v[100:103], v[68:71], v[120:123]
    s_lshl_b32 s48, s46, 10
    s_nop 0
    v_mfma_f32_16x16x32_bf16 v[124:127], v[100:103], v[76:79], v[124:127]
    s_add_u32 s48, s48, 86016
    v_mfma_f32_16x16x32_bf16 v[124:127], v[96:99], v[72:75], v[124:127]
    v_add_u32_e64 v44, s48, v9
    v_mfma_f32_16x16x32_bf16 v[140:143], v[104:107], v[72:75], v[140:143]
    v_mfma_f32_16x16x32_bf16 v[140:143], v[108:111], v[76:79], v[140:143]
    v_mfma_f32_16x16x32_bf16 v[136:139], v[108:111], v[68:71], v[136:139]
    v_mfma_f32_16x16x32_bf16 v[136:139], v[104:107], v[64:67], v[136:139]
    v_mfma_f32_16x16x32_bf16 v[132:135], v[104:107], v[56:59], v[132:135]
    v_mfma_f32_16x16x32_bf16 v[132:135], v[108:111], v[60:63], v[132:135]
    v_mfma_f32_16x16x32_bf16 v[128:131], v[108:111], v[52:55], v[128:131]
    v_mfma_f32_16x16x32_bf16 v[128:131], v[104:107], v[48:51], v[128:131]
    s_cmp_eq_u32 s86, 0
    s_cbranch_scc1 nob_184
xpc_186:
    s_waitcnt vmcnt(0)
    s_nop 0
    v_max3_u32 v43, v192, v193, v194
    v_max_u32_e64 v43, v43, v195
    v_max3_u32 v43, v43, v196, v197
    v_max3_u32 v43, v43, v198, v199
    v_max3_u32 v43, v43, v200, v201
    v_max3_u32 v43, v43, v202, v203
    v_max3_u32 v43, v43, v204, v205
    v_max3_u32 v43, v43, v206, v207
    v_cmp_eq_u32 vcc, -1, v43
    s_cbranch_vccz rtd_187
    s_sub_u32 s85, s85, 1
    s_cbranch_scc0 xpl_185
    s_mov_b32 s85, 0
rtd_187:
    v_lshlrev_b32 v32, 16, v204
    v_lshlrev_b32 v34, 16, v205
    v_lshlrev_b32 v36, 16, v206
    v_lshlrev_b32_e64 v38, 16, v207
    v_and_b32 v33, 0xffff0000, v204
    v_and_b32 v35, 0xffff0000, v205
    v_and_b32 v37, 0xffff0000, v206
    v_and_b32 v39, 0xffff0000, v207
    v_pk_add_f32 v[124:125], v[124:125], v[32:33]
    v_pk_add_f32 v[126:127], v[126:127], v[34:35]
    v_pk_add_f32 v[140:141], v[140:141], v[36:37]
    v_pk_add_f32 v[142:143], v[142:143], v[38:39]
    v_lshlrev_b32 v32, 16, v200
    v_lshlrev_b32 v34, 16, v201
    v_lshlrev_b32 v36, 16, v202
    v_lshlrev_b32 v38, 16, v203
    v_and_b32 v33, 0xffff0000, v200
    v_and_b32 v35, 0xffff0000, v201
    v_and_b32 v37, 0xffff0000, v202
    v_and_b32 v39, 0xffff0000, v203
    v_pk_add_f32 v[120:121], v[120:121], v[32:33]
    v_pk_add_f32 v[122:123], v[122:123], v[34:35]
    v_pk_add_f32 v[136:137], v[136:137], v[36:37]
    v_pk_add_f32 v[138:139], v[138:139], v[38:39]
    v_lshlrev_b32 v32, 16, v196
    v_lshlrev_b32 v34, 16, v197
    v_lshlrev_b32 v36, 16, v198
    v_lshlrev_b32 v38, 16, v199
    v_and_b32 v33, 0xffff0000, v196
    v_and_b32 v35, 0xffff0000, v197
    v_and_b32 v37, 0xffff0000, v198
    v_and_b32 v39, 0xffff0000, v199
    v_pk_add_f32 v[116:117], v[116:117], v[32:33]
    v_pk_add_f32 v[118:119], v[118:119], v[34:35]
    v_pk_add_f32 v[132:133], v[132:133], v[36:37]
    v_pk_add_f32 v[134:135], v[134:135], v[38:39]
    v_lshlrev_b32 v32, 16, v192
    v_lshlrev_b32 v34, 16, v193
    v_lshlrev_b32 v36, 16, v194
    v_lshlrev_b32 v38, 16, v195
    v_and_b32 v33, 0xffff0000, v192
    v_and_b32 v35, 0xffff0000, v193
    v_and_b32 v37, 0xffff0000, v194
    v_and_b32 v39, 0xffff0000, v195
    v_pk_add_f32 v[112:113], v[112:113], v[32:33]
    v_pk_add_f32 v[114:115], v[114:115], v[34:35]
    v_pk_add_f32 v[128:129], v[128:129], v[36:37]
    v_pk_add_f32 v[130:131], v[130:131], v[38:39]
    s_cmp_lg_u32 s7, 0
    s_cbranch_scc1 L_c_fin
nob_184:
    v_cvt_pk_bf16_f32 v92, v124, v125
    v_cvt_pk_bf16_f32 v93, v126, v127
    v_cvt_pk_bf16_f32 v94, v140, v141
    v_cvt_pk_bf16_f32 v95, v142, v143
    buffer_store_dwordx4 v[92:95], v1, s[16:19], s51 offen offset:2048 sc1
    v_cvt_pk_bf16_f32 v88, v120, v121
    v_cvt_pk_bf16_f32 v89, v122, v123
    v_cvt_pk_bf16_f32 v90, v136, v137
    v_cvt_pk_bf16_f32 v91, v138, v139
    buffer_store_dwordx4 v[88:91], v1, s[16:19], s51 offen offset:0 sc1
    v_cvt_pk_bf16_f32 v84, v116, v117
    v_cvt_pk_bf16_f32 v85, v118, v119
    v_cvt_pk_bf16_f32 v86, v132, v133
    v_cvt_pk_bf16_f32 v87, v134, v135
    buffer_store_dwordx4 v[84:87], v1, s[16:19], s50 offen offset:2048 sc1
    v_cvt_pk_bf16_f32 v80, v112, v113
    v_cvt_pk_bf16_f32 v81, v114, v115
    v_cvt_pk_bf16_f32 v82, v128, v129
    v_cvt_pk_bf16_f32 v83, v130, v131
    buffer_store_dwordx4 v[80:83], v1, s[16:19], s50 offen offset:0 sc1
    ds_write_b128 v44, v[92:95] offset:6144
    ds_write_b64 v2, v[92:93] offset:6144
    ds_write_b64 v3, v[94:95] offset:6144
    ds_write_b128 v44, v[88:91] offset:4096
    ds_write_b64 v2, v[88:89] offset:4096
    ds_write_b64 v3, v[90:91] offset:4096
    ds_write_b128 v44, v[84:87] offset:2048
    ds_write_b64 v2, v[84:85] offset:2048
    ds_write_b64 v3, v[86:87] offset:2048
    ds_write_b128 v44, v[80:83] offset:0
    ds_write_b64 v2, v[80:81] offset:0
    ds_write_b64 v3, v[82:83] offset:0
    s_mov_b64 vcc, 1
    s_mov_b32 s75, 3
    s_cmp_eq_u32 s86, 0
    s_cbranch_scc1 L_c_g3
    v_add_u32 v4, 86016, v9
    v_add_u32 v5, 87040, v9
    s_mov_b32 s7, 1
    s_mov_b32 s47, 16
    s_branch L_c_layer
L_c_g3:
    s_nop 0
    v_add_u32 v4, 86016, v9
    v_add_u32 v5, 87040, v9
    v_mov_b32 v6, v10
    v_mov_b32 v7, v11
    v_mov_b32 v8, v12
    s_mov_b32 s99, 7
    s_mov_b32 s70, 1
    s_mov_b32 s71, 0
    s_mov_b32 s64, 0xffff8000
    s_mov_b32 s65, 0xffff2000
    s_waitcnt lgkmcnt(0)
    s_barrier
    ds_read_b64_tr_b16 v[80:81], v6 offset:0
    ds_read_b64_tr_b16 v[82:83], v6 offset:512
    ds_read_b64_tr_b16 v[84:85], v6 offset:4096
    ds_read_b64_tr_b16 v[86:87], v6 offset:4608
    ds_read_b128 v[16:19], v4 offset:0
    ds_read_b128 v[20:23], v5 offset:0
    ds_read_b128 v[24:27], v4 offset:2048
    ds_read_b128 v[28:31], v5 offset:2048
    ds_read_b128 v[32:35], v4 offset:4096
    ds_read_b128 v[36:39], v5 offset:4096
    ds_read_b128 v[40:43], v4 offset:6144
    ds_read_b128 v[44:47], v5 offset:6144
    ds_read_b64_tr_b16 v[88:89], v7 offset:0
    ds_read_b64_tr_b16 v[90:91], v7 offset:512
    ds_read_b64_tr_b16 v[92:93], v7 offset:4096
    ds_read_b64_tr_b16 v[94:95], v7 offset:4608
    v_mov_b64 v[112:113], 0
    v_mov_b64 v[114:115], 0
    v_mov_b64 v[116:117], 0
    v_mov_b64 v[118:119], 0
    v_mov_b64 v[120:121], 0
    v_mov_b64 v[122:123], 0
    v_mov_b64 v[124:125], 0
    v_mov_b64 v[126:127], 0
    v_mov_b64 v[128:129], 0
    v_mov_b64 v[130:131], 0
    v_mov_b64 v[132:133], 0
    v_mov_b64 v[134:135], 0
    v_mov_b64 v[136:137], 0
    v_mov_b64 v[138:139], 0
    v_mov_b64 v[140:141], 0
    v_mov_b64 v[142:143], 0
    v_mov_b64 v[144:145], 0
    v_mov_b64 v[146:147], 0
    v_mov_b64 v[148:149], 0
    v_mov_b64 v[150:151], 0
    v_mov_b64 v[152:153], 0
    v_mov_b64 v[154:155], 0
    v_mov_b64 v[156:157], 0
    v_mov_b64 v[158:159], 0
    v_mov_b64 v[160:161], 0
    v_mov_b64 v[162:163], 0
    v_mov_b64 v[164:165], 0
    v_mov_b64 v[166:167], 0
    v_mov_b64 v[168:169], 0
    v_mov_b64 v[170:171], 0
    v_mov_b64 v[172:173], 0
    v_mov_b64 v[174:175], 0
    v_mov_b64 v[176:177], 0
    v_mov_b64 v[178:179], 0
    v_mov_b64 v[180:181], 0
    v_mov_b64 v[182:183], 0
    v_mov_b64 v[184:185], 0
    v_mov_b64 v[186:187], 0
    v_mov_b64 v[188:189], 0
    v_mov_b64 v[190:191], 0
    v_mov_b64 v[192:193], 0
    v_mov_b64 v[194:195], 0
    v_mov_b64 v[196:197], 0
    v_mov_b64 v[198:199], 0
    v_mov_b64 v[200:201], 0
    v_mov_b64 v[202:203], 0
    v_mov_b64 v[204:205], 0
    v_mov_b64 v[206:207], 0
    v_mov_b64 v[208:209], 0
    v_mov_b64 v[210:211], 0
    v_mov_b64 v[212:213], 0
    v_mov_b64 v[214:215], 0
    v_mov_b64 v[216:217], 0
    v_mov_b64 v[218:219], 0
    v_mov_b64 v[220:221], 0
    v_mov_b64 v[222:223], 0
    v_and_b32 v248, 48, v0
    v_and_b32 v249, 15, v0
    s_lshl_b32 s48, s45, 8
    s_nop 0
    s_add_u32 s48, s48, 151552
    v_lshl_add_u32 v249, v249, 2, s48
    s_lshl_b32 s49, s46, 7
    s_nop 0
    s_add_u32 s49, s49, 153600
    v_add_u32 v250, s49, v248
    s_lshl_b32 s49, s46, 6
    s_add_u32 s49, s49, 154368
    v_add_u32 v251, s49, v248
    s_branch cl_188
mid_190:
    s_add_u32 s48, s47, 3
    v_mov_b32 v254, s48
    s_cmp_eq_u32 s44, 0
    s_waitcnt vmcnt(0)
    s_cbranch_scc0 sigs_3192
    s_nop 0
    buffer_store_dword v254, v14, s[16:19], 0 offen
sigd_3193:
    s_branch midr_191
    .p2align 5
cl_188:
    s_waitcnt lgkmcnt(4)
    s_nop 0
    v_mfma_f32_16x16x32_bf16 v[112:115], v[80:83], v[16:19], v[112:115]
    ds_read_b64_tr_b16 v[96:97], v6 offset:8192
    v_mfma_f32_16x16x32_bf16 v[112:115], v[84:87], v[20:23], v[112:115]
    ds_read_b64_tr_b16 v[98:99], v6 offset:8704
    v_mfma_f32_16x16x32_bf16 v[116:119], v[84:87], v[28:31], v[116:119]
    ds_read_b64_tr_b16 v[100:101], v6 offset:12288
    v_mfma_f32_16x16x32_bf16 v[116:119], v[80:83], v[24:27], v[116:119]
    ds_read_b64_tr_b16 v[102:103], v6 offset:12800
    v_mfma_f32_16x16x32_bf16 v[120:123], v[80:83], v[32:35], v[120:123]
    s_add_u32 s71, s71, 1
    s_cmp_eq_u32 s71, 3
    v_mfma_f32_16x16x32_bf16 v[120:123], v[84:87], v[36:39], v[120:123]
    s_cselect_b32 s73, s64, 16384
    v_mfma_f32_16x16x32_bf16 v[124:127], v[84:87], v[44:47], v[124:127]
    s_cselect_b32 s74, s65, 28672
    v_mfma_f32_16x16x32_bf16 v[124:127], v[80:83], v[40:43], v[124:127]
    s_cselect_b32 s71, 0, s71
    s_waitcnt lgkmcnt(4)
    v_mfma_f32_16x16x32_bf16 v[140:143], v[88:91], v[40:43], v[140:143]
    ds_read_b64_tr_b16 v[104:105], v7 offset:8192
    v_mfma_f32_16x16x32_bf16 v[140:143], v[92:95], v[44:47], v[140:143]
    ds_read_b64_tr_b16 v[106:107], v7 offset:8704
    v_mfma_f32_16x16x32_bf16 v[136:139], v[92:95], v[36:39], v[136:139]
    ds_read_b64_tr_b16 v[108:109], v7 offset:12288
    v_mfma_f32_16x16x32_bf16 v[136:139], v[88:91], v[32:35], v[136:139]
    ds_read_b64_tr_b16 v[110:111], v7 offset:12800
    v_mfma_f32_16x16x32_bf16 v[132:135], v[88:91], v[24:27], v[132:135]
    v_mfma_f32_16x16x32_bf16 v[132:135], v[92:95], v[28:31], v[132:135]
    v_mfma_f32_16x16x32_bf16 v[128:131], v[92:95], v[20:23], v[128:131]
    v_mfma_f32_16x16x32_bf16 v[128:131], v[88:91], v[16:19], v[128:131]
    s_cbranch_vccnz mid_190
midr_191:
    s_waitcnt lgkmcnt(4)
    v_mfma_f32_16x16x32_bf16 v[144:147], v[96:99], v[16:19], v[144:147]
    ds_read_b64_tr_b16 v[80:81], v6 offset:16384
    v_mfma_f32_16x16x32_bf16 v[144:147], v[100:103], v[20:23], v[144:147]
    ds_read_b64_tr_b16 v[82:83], v6 offset:16896
    v_mfma_f32_16x16x32_bf16 v[148:151], v[100:103], v[28:31], v[148:151]
    ds_read_b64_tr_b16 v[84:85], v6 offset:20480
    v_mfma_f32_16x16x32_bf16 v[148:151], v[96:99], v[24:27], v[148:151]
    ds_read_b64_tr_b16 v[86:87], v6 offset:20992
    v_mfma_f32_16x16x32_bf16 v[152:155], v[96:99], v[32:35], v[152:155]
    v_mfma_f32_16x16x32_bf16 v[152:155], v[100:103], v[36:39], v[152:155]
    v_mfma_f32_16x16x32_bf16 v[156:159], v[100:103], v[44:47], v[156:159]
    v_mfma_f32_16x16x32_bf16 v[156:159], v[96:99], v[40:43], v[156:159]
    s_waitcnt lgkmcnt(4)
    s_nop 0
    v_mfma_f32_16x16x32_bf16 v[172:175], v[104:107], v[40:43], v[172:175]
    ds_read_b64_tr_b16 v[88:89], v7 offset:16384
    v_mfma_f32_16x16x32_bf16 v[172:175], v[108:111], v[44:47], v[172:175]
    ds_read_b64_tr_b16 v[90:91], v7 offset:16896
    v_mfma_f32_16x16x32_bf16 v[168:171], v[108:111], v[36:39], v[168:171]
    ds_read_b64_tr_b16 v[92:93], v7 offset:20480
    v_mfma_f32_16x16x32_bf16 v[168:171], v[104:107], v[32:35], v[168:171]
    ds_read_b64_tr_b16 v[94:95], v7 offset:20992
    v_mfma_f32_16x16x32_bf16 v[164:167], v[104:107], v[24:27], v[164:167]
    v_mfma_f32_16x16x32_bf16 v[164:167], v[108:111], v[28:31], v[164:167]
    v_mfma_f32_16x16x32_bf16 v[160:163], v[108:111], v[20:23], v[160:163]
    v_mfma_f32_16x16x32_bf16 v[160:163], v[104:107], v[16:19], v[160:163]
    s_waitcnt lgkmcnt(4)
    s_nop 0
    v_mfma_f32_16x16x32_bf16 v[176:179], v[80:83], v[16:19], v[176:179]
    ds_read_b64_tr_b16 v[96:97], v8 offset:24576
    v_mfma_f32_16x16x32_bf16 v[176:179], v[84:87], v[20:23], v[176:179]
    ds_read_b64_tr_b16 v[98:99], v8 offset:24832
    v_mfma_f32_16x16x32_bf16 v[180:183], v[84:87], v[28:31], v[180:183]
    ds_read_b64_tr_b16 v[100:101], v8 offset:26624
    v_mfma_f32_16x16x32_bf16 v[180:183], v[80:83], v[24:27], v[180:183]
    ds_read_b64_tr_b16 v[102:103], v8 offset:26880
    v_mfma_f32_16x16x32_bf16 v[184:187], v[80:83], v[32:35], v[184:187]
    v_add_u32 v4, s73, v4
    v_add_u32 v5, s73, v5
    v_mfma_f32_16x16x32_bf16 v[184:187], v[84:87], v[36:39], v[184:187]
    v_add_u32 v6, s74, v6
    v_add_u32 v7, s74, v7
    v_mfma_f32_16x16x32_bf16 v[188:191], v[84:87], v[44:47], v[188:191]
    v_add_u32 v8, s74, v8
    s_cbranch_vccnz mid_192
midr_193:
    v_mfma_f32_16x16x32_bf16 v[188:191], v[80:83], v[40:43], v[188:191]
    s_waitcnt lgkmcnt(0)
    s_barrier
    v_mfma_f32_16x16x32_bf16 v[204:207], v[88:91], v[40:43], v[204:207]
    ds_read_b64_tr_b16 v[80:81], v6 offset:0
    v_mfma_f32_16x16x32_bf16 v[204:207], v[92:95], v[44:47], v[204:207]
    ds_read_b64_tr_b16 v[82:83], v6 offset:512
    v_mfma_f32_16x16x32_bf16 v[200:203], v[92:95], v[36:39], v[200:203]
    ds_read_b64_tr_b16 v[84:85], v6 offset:4096
    v_mfma_f32_16x16x32_bf16 v[200:203], v[88:91], v[32:35], v[200:203]
    ds_read_b64_tr_b16 v[86:87], v6 offset:4608
    v_mfma_f32_16x16x32_bf16 v[196:199], v[88:91], v[24:27], v[196:199]
    ds_read_b128 v[48:51], v4 offset:0
    v_mfma_f32_16x16x32_bf16 v[196:199], v[92:95], v[28:31], v[196:199]
    ds_read_b128 v[52:55], v5 offset:0
    v_mfma_f32_16x16x32_bf16 v[192:195], v[92:95], v[20:23], v[192:195]
    ds_read_b128 v[56:59], v4 offset:2048
    v_mfma_f32_16x16x32_bf16 v[192:195], v[88:91], v[16:19], v[192:195]
    ds_read_b128 v[60:63], v5 offset:2048
    v_mfma_f32_16x16x32_bf16 v[208:211], v[96:99], v[16:19], v[208:211]
    ds_read_b128 v[64:67], v4 offset:4096
    v_mfma_f32_16x16x32_bf16 v[208:211], v[100:103], v[20:23], v[208:211]
    ds_read_b128 v[68:71], v5 offset:4096
    v_mfma_f32_16x16x32_bf16 v[212:215], v[100:103], v[28:31], v[212:215]
    ds_read_b128 v[72:75], v4 offset:6144
    v_mfma_f32_16x16x32_bf16 v[212:215], v[96:99], v[24:27], v[212:215]
    ds_read_b128 v[76:79], v5 offset:6144
    v_mfma_f32_16x16x32_bf16 v[216:219], v[96:99], v[32:35], v[216:219]
    ds_read_b64_tr_b16 v[88:89], v7 offset:0
    v_mfma_f32_16x16x32_bf16 v[216:219], v[100:103], v[36:39], v[216:219]
    ds_read_b64_tr_b16 v[90:91], v7 offset:512
    v_mfma_f32_16x16x32_bf16 v[220:223], v[100:103], v[44:47], v[220:223]
    ds_read_b64_tr_b16 v[92:93], v7 offset:4096
    v_mfma_f32_16x16x32_bf16 v[220:223], v[96:99], v[40:43], v[220:223]
    ds_read_b64_tr_b16 v[94:95], v7 offset:4608
    s_waitcnt lgkmcnt(4)
    s_nop 0
    v_mfma_f32_16x16x32_bf16 v[112:115], v[80:83], v[48:51], v[112:115]
    ds_read_b64_tr_b16 v[96:97], v6 offset:8192
    v_mfma_f32_16x16x32_bf16 v[112:115], v[84:87], v[52:55], v[112:115]
    ds_read_b64_tr_b16 v[98:99], v6 offset:8704
    v_mfma_f32_16x16x32_bf16 v[116:119], v[84:87], v[60:63], v[116:119]
    ds_read_b64_tr_b16 v[100:101], v6 offset:12288
    v_mfma_f32_16x16x32_bf16 v[116:119], v[80:83], v[56:59], v[116:119]
    ds_read_b64_tr_b16 v[102:103], v6 offset:12800
    v_mfma_f32_16x16x32_bf16 v[120:123], v[80:83], v[64:67], v[120:123]
    s_add_u32 s71, s71, 1
    s_cmp_eq_u32 s71, 3
    v_mfma_f32_16x16x32_bf16 v[120:123], v[84:87], v[68:71], v[120:123]
    s_cselect_b32 s73, s64, 16384
    v_mfma_f32_16x16x32_bf16 v[124:127], v[84:87], v[76:79], v[124:127]
    s_cselect_b32 s74, s65, 28672
    v_mfma_f32_16x16x32_bf16 v[124:127], v[80:83], v[72:75], v[124:127]
    s_cselect_b32 s71, 0, s71
    s_waitcnt lgkmcnt(4)
    v_mfma_f32_16x16x32_bf16 v[140:143], v[88:91], v[72:75], v[140:143]
    ds_read_b64_tr_b16 v[104:105], v7 offset:8192
    v_mfma_f32_16x16x32_bf16 v[140:143], v[92:95], v[76:79], v[140:143]
    ds_read_b64_tr_b16 v[106:107], v7 offset:8704
    v_mfma_f32_16x16x32_bf16 v[136:139], v[92:95], v[68:71], v[136:139]
    ds_read_b64_tr_b16 v[108:109], v7 offset:12288
    v_mfma_f32_16x16x32_bf16 v[136:139], v[88:91], v[64:67], v[136:139]
    ds_read_b64_tr_b16 v[110:111], v7 offset:12800
    v_mfma_f32_16x16x32_bf16 v[132:135], v[88:91], v[56:59], v[132:135]
    v_mfma_f32_16x16x32_bf16 v[132:135], v[92:95], v[60:63], v[132:135]
    v_mfma_f32_16x16x32_bf16 v[128:131], v[92:95], v[52:55], v[128:131]
    v_mfma_f32_16x16x32_bf16 v[128:131], v[88:91], v[48:51], v[128:131]
    s_waitcnt lgkmcnt(4)
    s_nop 0
    v_mfma_f32_16x16x32_bf16 v[144:147], v[96:99], v[48:51], v[144:147]
    ds_read_b64_tr_b16 v[80:81], v6 offset:16384
    v_mfma_f32_16x16x32_bf16 v[144:147], v[100:103], v[52:55], v[144:147]
    ds_read_b64_tr_b16 v[82:83], v6 offset:16896
    v_mfma_f32_16x16x32_bf16 v[148:151], v[100:103], v[60:63], v[148:151]
    ds_read_b64_tr_b16 v[84:85], v6 offset:20480
    v_mfma_f32_16x16x32_bf16 v[148:151], v[96:99], v[56:59], v[148:151]
    ds_read_b64_tr_b16 v[86:87], v6 offset:20992
    v_mfma_f32_16x16x32_bf16 v[152:155], v[96:99], v[64:67], v[152:155]
    v_mfma_f32_16x16x32_bf16 v[152:155], v[100:103], v[68:71], v[152:155]
    v_mfma_f32_16x16x32_bf16 v[156:159], v[100:103], v[76:79], v[156:159]
    v_mfma_f32_16x16x32_bf16 v[156:159], v[96:99], v[72:75], v[156:159]
    s_waitcnt lgkmcnt(4)
    s_nop 0
    v_mfma_f32_16x16x32_bf16 v[172:175], v[104:107], v[72:75], v[172:175]
    ds_read_b64_tr_b16 v[88:89], v7 offset:16384
    v_mfma_f32_16x16x32_bf16 v[172:175], v[108:111], v[76:79], v[172:175]
    ds_read_b64_tr_b16 v[90:91], v7 offset:16896
    v_mfma_f32_16x16x32_bf16 v[168:171], v[108:111], v[68:71], v[168:171]
    ds_read_b64_tr_b16 v[92:93], v7 offset:20480
    v_mfma_f32_16x16x32_bf16 v[168:171], v[104:107], v[64:67], v[168:171]
    ds_read_b64_tr_b16 v[94:95], v7 offset:20992
    v_mfma_f32_16x16x32_bf16 v[164:167], v[104:107], v[56:59], v[164:167]
    v_mfma_f32_16x16x32_bf16 v[164:167], v[108:111], v[60:63], v[164:167]
    v_mfma_f32_16x16x32_bf16 v[160:163], v[108:111], v[52:55], v[160:163]
    v_mfma_f32_16x16x32_bf16 v[160:163], v[104:107], v[48:51], v[160:163]
    s_waitcnt lgkmcnt(4)
    s_nop 0
    v_mfma_f32_16x16x32_bf16 v[176:179], v[80:83], v[48:51], v[176:179]
    ds_read_b64_tr_b16 v[96:97], v8 offset:24576
    v_mfma_f32_16x16x32_bf16 v[176:179], v[84:87], v[52:55], v[176:179]
    ds_read_b64_tr_b16 v[98:99], v8 offset:24832
    v_mfma_f32_16x16x32_bf16 v[180:183], v[84:87], v[60:63], v[180:183]
    ds_read_b64_tr_b16 v[100:101], v8 offset:26624
    v_mfma_f32_16x16x32_bf16 v[180:183], v[80:83], v[56:59], v[180:183]
    ds_read_b64_tr_b16 v[102:103], v8 offset:26880
    v_mfma_f32_16x16x32_bf16 v[184:187], v[80:83], v[64:67], v[184:187]
    v_add_u32 v4, s73, v4
    v_add_u32 v5, s73, v5
    v_mfma_f32_16x16x32_bf16 v[184:187], v[84:87], v[68:71], v[184:187]
    v_add_u32 v6, s74, v6
    v_add_u32 v7, s74, v7
    v_mfma_f32_16x16x32_bf16 v[188:191], v[84:87], v[76:79], v[188:191]
    v_add_u32_e64 v8, s74, v8
    v_mfma_f32_16x16x32_bf16 v[188:191], v[80:83], v[72:75], v[188:191]
    s_sub_u32 s99, s99, 1
    s_waitcnt lgkmcnt(0)
    s_barrier
    s_cbranch_scc1 tail_189
    v_mfma_f32_16x16x32_bf16 v[204:207], v[88:91], v[72:75], v[204:207]
    ds_read_b64_tr_b16 v[80:81], v6 offset:0
    v_mfma_f32_16x16x32_bf16 v[204:207], v[92:95], v[76:79], v[204:207]
    ds_read_b64_tr_b16 v[82:83], v6 offset:512
    v_mfma_f32_16x16x32_bf16 v[200:203], v[92:95], v[68:71], v[200:203]
    ds_read_b64_tr_b16 v[84:85], v6 offset:4096
    v_mfma_f32_16x16x32_bf16 v[200:203], v[88:91], v[64:67], v[200:203]
    ds_read_b64_tr_b16 v[86:87], v6 offset:4608
    v_mfma_f32_16x16x32_bf16 v[196:199], v[88:91], v[56:59], v[196:199]
    ds_read_b128 v[16:19], v4 offset:0
    v_mfma_f32_16x16x32_bf16 v[196:199], v[92:95], v[60:63], v[196:199]
    ds_read_b128 v[20:23], v5 offset:0
    v_mfma_f32_16x16x32_bf16 v[192:195], v[92:95], v[52:55], v[192:195]
    ds_read_b128 v[24:27], v4 offset:2048
    v_mfma_f32_16x16x32_bf16 v[192:195], v[88:91], v[48:51], v[192:195]
    ds_read_b128 v[28:31], v5 offset:2048
    v_mfma_f32_16x16x32_bf16 v[208:211], v[96:99], v[48:51], v[208:211]
    ds_read_b128 v[32:35], v4 offset:4096
    v_mfma_f32_16x16x32_bf16 v[208:211], v[100:103], v[52:55], v[208:211]
    ds_read_b128 v[36:39], v5 offset:4096
    v_mfma_f32_16x16x32_bf16 v[212:215], v[100:103], v[60:63], v[212:215]
    ds_read_b128 v[40:43], v4 offset:6144
    v_mfma_f32_16x16x32_bf16 v[212:215], v[96:99], v[56:59], v[212:215]
    ds_read_b128 v[44:47], v5 offset:6144
    v_mfma_f32_16x16x32_bf16 v[216:219], v[96:99], v[64:67], v[216:219]
    ds_read_b64_tr_b16 v[88:89], v7 offset:0
    v_mfma_f32_16x16x32_bf16 v[216:219], v[100:103], v[68:71], v[216:219]
    ds_read_b64_tr_b16 v[90:91], v7 offset:512
    v_mfma_f32_16x16x32_bf16 v[220:223], v[100:103], v[76:79], v[220:223]
    ds_read_b64_tr_b16 v[92:93], v7 offset:4096
    s_sub_u32 s70, s70, 1
    s_cmp_lg_u32 s70, 0
    v_mfma_f32_16x16x32_bf16 v[220:223], v[96:99], v[72:75], v[220:223]
    ds_read_b64_tr_b16 v[94:95], v7 offset:4608
    s_cbranch_scc1 cl_188
    s_mov_b32 s70, 8
    buffer_store_dword v254, v13, s[16:19], s83 offen sc1
    v_lshlrev_b32_e64 v252, 2, v0
    buffer_store_dword v253, v252, s[16:19], s61 offen sc1
    s_branch cl_188
    .p2align 5
tail_189:
    v_mfma_f32_16x16x32_bf16 v[204:207], v[88:91], v[72:75], v[204:207]
    ds_read2_b32 v[80:81], v249 offset0:0 offset1:128
    ds_read2_b32 v[82:83], v249 offset0:16 offset1:144
    ds_read2_b32 v[84:85], v249 offset0:32 offset1:160
    v_mfma_f32_16x16x32_bf16 v[204:207], v[92:95], v[76:79], v[204:207]
    ds_read2_b32 v[86:87], v249 offset0:48 offset1:176
    ds_read_b128 v[16:19], v250 offset:0
    ds_read_b128 v[20:23], v250 offset:1024
    v_mfma_f32_16x16x32_bf16 v[200:203], v[92:95], v[68:71], v[200:203]
    ds_read_b128 v[24:27], v250 offset:64
    ds_read_b128 v[28:31], v250 offset:1088
    ds_read_b128 v[32:35], v250 offset:256
    v_mfma_f32_16x16x32_bf16 v[200:203], v[88:91], v[64:67], v[200:203]
    ds_read_b128 v[36:39], v250 offset:1280
    ds_read_b128 v[40:43], v250 offset:320
    ds_read_b128 v[44:47], v250 offset:1344
    v_mfma_f32_16x16x32_bf16 v[196:199], v[88:91], v[56:59], v[196:199]
    s_mov_b32 s88, 0xbdd2d3e8
    s_mov_b32 s89, 0xc0135761
    s_andn2_b32 s54, 4, s4
    s_nop 0
    v_mfma_f32_16x16x32_bf16 v[196:199], v[92:95], v[60:63], v[196:199]
    s_mov_b32 s55, 0
    s_mov_b32 s56, s44
    s_mov_b32 s57, 0
    s_nop 0
    v_mfma_f32_16x16x32_bf16 v[192:195], v[92:95], v[52:55], v[192:195]
    s_mov_b64 vcc, s[56:57]
    s_nop 0
    s_mul_i32 s48, s3, 1835008
    s_add_u32 s48, s48, 33554432
    v_mfma_f32_16x16x32_bf16 v[192:195], v[88:91], v[48:51], v[192:195]
    s_and_b32 s49, s4, 7
    s_lshl_b32 s49, s49, 15
    s_add_u32 s48, s48, s49
    s_nop 0
    v_mfma_f32_16x16x32_bf16 v[208:211], v[96:99], v[48:51], v[208:211]
    s_lshr_b32 s49, s4, 3
    s_nop 0
    s_mul_i32 s50, s49, 786432
    s_add_u32 s50, s50, s48
    s_nop 0
    v_mfma_f32_16x16x32_bf16 v[208:211], v[100:103], v[52:55], v[208:211]
    s_add_u32 s51, s50, 4096
    s_mul_i32 s52, s3, 1835008
    s_lshr_b32 s49, s4, 1
    s_nop 0
    v_mfma_f32_16x16x32_bf16 v[212:215], v[100:103], v[60:63], v[212:215]
    s_lshl_b32 s49, s49, 15
    s_add_u32 s52, s52, s49
    s_and_b32 s49, s4, 1
    s_nop 0
    v_mfma_f32_16x16x32_bf16 v[212:215], v[96:99], v[56:59], v[212:215]
    s_lshl_b32 s49, s49, 14
    s_add_u32 s52, s52, s49
    s_add_u32 s52, s52, 35127296
    v_mfma_f32_16x16x32_bf16 v[216:219], v[96:99], v[64:67], v[216:219]
    s_mul_i32 s49, s46, 16376
    s_sub_u32 s52, s52, s49
    s_nop 0
    s_add_u32 s53, s52, 4096
    v_mfma_f32_16x16x32_bf16 v[216:219], v[100:103], v[68:71], v[216:219]
    v_mfma_f32_16x16x32_bf16 v[220:223], v[100:103], v[76:79], v[220:223]
    v_mfma_f32_16x16x32_bf16 v[220:223], v[96:99], v[72:75], v[220:223]
    s_waitcnt lgkmcnt(0)
    s_nop 0
    ds_read_b128 v[48:51], v250 offset:512
    ds_read_b128 v[52:55], v250 offset:1536
    ds_read_b128 v[56:59], v250 offset:576
    ds_read_b128 v[60:63], v250 offset:1600
    ds_read_b128 v[64:67], v251 offset:0
    ds_read_b128 v[68:71], v251 offset:1024
    v_pk_fma_f32 v[104:105], v[16:17], v[80:81], v[20:21] op_sel:[0,1,0] op_sel_hi:[1,1,1]
    v_pk_fma_f32 v[106:107], v[18:19], v[80:81], v[22:23] op_sel:[0,1,0] op_sel_hi:[1,1,1]
    v_pk_fma_f32 v[108:109], v[24:25], v[80:81], v[28:29] op_sel:[0,1,0] op_sel_hi:[1,1,1]
    v_pk_fma_f32 v[110:111], v[26:27], v[80:81], v[30:31] op_sel:[0,1,0] op_sel_hi:[1,1,1]
    v_pk_fma_f32 v[112:113], v[112:113], v[80:81], v[104:105] op_sel_hi:[1,0,1]
    v_pk_fma_f32 v[114:115], v[114:115], v[80:81], v[106:107] op_sel_hi:[1,0,1]
    v_pk_fma_f32 v[128:129], v[128:129], v[80:81], v[108:109] op_sel_hi:[1,0,1]
    v_pk_fma_f32 v[130:131], v[130:131], v[80:81], v[110:111] op_sel_hi:[1,0,1]
    v_pk_mul_f32 v[104:105], v[112:113], v[112:113]
    v_pk_mul_f32 v[106:107], v[114:115], v[114:115]
    v_pk_mul_f32 v[108:109], v[128:129], v[128:129]
    v_pk_mul_f32 v[110:111], v[130:131], v[130:131]
    v_pk_fma_f32 v[104:105], v[104:105], s[88:89], s[88:89] op_sel:[0,0,1] op_sel_hi:[1,0,1]
    v_pk_fma_f32 v[106:107], v[106:107], s[88:89], s[88:89] op_sel:[0,0,1] op_sel_hi:[1,0,1]
    v_pk_fma_f32 v[108:109], v[108:109], s[88:89], s[88:89] op_sel:[0,0,1] op_sel_hi:[1,0,1]
    v_pk_fma_f32 v[110:111], v[110:111], s[88:89], s[88:89] op_sel:[0,0,1] op_sel_hi:[1,0,1]
    v_pk_mul_f32 v[104:105], v[104:105], v[112:113]
    v_pk_mul_f32 v[106:107], v[106:107], v[114:115]
    v_pk_mul_f32 v[108:109], v[108:109], v[128:129]
    v_pk_mul_f32 v[110:111], v[110:111], v[130:131]
    v_exp_f32 v104, v104
    v_exp_f32 v105, v105
    v_exp_f32 v106, v106
    v_exp_f32 v107, v107
    v_exp_f32 v108, v108
    v_exp_f32 v109, v109
    v_exp_f32 v110, v110
    v_exp_f32 v111, v111
    v_pk_add_f32 v[104:105], v[104:105], 1.0 op_sel_hi:[1,0]
    v_pk_add_f32 v[106:107], v[106:107], 1.0 op_sel_hi:[1,0]
    v_pk_add_f32 v[108:109], v[108:109], 1.0 op_sel_hi:[1,0]
    v_pk_add_f32 v[110:111], v[110:111], 1.0 op_sel_hi:[1,0]
    v_rcp_f32 v104, v104
    v_rcp_f32 v105, v105
    v_rcp_f32 v106, v106
    v_rcp_f32 v107, v107
    v_rcp_f32 v108, v108
    v_rcp_f32 v109, v109
    v_rcp_f32 v110, v110
    v_rcp_f32 v111, v111
    v_pk_mul_f32 v[112:113], v[112:113], v[104:105]
    v_pk_mul_f32 v[114:115], v[114:115], v[106:107]
    v_pk_mul_f32 v[128:129], v[128:129], v[108:109]
    v_pk_mul_f32 v[130:131], v[130:131], v[110:111]
    v_cvt_pk_bf16_f32 v224, v112, v113
    v_cvt_pk_bf16_f32 v225, v114, v115
    v_cvt_pk_bf16_f32 v226, v128, v129
    v_cvt_pk_bf16_f32 v227, v130, v131
    s_cbranch_vccnz sms_194
    s_nop 0
    buffer_store_dwordx4 v[224:227], v1, s[16:19], s50 offen offset:0
smd_195:
    v_pk_fma_f32 v[104:105], v[16:17], v[82:83], v[20:21] op_sel:[0,1,0] op_sel_hi:[1,1,1]
    v_pk_fma_f32 v[106:107], v[18:19], v[82:83], v[22:23] op_sel:[0,1,0] op_sel_hi:[1,1,1]
    v_pk_fma_f32 v[108:109], v[24:25], v[82:83], v[28:29] op_sel:[0,1,0] op_sel_hi:[1,1,1]
    v_pk_fma_f32 v[110:111], v[26:27], v[82:83], v[30:31] op_sel:[0,1,0] op_sel_hi:[1,1,1]
    v_pk_fma_f32 v[116:117], v[116:117], v[82:83], v[104:105] op_sel_hi:[1,0,1]
    v_pk_fma_f32 v[118:119], v[118:119], v[82:83], v[106:107] op_sel_hi:[1,0,1]
    v_pk_fma_f32 v[132:133], v[132:133], v[82:83], v[108:109] op_sel_hi:[1,0,1]
    v_pk_fma_f32 v[134:135], v[134:135], v[82:83], v[110:111] op_sel_hi:[1,0,1]
    v_pk_mul_f32 v[104:105], v[116:117], v[116:117]
    v_pk_mul_f32 v[106:107], v[118:119], v[118:119]
    v_pk_mul_f32 v[108:109], v[132:133], v[132:133]
    v_pk_mul_f32 v[110:111], v[134:135], v[134:135]
    v_pk_fma_f32 v[104:105], v[104:105], s[88:89], s[88:89] op_sel:[0,0,1] op_sel_hi:[1,0,1]
    v_pk_fma_f32 v[106:107], v[106:107], s[88:89], s[88:89] op_sel:[0,0,1] op_sel_hi:[1,0,1]
    v_pk_fma_f32 v[108:109], v[108:109], s[88:89], s[88:89] op_sel:[0,0,1] op_sel_hi:[1,0,1]
    v_pk_fma_f32 v[110:111], v[110:111], s[88:89], s[88:89] op_sel:[0,0,1] op_sel_hi:[1,0,1]
    v_pk_mul_f32 v[104:105], v[104:105], v[116:117]
    v_pk_mul_f32 v[106:107], v[106:107], v[118:119]
    v_pk_mul_f32 v[108:109], v[108:109], v[132:133]
    v_pk_mul_f32 v[110:111], v[110:111], v[134:135]
    v_exp_f32 v104, v104
    v_exp_f32 v105, v105
    v_exp_f32 v106, v106
    v_exp_f32 v107, v107
    v_exp_f32 v108, v108
    v_exp_f32 v109, v109
    v_exp_f32 v110, v110
    v_exp_f32 v111, v111
    v_pk_add_f32 v[104:105], v[104:105], 1.0 op_sel_hi:[1,0]
    v_pk_add_f32 v[106:107], v[106:107], 1.0 op_sel_hi:[1,0]
    v_pk_add_f32 v[108:109], v[108:109], 1.0 op_sel_hi:[1,0]
    v_pk_add_f32 v[110:111], v[110:111], 1.0 op_sel_hi:[1,0]
    v_rcp_f32 v104, v104
    v_rcp_f32 v105, v105
    v_rcp_f32 v106, v106
    v_rcp_f32 v107, v107
    v_rcp_f32 v108, v108
    v_rcp_f32 v109, v109
    v_rcp_f32 v110, v110
    v_rcp_f32 v111, v111
    v_pk_mul_f32 v[116:117], v[116:117], v[104:105]
    v_pk_mul_f32 v[118:119], v[118:119], v[106:107]
    v_pk_mul_f32 v[132:133], v[132:133], v[108:109]
    v_pk_mul_f32 v[134:135], v[134:135], v[110:111]
    v_cvt_pk_bf16_f32 v228, v116, v117
    v_cvt_pk_bf16_f32 v229, v118, v119
    v_cvt_pk_bf16_f32 v230, v132, v133
    v_cvt_pk_bf16_f32 v231, v134, v135
    s_cbranch_vccnz sms_196
    s_nop 0
    buffer_store_dwordx4 v[228:231], v1, s[16:19], s50 offen offset:2048
smd_197:
    v_pk_fma_f32 v[104:105], v[16:17], v[84:85], v[20:21] op_sel:[0,1,0] op_sel_hi:[1,1,1]
    v_pk_fma_f32 v[106:107], v[18:19], v[84:85], v[22:23] op_sel:[0,1,0] op_sel_hi:[1,1,1]
    v_pk_fma_f32 v[108:109], v[24:25], v[84:85], v[28:29] op_sel:[0,1,0] op_sel_hi:[1,1,1]
    v_pk_fma_f32 v[110:111], v[26:27], v[84:85], v[30:31] op_sel:[0,1,0] op_sel_hi:[1,1,1]
    v_pk_fma_f32 v[120:121], v[120:121], v[84:85], v[104:105] op_sel_hi:[1,0,1]
    v_pk_fma_f32 v[122:123], v[122:123], v[84:85], v[106:107] op_sel_hi:[1,0,1]
    v_pk_fma_f32 v[136:137], v[136:137], v[84:85], v[108:109] op_sel_hi:[1,0,1]
    v_pk_fma_f32 v[138:139], v[138:139], v[84:85], v[110:111] op_sel_hi:[1,0,1]
    v_pk_mul_f32 v[104:105], v[120:121], v[120:121]
    v_pk_mul_f32 v[106:107], v[122:123], v[122:123]
    v_pk_mul_f32 v[108:109], v[136:137], v[136:137]
    v_pk_mul_f32 v[110:111], v[138:139], v[138:139]
    v_pk_fma_f32 v[104:105], v[104:105], s[88:89], s[88:89] op_sel:[0,0,1] op_sel_hi:[1,0,1]
    v_pk_fma_f32 v[106:107], v[106:107], s[88:89], s[88:89] op_sel:[0,0,1] op_sel_hi:[1,0,1]
    v_pk_fma_f32 v[108:109], v[108:109], s[88:89], s[88:89] op_sel:[0,0,1] op_sel_hi:[1,0,1]
    v_pk_fma_f32 v[110:111], v[110:111], s[88:89], s[88:89] op_sel:[0,0,1] op_sel_hi:[1,0,1]
    v_pk_mul_f32 v[104:105], v[104:105], v[120:121]
    v_pk_mul_f32 v[106:107], v[106:107], v[122:123]
    v_pk_mul_f32 v[108:109], v[108:109], v[136:137]
    v_pk_mul_f32 v[110:111], v[110:111], v[138:139]
    v_exp_f32 v104, v104
    v_exp_f32 v105, v105
    v_exp_f32 v106, v106
    v_exp_f32 v107, v107
    v_exp_f32 v108, v108
    v_exp_f32 v109, v109
    v_exp_f32 v110, v110
    v_exp_f32 v111, v111
    v_pk_add_f32 v[104:105], v[104:105], 1.0 op_sel_hi:[1,0]
    v_pk_add_f32 v[106:107], v[106:107], 1.0 op_sel_hi:[1,0]
    v_pk_add_f32 v[108:109], v[108:109], 1.0 op_sel_hi:[1,0]
    v_pk_add_f32 v[110:111], v[110:111], 1.0 op_sel_hi:[1,0]
    v_rcp_f32 v104, v104
    v_rcp_f32 v105, v105
    v_rcp_f32 v106, v106
    v_rcp_f32 v107, v107
    v_rcp_f32 v108, v108
    v_rcp_f32 v109, v109
    v_rcp_f32 v110, v110
    v_rcp_f32 v111, v111
    v_pk_mul_f32 v[120:121], v[120:121], v[104:105]
    v_pk_mul_f32 v[122:123], v[122:123], v[106:107]
    v_pk_mul_f32 v[136:137], v[136:137], v[108:109]
    v_pk_mul_f32 v[138:139], v[138:139], v[110:111]
    v_cvt_pk_bf16_f32 v232, v120, v121
    v_cvt_pk_bf16_f32 v233, v122, v123
    v_cvt_pk_bf16_f32 v234, v136, v137
    v_cvt_pk_bf16_f32 v235, v138, v139
    s_cbranch_vccnz sms_198
    s_nop 0
    buffer_store_dwordx4 v[232:235], v1, s[16:19], s51 offen offset:0
smd_199:
    v_pk_fma_f32 v[104:105], v[16:17], v[86:87], v[20:21] op_sel:[0,1,0] op_sel_hi:[1,1,1]
    v_pk_fma_f32 v[106:107], v[18:19], v[86:87], v[22:23] op_sel:[0,1,0] op_sel_hi:[1,1,1]
    v_pk_fma_f32 v[108:109], v[24:25], v[86:87], v[28:29] op_sel:[0,1,0] op_sel_hi:[1,1,1]
    v_pk_fma_f32 v[110:111], v[26:27], v[86:87], v[30:31] op_sel:[0,1,0] op_sel_hi:[1,1,1]
    v_pk_fma_f32 v[124:125], v[124:125], v[86:87], v[104:105] op_sel_hi:[1,0,1]
    v_pk_fma_f32 v[126:127], v[126:127], v[86:87], v[106:107] op_sel_hi:[1,0,1]
    v_pk_fma_f32 v[140:141], v[140:141], v[86:87], v[108:109] op_sel_hi:[1,0,1]
    v_pk_fma_f32 v[142:143], v[142:143], v[86:87], v[110:111] op_sel_hi:[1,0,1]
    v_pk_mul_f32 v[104:105], v[124:125], v[124:125]
    v_pk_mul_f32 v[106:107], v[126:127], v[126:127]
    v_pk_mul_f32 v[108:109], v[140:141], v[140:141]
    v_pk_mul_f32 v[110:111], v[142:143], v[142:143]
    v_pk_fma_f32 v[104:105], v[104:105], s[88:89], s[88:89] op_sel:[0,0,1] op_sel_hi:[1,0,1]
    v_pk_fma_f32 v[106:107], v[106:107], s[88:89], s[88:89] op_sel:[0,0,1] op_sel_hi:[1,0,1]
    v_pk_fma_f32 v[108:109], v[108:109], s[88:89], s[88:89] op_sel:[0,0,1] op_sel_hi:[1,0,1]
    v_pk_fma_f32 v[110:111], v[110:111], s[88:89], s[88:89] op_sel:[0,0,1] op_sel_hi:[1,0,1]
    v_pk_mul_f32 v[104:105], v[104:105], v[124:125]
    v_pk_mul_f32 v[106:107], v[106:107], v[126:127]
    v_pk_mul_f32 v[108:109], v[108:109], v[140:141]
    v_pk_mul_f32 v[110:111], v[110:111], v[142:143]
    v_exp_f32 v104, v104
    v_exp_f32 v105, v105
    v_exp_f32 v106, v106
    v_exp_f32 v107, v107
    v_exp_f32 v108, v108
    v_exp_f32 v109, v109
    v_exp_f32 v110, v110
    v_exp_f32 v111, v111
    v_pk_add_f32 v[104:105], v[104:105], 1.0 op_sel_hi:[1,0]
    v_pk_add_f32 v[106:107], v[106:107], 1.0 op_sel_hi:[1,0]
    v_pk_add_f32 v[108:109], v[108:109], 1.0 op_sel_hi:[1,0]
    v_pk_add_f32 v[110:111], v[110:111], 1.0 op_sel_hi:[1,0]
    v_rcp_f32 v104, v104
    v_rcp_f32 v105, v105
    v_rcp_f32 v106, v106
    v_rcp_f32 v107, v107
    v_rcp_f32 v108, v108
    v_rcp_f32 v109, v109
    v_rcp_f32 v110, v110
    v_rcp_f32 v111, v111
    v_pk_mul_f32 v[124:125], v[124:125], v[104:105]
    v_pk_mul_f32 v[126:127], v[126:127], v[106:107]
    v_pk_mul_f32 v[140:141], v[140:141], v[108:109]
    v_pk_mul_f32 v[142:143], v[142:143], v[110:111]
    v_cvt_pk_bf16_f32 v236, v124, v125
    v_cvt_pk_bf16_f32 v237, v126, v127
    v_cvt_pk_bf16_f32 v238, v140, v141
    v_cvt_pk_bf16_f32 v239, v142, v143
    s_cbranch_vccnz sms_200
    s_nop 0
    buffer_store_dwordx4 v[236:239], v1, s[16:19], s51 offen offset:2048
smd_201:
    s_add_u32 s50, s50, 262144
    s_add_u32 s51, s51, 262144
    s_waitcnt lgkmcnt(0)
    s_nop 0
    v_pk_fma_f32 v[104:105], v[32:33], v[80:81], v[36:37] op_sel:[0,1,0] op_sel_hi:[1,1,1]
    v_pk_fma_f32 v[106:107], v[34:35], v[80:81], v[38:39] op_sel:[0,1,0] op_sel_hi:[1,1,1]
    v_pk_fma_f32 v[108:109], v[40:41], v[80:81], v[44:45] op_sel:[0,1,0] op_sel_hi:[1,1,1]
    v_pk_fma_f32 v[110:111], v[42:43], v[80:81], v[46:47] op_sel:[0,1,0] op_sel_hi:[1,1,1]
    v_pk_fma_f32 v[144:145], v[144:145], v[80:81], v[104:105] op_sel_hi:[1,0,1]
    v_pk_fma_f32 v[146:147], v[146:147], v[80:81], v[106:107] op_sel_hi:[1,0,1]
    v_pk_fma_f32 v[160:161], v[160:161], v[80:81], v[108:109] op_sel_hi:[1,0,1]
    v_pk_fma_f32 v[162:163], v[162:163], v[80:81], v[110:111] op_sel_hi:[1,0,1]
    v_pk_mul_f32 v[104:105], v[144:145], v[144:145]
    v_pk_mul_f32 v[106:107], v[146:147], v[146:147]
    v_pk_mul_f32 v[108:109], v[160:161], v[160:161]
    v_pk_mul_f32 v[110:111], v[162:163], v[162:163]
    v_pk_fma_f32 v[104:105], v[104:105], s[88:89], s[88:89] op_sel:[0,0,1] op_sel_hi:[1,0,1]
    v_pk_fma_f32 v[106:107], v[106:107], s[88:89], s[88:89] op_sel:[0,0,1] op_sel_hi:[1,0,1]
    v_pk_fma_f32 v[108:109], v[108:109], s[88:89], s[88:89] op_sel:[0,0,1] op_sel_hi:[1,0,1]
    v_pk_fma_f32 v[110:111], v[110:111], s[88:89], s[88:89] op_sel:[0,0,1] op_sel_hi:[1,0,1]
    v_pk_mul_f32 v[104:105], v[104:105], v[144:145]
    v_pk_mul_f32 v[106:107], v[106:107], v[146:147]
    v_pk_mul_f32 v[108:109], v[108:109], v[160:161]
    v_pk_mul_f32 v[110:111], v[110:111], v[162:163]
    v_exp_f32 v104, v104
    v_exp_f32 v105, v105
    v_exp_f32 v106, v106
    v_exp_f32 v107, v107
    v_exp_f32 v108, v108
    v_exp_f32 v109, v109
    v_exp_f32 v110, v110
    v_exp_f32 v111, v111
    v_pk_add_f32 v[104:105], v[104:105], 1.0 op_sel_hi:[1,0]
    v_pk_add_f32 v[106:107], v[106:107], 1.0 op_sel_hi:[1,0]
    v_pk_add_f32 v[108:109], v[108:109], 1.0 op_sel_hi:[1,0]
    v_pk_add_f32 v[110:111], v[110:111], 1.0 op_sel_hi:[1,0]
    v_rcp_f32 v104, v104
    v_rcp_f32 v105, v105
    v_rcp_f32 v106, v106
    v_rcp_f32 v107, v107
    v_rcp_f32 v108, v108
    v_rcp_f32 v109, v109
    v_rcp_f32 v110, v110
    v_rcp_f32 v111, v111
    v_pk_mul_f32 v[144:145], v[144:145], v[104:105]
    v_pk_mul_f32 v[146:147], v[146:147], v[106:107]
    v_pk_mul_f32 v[160:161], v[160:161], v[108:109]
    v_pk_mul_f32 v[162:163], v[162:163], v[110:111]
    v_cvt_pk_bf16_f32 v224, v144, v145
    v_cvt_pk_bf16_f32 v225, v146, v147
    v_cvt_pk_bf16_f32 v226, v160, v161
    v_cvt_pk_bf16_f32 v227, v162, v163
    buffer_store_dwordx4 v[224:227], v1, s[16:19], s50 offen offset:0 sc1
    s_add_u32 s48, s47, 5
    v_mov_b32 v254, s48
    s_cmp_eq_u32 s44, 0
    s_waitcnt vmcnt(1)
    s_cbranch_scc0 sigs_202
    s_nop 0
    buffer_store_dword v254, v14, s[16:19], 0 offen
sigd_203:
    v_pk_fma_f32 v[104:105], v[32:33], v[82:83], v[36:37] op_sel:[0,1,0] op_sel_hi:[1,1,1]
    v_pk_fma_f32 v[106:107], v[34:35], v[82:83], v[38:39] op_sel:[0,1,0] op_sel_hi:[1,1,1]
    v_pk_fma_f32 v[108:109], v[40:41], v[82:83], v[44:45] op_sel:[0,1,0] op_sel_hi:[1,1,1]
    v_pk_fma_f32 v[110:111], v[42:43], v[82:83], v[46:47] op_sel:[0,1,0] op_sel_hi:[1,1,1]
    v_pk_fma_f32 v[148:149], v[148:149], v[82:83], v[104:105] op_sel_hi:[1,0,1]
    v_pk_fma_f32 v[150:151], v[150:151], v[82:83], v[106:107] op_sel_hi:[1,0,1]
    v_pk_fma_f32 v[164:165], v[164:165], v[82:83], v[108:109] op_sel_hi:[1,0,1]
    v_pk_fma_f32 v[166:167], v[166:167], v[82:83], v[110:111] op_sel_hi:[1,0,1]
    v_pk_mul_f32 v[104:105], v[148:149], v[148:149]
    v_pk_mul_f32 v[106:107], v[150:151], v[150:151]
    v_pk_mul_f32 v[108:109], v[164:165], v[164:165]
    v_pk_mul_f32 v[110:111], v[166:167], v[166:167]
    v_pk_fma_f32 v[104:105], v[104:105], s[88:89], s[88:89] op_sel:[0,0,1] op_sel_hi:[1,0,1]
    v_pk_fma_f32 v[106:107], v[106:107], s[88:89], s[88:89] op_sel:[0,0,1] op_sel_hi:[1,0,1]
    v_pk_fma_f32 v[108:109], v[108:109], s[88:89], s[88:89] op_sel:[0,0,1] op_sel_hi:[1,0,1]
    v_pk_fma_f32 v[110:111], v[110:111], s[88:89], s[88:89] op_sel:[0,0,1] op_sel_hi:[1,0,1]
    v_pk_mul_f32 v[104:105], v[104:105], v[148:149]
    v_pk_mul_f32 v[106:107], v[106:107], v[150:151]
    v_pk_mul_f32 v[108:109], v[108:109], v[164:165]
    v_pk_mul_f32 v[110:111], v[110:111], v[166:167]
    v_exp_f32 v104, v104
    v_exp_f32 v105, v105
    v_exp_f32 v106, v106
    v_exp_f32 v107, v107
    v_exp_f32 v108, v108
    v_exp_f32 v109, v109
    v_exp_f32 v110, v110
    v_exp_f32 v111, v111
    v_pk_add_f32 v[104:105], v[104:105], 1.0 op_sel_hi:[1,0]
    v_pk_add_f32 v[106:107], v[106:107], 1.0 op_sel_hi:[1,0]
    v_pk_add_f32 v[108:109], v[108:109], 1.0 op_sel_hi:[1,0]
    v_pk_add_f32 v[110:111], v[110:111], 1.0 op_sel_hi:[1,0]
    v_rcp_f32 v104, v104
    v_rcp_f32 v105, v105
    v_rcp_f32 v106, v106
    v_rcp_f32 v107, v107
    v_rcp_f32 v108, v108
    v_rcp_f32 v109, v109
    v_rcp_f32 v110, v110
    v_rcp_f32 v111, v111
    v_pk_mul_f32 v[148:149], v[148:149], v[104:105]
    v_pk_mul_f32 v[150:151], v[150:151], v[106:107]
    v_pk_mul_f32 v[164:165], v[164:165], v[108:109]
    v_pk_mul_f32 v[166:167], v[166:167], v[110:111]
    v_cvt_pk_bf16_f32 v228, v148, v149
    v_cvt_pk_bf16_f32 v229, v150, v151
    v_cvt_pk_bf16_f32 v230, v164, v165
    v_cvt_pk_bf16_f32 v231, v166, v167
    buffer_store_dwordx4 v[228:231], v1, s[16:19], s50 offen offset:2048 sc1
    v_pk_fma_f32 v[104:105], v[32:33], v[84:85], v[36:37] op_sel:[0,1,0] op_sel_hi:[1,1,1]
    v_pk_fma_f32 v[106:107], v[34:35], v[84:85], v[38:39] op_sel:[0,1,0] op_sel_hi:[1,1,1]
    v_pk_fma_f32 v[108:109], v[40:41], v[84:85], v[44:45] op_sel:[0,1,0] op_sel_hi:[1,1,1]
    v_pk_fma_f32 v[110:111], v[42:43], v[84:85], v[46:47] op_sel:[0,1,0] op_sel_hi:[1,1,1]
    v_pk_fma_f32 v[152:153], v[152:153], v[84:85], v[104:105] op_sel_hi:[1,0,1]
    v_pk_fma_f32 v[154:155], v[154:155], v[84:85], v[106:107] op_sel_hi:[1,0,1]
    v_pk_fma_f32 v[168:169], v[168:169], v[84:85], v[108:109] op_sel_hi:[1,0,1]
    v_pk_fma_f32 v[170:171], v[170:171], v[84:85], v[110:111] op_sel_hi:[1,0,1]
    v_pk_mul_f32 v[104:105], v[152:153], v[152:153]
    v_pk_mul_f32 v[106:107], v[154:155], v[154:155]
    v_pk_mul_f32 v[108:109], v[168:169], v[168:169]
    v_pk_mul_f32 v[110:111], v[170:171], v[170:171]
    v_pk_fma_f32 v[104:105], v[104:105], s[88:89], s[88:89] op_sel:[0,0,1] op_sel_hi:[1,0,1]
    v_pk_fma_f32 v[106:107], v[106:107], s[88:89], s[88:89] op_sel:[0,0,1] op_sel_hi:[1,0,1]
    v_pk_fma_f32 v[108:109], v[108:109], s[88:89], s[88:89] op_sel:[0,0,1] op_sel_hi:[1,0,1]
    v_pk_fma_f32 v[110:111], v[110:111], s[88:89], s[88:89] op_sel:[0,0,1] op_sel_hi:[1,0,1]
    v_pk_mul_f32 v[104:105], v[104:105], v[152:153]
    v_pk_mul_f32 v[106:107], v[106:107], v[154:155]
    v_pk_mul_f32 v[108:109], v[108:109], v[168:169]
    v_pk_mul_f32 v[110:111], v[110:111], v[170:171]
    v_exp_f32 v104, v104
    v_exp_f32 v105, v105
    v_exp_f32 v106, v106
    v_exp_f32 v107, v107
    v_exp_f32 v108, v108
    v_exp_f32 v109, v109
    v_exp_f32 v110, v110
    v_exp_f32 v111, v111
    v_pk_add_f32 v[104:105], v[104:105], 1.0 op_sel_hi:[1,0]
    v_pk_add_f32 v[106:107], v[106:107], 1.0 op_sel_hi:[1,0]
    v_pk_add_f32 v[108:109], v[108:109], 1.0 op_sel_hi:[1,0]
    v_pk_add_f32 v[110:111], v[110:111], 1.0 op_sel_hi:[1,0]
    v_rcp_f32 v104, v104
    v_rcp_f32 v105, v105
    v_rcp_f32 v106, v106
    v_rcp_f32 v107, v107
    v_rcp_f32 v108, v108
    v_rcp_f32 v109, v109
    v_rcp_f32 v110, v110
    v_rcp_f32 v111, v111
    v_pk_mul_f32 v[152:153], v[152:153], v[104:105]
    v_pk_mul_f32 v[154:155], v[154:155], v[106:107]
    v_pk_mul_f32 v[168:169], v[168:169], v[108:109]
    v_pk_mul_f32 v[170:171], v[170:171], v[110:111]
    v_cvt_pk_bf16_f32 v232, v152, v153
    v_cvt_pk_bf16_f32 v233, v154, v155
    v_cvt_pk_bf16_f32 v234, v168, v169
    v_cvt_pk_bf16_f32 v235, v170, v171
    buffer_store_dwordx4 v[232:235], v1, s[16:19], s51 offen offset:0 sc1
    v_pk_fma_f32 v[104:105], v[32:33], v[86:87], v[36:37] op_sel:[0,1,0] op_sel_hi:[1,1,1]
    v_pk_fma_f32 v[106:107], v[34:35], v[86:87], v[38:39] op_sel:[0,1,0] op_sel_hi:[1,1,1]
    v_pk_fma_f32 v[108:109], v[40:41], v[86:87], v[44:45] op_sel:[0,1,0] op_sel_hi:[1,1,1]
    v_pk_fma_f32 v[110:111], v[42:43], v[86:87], v[46:47] op_sel:[0,1,0] op_sel_hi:[1,1,1]
    v_pk_fma_f32 v[156:157], v[156:157], v[86:87], v[104:105] op_sel_hi:[1,0,1]
    v_pk_fma_f32 v[158:159], v[158:159], v[86:87], v[106:107] op_sel_hi:[1,0,1]
    v_pk_fma_f32 v[172:173], v[172:173], v[86:87], v[108:109] op_sel_hi:[1,0,1]
    v_pk_fma_f32 v[174:175], v[174:175], v[86:87], v[110:111] op_sel_hi:[1,0,1]
    v_pk_mul_f32 v[104:105], v[156:157], v[156:157]
    v_pk_mul_f32 v[106:107], v[158:159], v[158:159]
    v_pk_mul_f32 v[108:109], v[172:173], v[172:173]
    v_pk_mul_f32 v[110:111], v[174:175], v[174:175]
    v_pk_fma_f32 v[104:105], v[104:105], s[88:89], s[88:89] op_sel:[0,0,1] op_sel_hi:[1,0,1]
    v_pk_fma_f32 v[106:107], v[106:107], s[88:89], s[88:89] op_sel:[0,0,1] op_sel_hi:[1,0,1]
    v_pk_fma_f32 v[108:109], v[108:109], s[88:89], s[88:89] op_sel:[0,0,1] op_sel_hi:[1,0,1]
    v_pk_fma_f32 v[110:111], v[110:111], s[88:89], s[88:89] op_sel:[0,0,1] op_sel_hi:[1,0,1]
    v_pk_mul_f32 v[104:105], v[104:105], v[156:157]
    v_pk_mul_f32 v[106:107], v[106:107], v[158:159]
    v_pk_mul_f32 v[108:109], v[108:109], v[172:173]
    v_pk_mul_f32 v[110:111], v[110:111], v[174:175]
    v_exp_f32 v104, v104
    v_exp_f32 v105, v105
    v_exp_f32 v106, v106
    v_exp_f32 v107, v107
    v_exp_f32 v108, v108
    v_exp_f32 v109, v109
    v_exp_f32 v110, v110
    v_exp_f32 v111, v111
    v_pk_add_f32 v[104:105], v[104:105], 1.0 op_sel_hi:[1,0]
    v_pk_add_f32 v[106:107], v[106:107], 1.0 op_sel_hi:[1,0]
    v_pk_add_f32 v[108:109], v[108:109], 1.0 op_sel_hi:[1,0]
    v_pk_add_f32 v[110:111], v[110:111], 1.0 op_sel_hi:[1,0]
    v_rcp_f32 v104, v104
    v_rcp_f32 v105, v105
    v_rcp_f32 v106, v106
    v_rcp_f32 v107, v107
    v_rcp_f32 v108, v108
    v_rcp_f32 v109, v109
    v_rcp_f32 v110, v110
    v_rcp_f32 v111, v111
    v_pk_mul_f32 v[156:157], v[156:157], v[104:105]
    v_pk_mul_f32 v[158:159], v[158:159], v[106:107]
    v_pk_mul_f32 v[172:173], v[172:173], v[108:109]
    v_pk_mul_f32 v[174:175], v[174:175], v[110:111]
    v_cvt_pk_bf16_f32 v236, v156, v157
    v_cvt_pk_bf16_f32 v237, v158, v159
    v_cvt_pk_bf16_f32 v238, v172, v173
    v_cvt_pk_bf16_f32 v239, v174, v175
    buffer_store_dwordx4 v[236:239], v1, s[16:19], s51 offen offset:2048 sc1
    s_add_u32 s50, s50, 262144
    s_add_u32 s51, s51, 262144
    v_pk_fma_f32 v[104:105], v[64:65], v[80:81], v[68:69] op_sel:[0,1,0] op_sel_hi:[1,1,1]
    v_pk_fma_f32 v[106:107], v[66:67], v[80:81], v[70:71] op_sel:[0,1,0] op_sel_hi:[1,1,1]
    v_pk_fma_f32 v[108:109], v[64:65], v[82:83], v[68:69] op_sel:[0,1,0] op_sel_hi:[1,1,1]
    v_pk_fma_f32 v[110:111], v[66:67], v[82:83], v[70:71] op_sel:[0,1,0] op_sel_hi:[1,1,1]
    v_pk_fma_f32 v[208:209], v[208:209], v[80:81], v[104:105] op_sel_hi:[1,0,1]
    v_pk_fma_f32 v[210:211], v[210:211], v[80:81], v[106:107] op_sel_hi:[1,0,1]
    v_pk_fma_f32 v[212:213], v[212:213], v[82:83], v[108:109] op_sel_hi:[1,0,1]
    v_pk_fma_f32 v[214:215], v[214:215], v[82:83], v[110:111] op_sel_hi:[1,0,1]
    v_pk_mul_f32 v[104:105], v[208:209], v[208:209]
    v_pk_mul_f32 v[106:107], v[210:211], v[210:211]
    v_pk_mul_f32 v[108:109], v[212:213], v[212:213]
    v_pk_mul_f32 v[110:111], v[214:215], v[214:215]
    v_pk_fma_f32 v[104:105], v[104:105], s[88:89], s[88:89] op_sel:[0,0,1] op_sel_hi:[1,0,1]
    v_pk_fma_f32 v[106:107], v[106:107], s[88:89], s[88:89] op_sel:[0,0,1] op_sel_hi:[1,0,1]
    v_pk_fma_f32 v[108:109], v[108:109], s[88:89], s[88:89] op_sel:[0,0,1] op_sel_hi:[1,0,1]
    v_pk_fma_f32 v[110:111], v[110:111], s[88:89], s[88:89] op_sel:[0,0,1] op_sel_hi:[1,0,1]
    v_pk_mul_f32 v[104:105], v[104:105], v[208:209]
    v_pk_mul_f32 v[106:107], v[106:107], v[210:211]
    v_pk_mul_f32 v[108:109], v[108:109], v[212:213]
    v_pk_mul_f32 v[110:111], v[110:111], v[214:215]
    v_exp_f32 v104, v104
    v_exp_f32 v105, v105
    v_exp_f32 v106, v106
    v_exp_f32 v107, v107
    v_exp_f32 v108, v108
    v_exp_f32 v109, v109
    v_exp_f32 v110, v110
    v_exp_f32 v111, v111
    v_pk_add_f32 v[104:105], v[104:105], 1.0 op_sel_hi:[1,0]
    v_pk_add_f32 v[106:107], v[106:107], 1.0 op_sel_hi:[1,0]
    v_pk_add_f32 v[108:109], v[108:109], 1.0 op_sel_hi:[1,0]
    v_pk_add_f32 v[110:111], v[110:111], 1.0 op_sel_hi:[1,0]
    v_rcp_f32 v104, v104
    v_rcp_f32 v105, v105
    v_rcp_f32 v106, v106
    v_rcp_f32 v107, v107
    v_rcp_f32 v108, v108
    v_rcp_f32 v109, v109
    v_rcp_f32 v110, v110
    v_rcp_f32 v111, v111
    v_pk_mul_f32 v[208:209], v[208:209], v[104:105]
    v_pk_mul_f32 v[210:211], v[210:211], v[106:107]
    v_pk_mul_f32 v[212:213], v[212:213], v[108:109]
    v_pk_mul_f32 v[214:215], v[214:215], v[110:111]
    v_cvt_pk_bf16_f32 v224, v208, v209
    v_cvt_pk_bf16_f32 v225, v210, v211
    v_cvt_pk_bf16_f32 v226, v212, v213
    v_cvt_pk_bf16_f32 v227, v214, v215
    s_cbranch_vccnz sms_204
    s_nop 0
    buffer_store_dwordx2 v[224:225], v1, s[16:19], s52 offen offset:0
    buffer_store_dwordx2 v[226:227], v1, s[16:19], s52 offen offset:2048
smd_205:
    v_pk_fma_f32 v[104:105], v[64:65], v[84:85], v[68:69] op_sel:[0,1,0] op_sel_hi:[1,1,1]
    v_pk_fma_f32 v[106:107], v[66:67], v[84:85], v[70:71] op_sel:[0,1,0] op_sel_hi:[1,1,1]
    v_pk_fma_f32 v[108:109], v[64:65], v[86:87], v[68:69] op_sel:[0,1,0] op_sel_hi:[1,1,1]
    v_pk_fma_f32 v[110:111], v[66:67], v[86:87], v[70:71] op_sel:[0,1,0] op_sel_hi:[1,1,1]
    v_pk_fma_f32 v[216:217], v[216:217], v[84:85], v[104:105] op_sel_hi:[1,0,1]
    v_pk_fma_f32 v[218:219], v[218:219], v[84:85], v[106:107] op_sel_hi:[1,0,1]
    v_pk_fma_f32 v[220:221], v[220:221], v[86:87], v[108:109] op_sel_hi:[1,0,1]
    v_pk_fma_f32 v[222:223], v[222:223], v[86:87], v[110:111] op_sel_hi:[1,0,1]
    v_pk_mul_f32 v[104:105], v[216:217], v[216:217]
    v_pk_mul_f32 v[106:107], v[218:219], v[218:219]
    v_pk_mul_f32 v[108:109], v[220:221], v[220:221]
    v_pk_mul_f32 v[110:111], v[222:223], v[222:223]
    v_pk_fma_f32 v[104:105], v[104:105], s[88:89], s[88:89] op_sel:[0,0,1] op_sel_hi:[1,0,1]
    v_pk_fma_f32 v[106:107], v[106:107], s[88:89], s[88:89] op_sel:[0,0,1] op_sel_hi:[1,0,1]
    v_pk_fma_f32 v[108:109], v[108:109], s[88:89], s[88:89] op_sel:[0,0,1] op_sel_hi:[1,0,1]
    v_pk_fma_f32 v[110:111], v[110:111], s[88:89], s[88:89] op_sel:[0,0,1] op_sel_hi:[1,0,1]
    v_pk_mul_f32 v[104:105], v[104:105], v[216:217]
    v_pk_mul_f32 v[106:107], v[106:107], v[218:219]
    v_pk_mul_f32 v[108:109], v[108:109], v[220:221]
    v_pk_mul_f32 v[110:111], v[110:111], v[222:223]
    v_exp_f32 v104, v104
    v_exp_f32 v105, v105
    v_exp_f32 v106, v106
    v_exp_f32 v107, v107
    v_exp_f32 v108, v108
    v_exp_f32 v109, v109
    v_exp_f32 v110, v110
    v_exp_f32 v111, v111
    v_pk_add_f32 v[104:105], v[104:105], 1.0 op_sel_hi:[1,0]
    v_pk_add_f32 v[106:107], v[106:107], 1.0 op_sel_hi:[1,0]
    v_pk_add_f32 v[108:109], v[108:109], 1.0 op_sel_hi:[1,0]
    v_pk_add_f32 v[110:111], v[110:111], 1.0 op_sel_hi:[1,0]
    v_rcp_f32 v104, v104
    v_rcp_f32 v105, v105
    v_rcp_f32 v106, v106
    v_rcp_f32 v107, v107
    v_rcp_f32 v108, v108
    v_rcp_f32 v109, v109
    v_rcp_f32 v110, v110
    v_rcp_f32 v111, v111
    v_pk_mul_f32 v[216:217], v[216:217], v[104:105]
    v_pk_mul_f32 v[218:219], v[218:219], v[106:107]
    v_pk_mul_f32 v[220:221], v[220:221], v[108:109]
    v_pk_mul_f32 v[222:223], v[222:223], v[110:111]
    v_cvt_pk_bf16_f32 v228, v216, v217
    v_cvt_pk_bf16_f32 v229, v218, v219
    v_cvt_pk_bf16_f32 v230, v220, v221
    v_cvt_pk_bf16_f32 v231, v222, v223
    s_cbranch_vccnz sms_206
    s_nop 0
    buffer_store_dwordx2 v[228:229], v1, s[16:19], s53 offen offset:0
    buffer_store_dwordx2 v[230:231], v1, s[16:19], s53 offen offset:2048
smd_207:
    ds_read_b64 v[144:145], v2 offset:0
    ds_read_b64 v[146:147], v3 offset:0
    ds_read_b64 v[148:149], v2 offset:2048
    ds_read_b64 v[150:151], v3 offset:2048
    ds_read_b64 v[152:153], v2 offset:4096
    ds_read_b64 v[154:155], v3 offset:4096
    ds_read_b64 v[156:157], v2 offset:6144
    ds_read_b64 v[158:159], v3 offset:6144
    s_lshl_b32 s48, s46, 7
    s_nop 0
    s_add_u32 s48, s48, 155648
    v_and_b32 v252, 48, v0
    v_add_u32 v252, s48, v252
    ds_read_b128 v[160:163], v252 offset:0
    ds_read_b128 v[164:167], v252 offset:64
    s_or_b64 vcc, vcc, s[54:55]
    s_nop 0
    v_pk_fma_f32 v[104:105], v[48:49], v[80:81], v[52:53] op_sel:[0,1,0] op_sel_hi:[1,1,1]
    v_pk_fma_f32 v[106:107], v[50:51], v[80:81], v[54:55] op_sel:[0,1,0] op_sel_hi:[1,1,1]
    v_pk_fma_f32 v[108:109], v[56:57], v[80:81], v[60:61] op_sel:[0,1,0] op_sel_hi:[1,1,1]
    v_pk_fma_f32 v[110:111], v[58:59], v[80:81], v[62:63] op_sel:[0,1,0] op_sel_hi:[1,1,1]
    v_pk_fma_f32 v[176:177], v[176:177], v[80:81], v[104:105] op_sel_hi:[1,0,1]
    v_pk_fma_f32 v[178:179], v[178:179], v[80:81], v[106:107] op_sel_hi:[1,0,1]
    v_pk_fma_f32 v[192:193], v[192:193], v[80:81], v[108:109] op_sel_hi:[1,0,1]
    v_pk_fma_f32 v[194:195], v[194:195], v[80:81], v[110:111] op_sel_hi:[1,0,1]
    v_pk_mul_f32 v[104:105], v[176:177], v[176:177]
    v_pk_mul_f32 v[106:107], v[178:179], v[178:179]
    v_pk_mul_f32 v[108:109], v[192:193], v[192:193]
    v_pk_mul_f32 v[110:111], v[194:195], v[194:195]
    v_pk_fma_f32 v[104:105], v[104:105], s[88:89], s[88:89] op_sel:[0,0,1] op_sel_hi:[1,0,1]
    v_pk_fma_f32 v[106:107], v[106:107], s[88:89], s[88:89] op_sel:[0,0,1] op_sel_hi:[1,0,1]
    v_pk_fma_f32 v[108:109], v[108:109], s[88:89], s[88:89] op_sel:[0,0,1] op_sel_hi:[1,0,1]
    v_pk_fma_f32 v[110:111], v[110:111], s[88:89], s[88:89] op_sel:[0,0,1] op_sel_hi:[1,0,1]
    v_pk_mul_f32 v[104:105], v[104:105], v[176:177]
    v_pk_mul_f32 v[106:107], v[106:107], v[178:179]
    v_pk_mul_f32 v[108:109], v[108:109], v[192:193]
    v_pk_mul_f32 v[110:111], v[110:111], v[194:195]
    v_exp_f32 v104, v104
    v_exp_f32 v105, v105
    v_exp_f32 v106, v106
    v_exp_f32 v107, v107
    v_exp_f32 v108, v108
    v_exp_f32 v109, v109
    v_exp_f32 v110, v110
    v_exp_f32 v111, v111
    v_pk_add_f32 v[104:105], v[104:105], 1.0 op_sel_hi:[1,0]
    v_pk_add_f32 v[106:107], v[106:107], 1.0 op_sel_hi:[1,0]
    v_pk_add_f32 v[108:109], v[108:109], 1.0 op_sel_hi:[1,0]
    v_pk_add_f32 v[110:111], v[110:111], 1.0 op_sel_hi:[1,0]
    v_rcp_f32 v104, v104
    v_rcp_f32 v105, v105
    v_rcp_f32 v106, v106
    v_rcp_f32 v107, v107
    v_rcp_f32 v108, v108
    v_rcp_f32 v109, v109
    v_rcp_f32 v110, v110
    v_rcp_f32 v111, v111
    v_pk_mul_f32 v[176:177], v[176:177], v[104:105]
    v_pk_mul_f32 v[178:179], v[178:179], v[106:107]
    v_pk_mul_f32 v[192:193], v[192:193], v[108:109]
    v_pk_mul_f32 v[194:195], v[194:195], v[110:111]
    v_cvt_pk_bf16_f32 v232, v176, v177
    v_cvt_pk_bf16_f32 v233, v178, v179
    v_cvt_pk_bf16_f32 v234, v192, v193
    v_cvt_pk_bf16_f32 v235, v194, v195
    s_cbranch_vccnz sms_208
    s_nop 0
    buffer_store_dwordx4 v[232:235], v1, s[16:19], s50 offen offset:0
smd_209:
    v_pk_fma_f32 v[104:105], v[48:49], v[82:83], v[52:53] op_sel:[0,1,0] op_sel_hi:[1,1,1]
    v_pk_fma_f32 v[106:107], v[50:51], v[82:83], v[54:55] op_sel:[0,1,0] op_sel_hi:[1,1,1]
    v_pk_fma_f32 v[108:109], v[56:57], v[82:83], v[60:61] op_sel:[0,1,0] op_sel_hi:[1,1,1]
    v_pk_fma_f32 v[110:111], v[58:59], v[82:83], v[62:63] op_sel:[0,1,0] op_sel_hi:[1,1,1]
    v_pk_fma_f32 v[180:181], v[180:181], v[82:83], v[104:105] op_sel_hi:[1,0,1]
    v_pk_fma_f32 v[182:183], v[182:183], v[82:83], v[106:107] op_sel_hi:[1,0,1]
    v_pk_fma_f32 v[196:197], v[196:197], v[82:83], v[108:109] op_sel_hi:[1,0,1]
    v_pk_fma_f32 v[198:199], v[198:199], v[82:83], v[110:111] op_sel_hi:[1,0,1]
    v_pk_mul_f32 v[104:105], v[180:181], v[180:181]
    v_pk_mul_f32 v[106:107], v[182:183], v[182:183]
    v_pk_mul_f32 v[108:109], v[196:197], v[196:197]
    v_pk_mul_f32 v[110:111], v[198:199], v[198:199]
    v_pk_fma_f32 v[104:105], v[104:105], s[88:89], s[88:89] op_sel:[0,0,1] op_sel_hi:[1,0,1]
    v_pk_fma_f32 v[106:107], v[106:107], s[88:89], s[88:89] op_sel:[0,0,1] op_sel_hi:[1,0,1]
    v_pk_fma_f32 v[108:109], v[108:109], s[88:89], s[88:89] op_sel:[0,0,1] op_sel_hi:[1,0,1]
    v_pk_fma_f32 v[110:111], v[110:111], s[88:89], s[88:89] op_sel:[0,0,1] op_sel_hi:[1,0,1]
    v_pk_mul_f32 v[104:105], v[104:105], v[180:181]
    v_pk_mul_f32 v[106:107], v[106:107], v[182:183]
    v_pk_mul_f32 v[108:109], v[108:109], v[196:197]
    v_pk_mul_f32 v[110:111], v[110:111], v[198:199]
    v_exp_f32 v104, v104
    v_exp_f32 v105, v105
    v_exp_f32 v106, v106
    v_exp_f32 v107, v107
    v_exp_f32 v108, v108
    v_exp_f32 v109, v109
    v_exp_f32 v110, v110
    v_exp_f32 v111, v111
    v_pk_add_f32 v[104:105], v[104:105], 1.0 op_sel_hi:[1,0]
    v_pk_add_f32 v[106:107], v[106:107], 1.0 op_sel_hi:[1,0]
    v_pk_add_f32 v[108:109], v[108:109], 1.0 op_sel_hi:[1,0]
    v_pk_add_f32 v[110:111], v[110:111], 1.0 op_sel_hi:[1,0]
    v_rcp_f32 v104, v104
    v_rcp_f32 v105, v105
    v_rcp_f32 v106, v106
    v_rcp_f32 v107, v107
    v_rcp_f32 v108, v108
    v_rcp_f32 v109, v109
    v_rcp_f32 v110, v110
    v_rcp_f32 v111, v111
    v_pk_mul_f32 v[180:181], v[180:181], v[104:105]
    v_pk_mul_f32 v[182:183], v[182:183], v[106:107]
    v_pk_mul_f32 v[196:197], v[196:197], v[108:109]
    v_pk_mul_f32 v[198:199], v[198:199], v[110:111]
    v_cvt_pk_bf16_f32 v236, v180, v181
    v_cvt_pk_bf16_f32 v237, v182, v183
    v_cvt_pk_bf16_f32 v238, v196, v197
    v_cvt_pk_bf16_f32 v239, v198, v199
    s_cbranch_vccnz sms_210
    s_nop 0
    buffer_store_dwordx4 v[236:239], v1, s[16:19], s50 offen offset:2048
smd_211:
    v_pk_fma_f32 v[104:105], v[48:49], v[84:85], v[52:53] op_sel:[0,1,0] op_sel_hi:[1,1,1]
    v_pk_fma_f32 v[106:107], v[50:51], v[84:85], v[54:55] op_sel:[0,1,0] op_sel_hi:[1,1,1]
    v_pk_fma_f32 v[108:109], v[56:57], v[84:85], v[60:61] op_sel:[0,1,0] op_sel_hi:[1,1,1]
    v_pk_fma_f32 v[110:111], v[58:59], v[84:85], v[62:63] op_sel:[0,1,0] op_sel_hi:[1,1,1]
    v_pk_fma_f32 v[184:185], v[184:185], v[84:85], v[104:105] op_sel_hi:[1,0,1]
    v_pk_fma_f32 v[186:187], v[186:187], v[84:85], v[106:107] op_sel_hi:[1,0,1]
    v_pk_fma_f32 v[200:201], v[200:201], v[84:85], v[108:109] op_sel_hi:[1,0,1]
    v_pk_fma_f32 v[202:203], v[202:203], v[84:85], v[110:111] op_sel_hi:[1,0,1]
    v_pk_mul_f32 v[104:105], v[184:185], v[184:185]
    v_pk_mul_f32 v[106:107], v[186:187], v[186:187]
    v_pk_mul_f32 v[108:109], v[200:201], v[200:201]
    v_pk_mul_f32 v[110:111], v[202:203], v[202:203]
    v_pk_fma_f32 v[104:105], v[104:105], s[88:89], s[88:89] op_sel:[0,0,1] op_sel_hi:[1,0,1]
    v_pk_fma_f32 v[106:107], v[106:107], s[88:89], s[88:89] op_sel:[0,0,1] op_sel_hi:[1,0,1]
    v_pk_fma_f32 v[108:109], v[108:109], s[88:89], s[88:89] op_sel:[0,0,1] op_sel_hi:[1,0,1]
    v_pk_fma_f32 v[110:111], v[110:111], s[88:89], s[88:89] op_sel:[0,0,1] op_sel_hi:[1,0,1]
    v_pk_mul_f32 v[104:105], v[104:105], v[184:185]
    v_pk_mul_f32 v[106:107], v[106:107], v[186:187]
    v_pk_mul_f32 v[108:109], v[108:109], v[200:201]
    v_pk_mul_f32 v[110:111], v[110:111], v[202:203]
    v_exp_f32 v104, v104
    v_exp_f32 v105, v105
    v_exp_f32 v106, v106
    v_exp_f32 v107, v107
    v_exp_f32 v108, v108
    v_exp_f32 v109, v109
    v_exp_f32 v110, v110
    v_exp_f32 v111, v111
    v_pk_add_f32 v[104:105], v[104:105], 1.0 op_sel_hi:[1,0]
    v_pk_add_f32 v[106:107], v[106:107], 1.0 op_sel_hi:[1,0]
    v_pk_add_f32 v[108:109], v[108:109], 1.0 op_sel_hi:[1,0]
    v_pk_add_f32 v[110:111], v[110:111], 1.0 op_sel_hi:[1,0]
    v_rcp_f32 v104, v104
    v_rcp_f32 v105, v105
    v_rcp_f32 v106, v106
    v_rcp_f32 v107, v107
    v_rcp_f32 v108, v108
    v_rcp_f32 v109, v109
    v_rcp_f32 v110, v110
    v_rcp_f32 v111, v111
    v_pk_mul_f32 v[184:185], v[184:185], v[104:105]
    v_pk_mul_f32 v[186:187], v[186:187], v[106:107]
    v_pk_mul_f32 v[200:201], v[200:201], v[108:109]
    v_pk_mul_f32 v[202:203], v[202:203], v[110:111]
    v_cvt_pk_bf16_f32 v224, v184, v185
    v_cvt_pk_bf16_f32 v225, v186, v187
    v_cvt_pk_bf16_f32 v226, v200, v201
    v_cvt_pk_bf16_f32 v227, v202, v203
    s_cbranch_vccnz sms_212
    s_nop 0
    buffer_store_dwordx4 v[224:227], v1, s[16:19], s51 offen offset:0
smd_213:
    v_pk_fma_f32 v[104:105], v[48:49], v[86:87], v[52:53] op_sel:[0,1,0] op_sel_hi:[1,1,1]
    v_pk_fma_f32 v[106:107], v[50:51], v[86:87], v[54:55] op_sel:[0,1,0] op_sel_hi:[1,1,1]
    v_pk_fma_f32 v[108:109], v[56:57], v[86:87], v[60:61] op_sel:[0,1,0] op_sel_hi:[1,1,1]
    v_pk_fma_f32 v[110:111], v[58:59], v[86:87], v[62:63] op_sel:[0,1,0] op_sel_hi:[1,1,1]
    v_pk_fma_f32 v[188:189], v[188:189], v[86:87], v[104:105] op_sel_hi:[1,0,1]
    v_pk_fma_f32 v[190:191], v[190:191], v[86:87], v[106:107] op_sel_hi:[1,0,1]
    v_pk_fma_f32 v[204:205], v[204:205], v[86:87], v[108:109] op_sel_hi:[1,0,1]
    v_pk_fma_f32 v[206:207], v[206:207], v[86:87], v[110:111] op_sel_hi:[1,0,1]
    v_pk_mul_f32 v[104:105], v[188:189], v[188:189]
    v_pk_mul_f32 v[106:107], v[190:191], v[190:191]
    v_pk_mul_f32 v[108:109], v[204:205], v[204:205]
    v_pk_mul_f32 v[110:111], v[206:207], v[206:207]
    v_pk_fma_f32 v[104:105], v[104:105], s[88:89], s[88:89] op_sel:[0,0,1] op_sel_hi:[1,0,1]
    v_pk_fma_f32 v[106:107], v[106:107], s[88:89], s[88:89] op_sel:[0,0,1] op_sel_hi:[1,0,1]
    v_pk_fma_f32 v[108:109], v[108:109], s[88:89], s[88:89] op_sel:[0,0,1] op_sel_hi:[1,0,1]
    v_pk_fma_f32 v[110:111], v[110:111], s[88:89], s[88:89] op_sel:[0,0,1] op_sel_hi:[1,0,1]
    v_pk_mul_f32 v[104:105], v[104:105], v[188:189]
    v_pk_mul_f32 v[106:107], v[106:107], v[190:191]
    v_pk_mul_f32 v[108:109], v[108:109], v[204:205]
    v_pk_mul_f32 v[110:111], v[110:111], v[206:207]
    v_exp_f32 v104, v104
    v_exp_f32 v105, v105
    v_exp_f32 v106, v106
    v_exp_f32 v107, v107
    v_exp_f32 v108, v108
    v_exp_f32 v109, v109
    v_exp_f32 v110, v110
    v_exp_f32 v111, v111
    v_pk_add_f32 v[104:105], v[104:105], 1.0 op_sel_hi:[1,0]
    v_pk_add_f32 v[106:107], v[106:107], 1.0 op_sel_hi:[1,0]
    v_pk_add_f32 v[108:109], v[108:109], 1.0 op_sel_hi:[1,0]
    v_pk_add_f32 v[110:111], v[110:111], 1.0 op_sel_hi:[1,0]
    v_rcp_f32 v104, v104
    v_rcp_f32 v105, v105
    v_rcp_f32 v106, v106
    v_rcp_f32 v107, v107
    v_rcp_f32 v108, v108
    v_rcp_f32 v109, v109
    v_rcp_f32 v110, v110
    v_rcp_f32 v111, v111
    v_pk_mul_f32 v[188:189], v[188:189], v[104:105]
    v_pk_mul_f32 v[190:191], v[190:191], v[106:107]
    v_pk_mul_f32 v[204:205], v[204:205], v[108:109]
    v_pk_mul_f32 v[206:207], v[206:207], v[110:111]
    v_cvt_pk_bf16_f32 v228, v188, v189
    v_cvt_pk_bf16_f32 v229, v190, v191
    v_cvt_pk_bf16_f32 v230, v204, v205
    v_cvt_pk_bf16_f32 v231, v206, v207
    s_cbranch_vccnz sms_214
    s_nop 0
    buffer_store_dwordx4 v[228:231], v1, s[16:19], s51 offen offset:2048
smd_215:
    s_add_u32 s48, s47, 6
    v_mov_b32 v254, s48
    s_cmp_eq_u32 s44, 0
    s_waitcnt vmcnt(8)
    s_cbranch_scc0 sigs_216
    s_nop 0
    buffer_store_dword v254, v14, s[16:19], 0 offen
sigd_217:
    s_mov_b32 s86, 1
    s_nop 0
    s_mov_b32 s66, 32768
    s_mov_b32 s67, 32768
    v_add_u32 v4, 16384, v9
    v_add_u32 v5, 17408, v9
    v_mov_b32 v6, v10
    v_mov_b32 v7, v11
    s_waitcnt lgkmcnt(0)
    v_lshlrev_b32 v112, 16, v144
    v_lshlrev_b32 v114, 16, v145
    v_lshlrev_b32 v128, 16, v146
    v_lshlrev_b32_e64 v130, 16, v147
    v_and_b32 v113, 0xffff0000, v144
    v_and_b32 v115, 0xffff0000, v145
    v_and_b32 v129, 0xffff0000, v146
    v_and_b32 v131, 0xffff0000, v147
    v_pk_add_f32 v[112:113], v[112:113], v[160:161]
    v_pk_add_f32 v[114:115], v[114:115], v[162:163]
    v_pk_add_f32 v[128:129], v[128:129], v[164:165]
    v_pk_add_f32 v[130:131], v[130:131], v[166:167]
    v_lshlrev_b32 v116, 16, v148
    v_lshlrev_b32 v118, 16, v149
    v_lshlrev_b32 v132, 16, v150
    v_lshlrev_b32 v134, 16, v151
    v_and_b32 v117, 0xffff0000, v148
    v_and_b32 v119, 0xffff0000, v149
    v_and_b32 v133, 0xffff0000, v150
    v_and_b32 v135, 0xffff0000, v151
    v_pk_add_f32 v[116:117], v[116:117], v[160:161]
    v_pk_add_f32 v[118:119], v[118:119], v[162:163]
    v_pk_add_f32 v[132:133], v[132:133], v[164:165]
    v_pk_add_f32 v[134:135], v[134:135], v[166:167]
    v_lshlrev_b32 v120, 16, v152
    v_lshlrev_b32 v122, 16, v153
    v_lshlrev_b32 v136, 16, v154
    v_lshlrev_b32 v138, 16, v155
    v_and_b32 v121, 0xffff0000, v152
    v_and_b32 v123, 0xffff0000, v153
    v_and_b32 v137, 0xffff0000, v154
    v_and_b32 v139, 0xffff0000, v155
    v_pk_add_f32 v[120:121], v[120:121], v[160:161]
    v_pk_add_f32 v[122:123], v[122:123], v[162:163]
    v_pk_add_f32 v[136:137], v[136:137], v[164:165]
    v_pk_add_f32 v[138:139], v[138:139], v[166:167]
    v_lshlrev_b32 v124, 16, v156
    v_lshlrev_b32 v126, 16, v157
    v_lshlrev_b32 v140, 16, v158
    v_lshlrev_b32 v142, 16, v159
    v_and_b32 v125, 0xffff0000, v156
    v_and_b32 v127, 0xffff0000, v157
    v_and_b32 v141, 0xffff0000, v158
    v_and_b32 v143, 0xffff0000, v159
    v_pk_add_f32 v[124:125], v[124:125], v[160:161]
    v_pk_add_f32 v[126:127], v[126:127], v[162:163]
    v_pk_add_f32 v[140:141], v[140:141], v[164:165]
    v_pk_add_f32 v[142:143], v[142:143], v[166:167]
    v_mov_b64 v[144:145], 0
    v_mov_b64 v[146:147], 0
    v_mov_b64 v[148:149], 0
    v_mov_b64 v[150:151], 0
    v_mov_b64 v[152:153], 0
    v_mov_b64 v[154:155], 0
    v_mov_b64 v[156:157], 0
    v_mov_b64 v[158:159], 0
    v_mov_b64 v[160:161], 0
    v_mov_b64 v[162:163], 0
    v_mov_b64 v[164:165], 0
    v_mov_b64 v[166:167], 0
    v_mov_b64 v[168:169], 0
    v_mov_b64 v[170:171], 0
    v_mov_b64 v[172:173], 0
    v_mov_b64 v[174:175], 0
    s_mov_b32 s99, 7
    s_mov_b32 s70, 1
    s_mov_b32 s71, 0
    s_nop 0
    s_mov_b32 s64, 0xfffe8000
    s_mov_b32 s65, 0xfffe8000
    s_waitcnt lgkmcnt(0)
    s_barrier
    ds_read_b64_tr_b16 v[80:81], v6 offset:0
    ds_read_b64_tr_b16 v[82:83], v6 offset:512
    ds_read_b64_tr_b16 v[84:85], v6 offset:4096
    ds_read_b64_tr_b16 v[86:87], v6 offset:4608
    ds_read_b128 v[16:19], v4 offset:0
    ds_read_b128 v[20:23], v5 offset:0
    ds_read_b128 v[24:27], v4 offset:2048
    ds_read_b128 v[28:31], v5 offset:2048
    ds_read_b128 v[32:35], v4 offset:4096
    ds_read_b128 v[36:39], v5 offset:4096
    ds_read_b128 v[40:43], v4 offset:6144
    ds_read_b128 v[44:47], v5 offset:6144
    ds_read_b64_tr_b16 v[88:89], v7 offset:0
    ds_read_b64_tr_b16 v[90:91], v7 offset:512
    ds_read_b64_tr_b16 v[92:93], v7 offset:4096
    ds_read_b64_tr_b16 v[94:95], v7 offset:4608
    s_mov_b32 s75, 1
    .p2align 5
cl_219:
    s_waitcnt lgkmcnt(4)
    s_nop 0
    v_mfma_f32_16x16x32_bf16 v[112:115], v[80:83], v[16:19], v[112:115]
    ds_read_b64_tr_b16 v[96:97], v6 offset:8192
    v_mfma_f32_16x16x32_bf16 v[112:115], v[84:87], v[20:23], v[112:115]
    ds_read_b64_tr_b16 v[98:99], v6 offset:8704
    v_mfma_f32_16x16x32_bf16 v[116:119], v[84:87], v[28:31], v[116:119]
    ds_read_b64_tr_b16 v[100:101], v6 offset:12288
    v_mfma_f32_16x16x32_bf16 v[116:119], v[80:83], v[24:27], v[116:119]
    ds_read_b64_tr_b16 v[102:103], v6 offset:12800
    v_mfma_f32_16x16x32_bf16 v[120:123], v[80:83], v[32:35], v[120:123]
    s_add_u32 s71, s71, 1
    s_cmp_eq_u32 s71, 4
    v_mfma_f32_16x16x32_bf16 v[120:123], v[84:87], v[36:39], v[120:123]
    s_cselect_b32 s73, s64, 32768
    v_mfma_f32_16x16x32_bf16 v[124:127], v[84:87], v[44:47], v[124:127]
    s_cselect_b32 s74, s65, 32768
    v_mfma_f32_16x16x32_bf16 v[124:127], v[80:83], v[40:43], v[124:127]
    s_cselect_b32 s71, 0, s71
    s_waitcnt lgkmcnt(4)
    v_mfma_f32_16x16x32_bf16 v[140:143], v[88:91], v[40:43], v[140:143]
    ds_read_b64_tr_b16 v[104:105], v7 offset:8192
    v_mfma_f32_16x16x32_bf16 v[140:143], v[92:95], v[44:47], v[140:143]
    ds_read_b64_tr_b16 v[106:107], v7 offset:8704
    v_mfma_f32_16x16x32_bf16 v[136:139], v[92:95], v[36:39], v[136:139]
    ds_read_b64_tr_b16 v[108:109], v7 offset:12288
    v_mfma_f32_16x16x32_bf16 v[136:139], v[88:91], v[32:35], v[136:139]
    ds_read_b64_tr_b16 v[110:111], v7 offset:12800
    v_mfma_f32_16x16x32_bf16 v[132:135], v[88:91], v[24:27], v[132:135]
    v_add_u32 v4, s73, v4
    v_add_u32 v5, s73, v5
    v_mfma_f32_16x16x32_bf16 v[132:135], v[92:95], v[28:31], v[132:135]
    v_add_u32 v6, s74, v6
    v_add_u32 v7, s74, v7
    v_mfma_f32_16x16x32_bf16 v[128:131], v[92:95], v[20:23], v[128:131]
    v_mfma_f32_16x16x32_bf16 v[128:131], v[88:91], v[16:19], v[128:131]
    s_waitcnt lgkmcnt(0)
    s_barrier
    v_mfma_f32_16x16x32_bf16 v[144:147], v[96:99], v[16:19], v[144:147]
    ds_read_b64_tr_b16 v[80:81], v6 offset:0
    v_mfma_f32_16x16x32_bf16 v[144:147], v[100:103], v[20:23], v[144:147]
    ds_read_b64_tr_b16 v[82:83], v6 offset:512
    v_mfma_f32_16x16x32_bf16 v[148:151], v[100:103], v[28:31], v[148:151]
    ds_read_b64_tr_b16 v[84:85], v6 offset:4096
    v_mfma_f32_16x16x32_bf16 v[148:151], v[96:99], v[24:27], v[148:151]
    ds_read_b64_tr_b16 v[86:87], v6 offset:4608
    v_mfma_f32_16x16x32_bf16 v[152:155], v[96:99], v[32:35], v[152:155]
    ds_read_b128 v[48:51], v4 offset:0
    v_mfma_f32_16x16x32_bf16 v[152:155], v[100:103], v[36:39], v[152:155]
    ds_read_b128 v[52:55], v5 offset:0
    v_mfma_f32_16x16x32_bf16 v[156:159], v[100:103], v[44:47], v[156:159]
    ds_read_b128 v[56:59], v4 offset:2048
    v_mfma_f32_16x16x32_bf16 v[156:159], v[96:99], v[40:43], v[156:159]
    ds_read_b128 v[60:63], v5 offset:2048
    v_mfma_f32_16x16x32_bf16 v[172:175], v[104:107], v[40:43], v[172:175]
    ds_read_b128 v[64:67], v4 offset:4096
    v_mfma_f32_16x16x32_bf16 v[172:175], v[108:111], v[44:47], v[172:175]
    ds_read_b128 v[68:71], v5 offset:4096
    v_mfma_f32_16x16x32_bf16 v[168:171], v[108:111], v[36:39], v[168:171]
    ds_read_b128 v[72:75], v4 offset:6144
    v_mfma_f32_16x16x32_bf16 v[168:171], v[104:107], v[32:35], v[168:171]
    ds_read_b128 v[76:79], v5 offset:6144
    v_mfma_f32_16x16x32_bf16 v[164:167], v[104:107], v[24:27], v[164:167]
    ds_read_b64_tr_b16 v[88:89], v7 offset:0
    v_mfma_f32_16x16x32_bf16 v[164:167], v[108:111], v[28:31], v[164:167]
    ds_read_b64_tr_b16 v[90:91], v7 offset:512
    v_mfma_f32_16x16x32_bf16 v[160:163], v[108:111], v[20:23], v[160:163]
    ds_read_b64_tr_b16 v[92:93], v7 offset:4096
    v_mfma_f32_16x16x32_bf16 v[160:163], v[104:107], v[16:19], v[160:163]
    ds_read_b64_tr_b16 v[94:95], v7 offset:4608
    s_waitcnt lgkmcnt(4)
    s_nop 0
    v_mfma_f32_16x16x32_bf16 v[112:115], v[80:83], v[48:51], v[112:115]
    ds_read_b64_tr_b16 v[96:97], v6 offset:8192
    v_mfma_f32_16x16x32_bf16 v[112:115], v[84:87], v[52:55], v[112:115]
    ds_read_b64_tr_b16 v[98:99], v6 offset:8704
    v_mfma_f32_16x16x32_bf16 v[116:119], v[84:87], v[60:63], v[116:119]
    ds_read_b64_tr_b16 v[100:101], v6 offset:12288
    v_mfma_f32_16x16x32_bf16 v[116:119], v[80:83], v[56:59], v[116:119]
    ds_read_b64_tr_b16 v[102:103], v6 offset:12800
    v_mfma_f32_16x16x32_bf16 v[120:123], v[80:83], v[64:67], v[120:123]
    s_add_u32 s71, s71, 1
    s_cmp_eq_u32 s71, 4
    v_mfma_f32_16x16x32_bf16 v[120:123], v[84:87], v[68:71], v[120:123]
    s_cselect_b32 s73, s64, 32768
    v_mfma_f32_16x16x32_bf16 v[124:127], v[84:87], v[76:79], v[124:127]
    s_cselect_b32 s74, s65, 32768
    v_mfma_f32_16x16x32_bf16 v[124:127], v[80:83], v[72:75], v[124:127]
    s_cselect_b32 s71, 0, s71
    s_waitcnt lgkmcnt(4)
    v_mfma_f32_16x16x32_bf16 v[140:143], v[88:91], v[72:75], v[140:143]
    ds_read_b64_tr_b16 v[104:105], v7 offset:8192
    v_mfma_f32_16x16x32_bf16 v[140:143], v[92:95], v[76:79], v[140:143]
    ds_read_b64_tr_b16 v[106:107], v7 offset:8704
    v_mfma_f32_16x16x32_bf16 v[136:139], v[92:95], v[68:71], v[136:139]
    ds_read_b64_tr_b16 v[108:109], v7 offset:12288
    v_mfma_f32_16x16x32_bf16 v[136:139], v[88:91], v[64:67], v[136:139]
    ds_read_b64_tr_b16 v[110:111], v7 offset:12800
    v_mfma_f32_16x16x32_bf16 v[132:135], v[88:91], v[56:59], v[132:135]
    v_add_u32 v4, s73, v4
    v_add_u32 v5, s73, v5
    v_mfma_f32_16x16x32_bf16 v[132:135], v[92:95], v[60:63], v[132:135]
    v_add_u32 v6, s74, v6
    v_add_u32 v7, s74, v7
    v_mfma_f32_16x16x32_bf16 v[128:131], v[92:95], v[52:55], v[128:131]
    v_mfma_f32_16x16x32_bf16 v[128:131], v[88:91], v[48:51], v[128:131]
    s_waitcnt lgkmcnt(0)
    s_barrier
    v_mfma_f32_16x16x32_bf16 v[144:147], v[96:99], v[48:51], v[144:147]
    ds_read_b64_tr_b16 v[80:81], v6 offset:0
    v_mfma_f32_16x16x32_bf16 v[144:147], v[100:103], v[52:55], v[144:147]
    ds_read_b64_tr_b16 v[82:83], v6 offset:512
    v_mfma_f32_16x16x32_bf16 v[148:151], v[100:103], v[60:63], v[148:151]
    ds_read_b64_tr_b16 v[84:85], v6 offset:4096
    v_mfma_f32_16x16x32_bf16 v[148:151], v[96:99], v[56:59], v[148:151]
    ds_read_b64_tr_b16 v[86:87], v6 offset:4608
    v_mfma_f32_16x16x32_bf16 v[152:155], v[96:99], v[64:67], v[152:155]
    ds_read_b128 v[16:19], v4 offset:0
    v_mfma_f32_16x16x32_bf16 v[152:155], v[100:103], v[68:71], v[152:155]
    ds_read_b128 v[20:23], v5 offset:0
    v_mfma_f32_16x16x32_bf16 v[156:159], v[100:103], v[76:79], v[156:159]
    ds_read_b128 v[24:27], v4 offset:2048
    v_mfma_f32_16x16x32_bf16 v[156:159], v[96:99], v[72:75], v[156:159]
    ds_read_b128 v[28:31], v5 offset:2048
    v_mfma_f32_16x16x32_bf16 v[172:175], v[104:107], v[72:75], v[172:175]
    ds_read_b128 v[32:35], v4 offset:4096
    v_mfma_f32_16x16x32_bf16 v[172:175], v[108:111], v[76:79], v[172:175]
    ds_read_b128 v[36:39], v5 offset:4096
    v_mfma_f32_16x16x32_bf16 v[168:171], v[108:111], v[68:71], v[168:171]
    ds_read_b128 v[40:43], v4 offset:6144
    v_mfma_f32_16x16x32_bf16 v[168:171], v[104:107], v[64:67], v[168:171]
    ds_read_b128 v[44:47], v5 offset:6144
    v_mfma_f32_16x16x32_bf16 v[164:167], v[104:107], v[56:59], v[164:167]
    ds_read_b64_tr_b16 v[88:89], v7 offset:0
    v_mfma_f32_16x16x32_bf16 v[164:167], v[108:111], v[60:63], v[164:167]
    ds_read_b64_tr_b16 v[90:91], v7 offset:512
    v_mfma_f32_16x16x32_bf16 v[160:163], v[108:111], v[52:55], v[160:163]
    ds_read_b64_tr_b16 v[92:93], v7 offset:4096
    s_sub_u32 s70, s70, 1
    s_cmp_lg_u32 s70, 0
    v_mfma_f32_16x16x32_bf16 v[160:163], v[104:107], v[48:51], v[160:163]
    ds_read_b64_tr_b16 v[94:95], v7 offset:4608
    s_cbranch_scc1 cl_219
    s_cmp_eq_u32 s75, 0
    s_cbranch_scc1 hkd_218
    s_cmp_eq_u32 s7, 0
    s_cselect_b32 s70, 1, s30
    s_add_u32 s70, s70, 10
    s_mov_b32 s75, 0
    s_add_u32 s48, s47, 7
    v_mov_b32 v254, s48
    s_cmp_eq_u32 s44, 0
    s_waitcnt vmcnt(0)
    s_cbranch_scc0 sigs_221
    buffer_store_dword v254, v14, s[16:19], 0 offen
sigd_222:
    buffer_store_dword v254, v13, s[16:19], s83 offen sc1
    s_branch cl_219
hkd_218:
    s_lshl_b32 s49, s2, 14
    s_lshl_b32 s50, s6, 12
    s_add_u32 s49, s49, s50
    s_xor_b32 s50, s49, 16384
    s_add_u32 s55, s49, 16777216
    s_add_u32 s53, s50, 16777216
    s_mov_b32 s70, 3
    s_mov_b32 s99, 3
    v_cvt_pk_bf16_f32 v176, v144, v145
    v_cvt_pk_bf16_f32 v177, v146, v147
    v_cvt_pk_bf16_f32 v178, v160, v161
    v_cvt_pk_bf16_f32 v179, v162, v163
    buffer_store_dwordx4 v[176:179], v15, s[16:19], s53 offen offset:0 sc1
    v_cvt_pk_bf16_f32 v180, v148, v149
    v_cvt_pk_bf16_f32 v181, v150, v151
    v_cvt_pk_bf16_f32 v182, v164, v165
    v_cvt_pk_bf16_f32 v183, v166, v167
    buffer_store_dwordx4 v[180:183], v15, s[16:19], s53 offen offset:1024 sc1
    v_cvt_pk_bf16_f32 v184, v152, v153
    v_cvt_pk_bf16_f32 v185, v154, v155
    v_cvt_pk_bf16_f32 v186, v168, v169
    v_cvt_pk_bf16_f32 v187, v170, v171
    buffer_store_dwordx4 v[184:187], v15, s[16:19], s53 offen offset:2048 sc1
    v_cvt_pk_bf16_f32 v188, v156, v157
    v_cvt_pk_bf16_f32 v189, v158, v159
    v_cvt_pk_bf16_f32 v190, v172, v173
    v_cvt_pk_bf16_f32 v191, v174, v175
    buffer_store_dwordx4 v[188:191], v15, s[16:19], s53 offen offset:3072 sc1
    s_branch L_c_nb2
L_c_fin:
    s_nop 0
    v_cvt_pk_bf16_f32 v92, v124, v125
    v_cvt_pk_bf16_f32 v93, v126, v127
    v_cvt_pk_bf16_f32 v94, v140, v141
    v_cvt_pk_bf16_f32 v95, v142, v143
    ds_write_b64 v2, v[92:93] offset:6144
    ds_write_b64 v3, v[94:95] offset:6144
    v_cvt_pk_bf16_f32 v88, v120, v121
    v_cvt_pk_bf16_f32 v89, v122, v123
    v_cvt_pk_bf16_f32 v90, v136, v137
    v_cvt_pk_bf16_f32 v91, v138, v139
    ds_write_b64 v2, v[88:89] offset:4096
    ds_write_b64 v3, v[90:91] offset:4096
    v_cvt_pk_bf16_f32 v84, v116, v117
    v_cvt_pk_bf16_f32 v85, v118, v119
    v_cvt_pk_bf16_f32 v86, v132, v133
    v_cvt_pk_bf16_f32 v87, v134, v135
    ds_write_b64 v2, v[84:85] offset:2048
    ds_write_b64 v3, v[86:87] offset:2048
    v_cvt_pk_bf16_f32 v80, v112, v113
    v_cvt_pk_bf16_f32 v81, v114, v115
    v_cvt_pk_bf16_f32 v82, v128, v129
    v_cvt_pk_bf16_f32 v83, v130, v131
    ds_write_b64 v2, v[80:81] offset:0
    ds_write_b64 v3, v[82:83] offset:0
    s_lshl_b32 s48, s3, 18
    s_lshl_b32 s49, s4, 7
    s_add_u32 s49, s49, s48
    s_add_u32 s50, s6, 0
    s_lshl_b32 s51, s50, 15
    s_add_u32 s49, s49, s51
    s_lshl_b32 s50, s50, 11
    s_nop 0
    s_add_u32 s50, s50, 135168
    s_mov_b32 s20, s40
    s_mov_b32 s21, s41
    s_mov_b32 s22, 4194304
    s_mov_b32 s23, 0x20000
    v_lshrrev_b32 v20, 3, v0
    v_and_b32 v21, 7, v0
    v_lshlrev_b32_e64 v22, 11, v20
    v_lshl_add_u32 v22, v21, 4, v22
    v_lshrrev_b32 v23, 4, v0
    v_xor_b32 v21, v21, v23
    v_lshlrev_b32_e64 v21, 4, v21
    v_lshl_add_u32 v21, v20, 7, v21
    v_add_u32 v21, s50, v21
    v_xor_b32 v20, 64, v21
    v_add_u32 v23, 16384, v22
    s_waitcnt lgkmcnt(0)
    s_barrier
    ds_read_b128 v[24:27], v21
    ds_read_b128 v[28:31], v20 offset:1024
    s_waitcnt lgkmcnt(1)
    s_nop 0
    buffer_store_dwordx4 v[24:27], v22, s[20:23], s49 offen
    s_waitcnt lgkmcnt(0)
    s_nop 0
    buffer_store_dwordx4 v[28:31], v23, s[20:23], s49 offen
    s_endpgm
fcc_22:
poll_23:
    s_nop 0
    buffer_load_dword v38, v37, s[16:19], 0 offen sc1
    s_waitcnt vmcnt(0)
pollc_24:
    v_cmp_le_u32 vcc, s84, v38
    s_nop 0
    s_andn2_b64 s[78:79], s[76:77], vcc
    s_cbranch_scc0 polld_25
    s_sub_u32 s85, s85, 1
    s_cbranch_scc0 poll_23
    s_mov_b32 s85, 0
polld_25:
    s_branch fc_21
jrr_40:
    s_lshl_b32 s48, s7, 19
    s_lshl_b32 s49, s3, 14
    s_add_u32 s48, s48, s49
    s_add_u32 s48, s48, 1048576
    buffer_load_dwordx4 v[64:67], v35, s[16:19], s48 offen offset:0 sc1
    buffer_load_dwordx4 v[68:71], v35, s[16:19], s48 offen offset:1024 sc1
    buffer_load_dwordx4 v[72:75], v35, s[16:19], s48 offen offset:2048 sc1
    buffer_load_dwordx4 v[76:79], v35, s[16:19], s48 offen offset:3072 sc1
    s_waitcnt vmcnt(0)
    s_branch jrc_41
kvp_52:
    buffer_load_dwordx4 v[128:131], v132, s[16:19], s52 offen sc1
    s_bitcmp1_b32 s98, 0
    s_cbranch_scc0 kvl_2056
    buffer_load_dwordx4 v[64:67], v33, s[16:19], s48 offen offset:0 sc1
    buffer_load_dwordx4 v[68:71], v33, s[16:19], s48 offen offset:1024 sc1
    buffer_load_dwordx4 v[72:75], v33, s[16:19], s48 offen offset:2048 sc1
    buffer_load_dwordx4 v[76:79], v33, s[16:19], s48 offen offset:3072 sc1
kvl_2056:
    s_bitcmp1_b32 s98, 1
    s_cbranch_scc0 kvl_2057
    buffer_load_dwordx4 v[80:83], v33, s[16:19], s49 offen offset:0 sc1
    buffer_load_dwordx4 v[84:87], v33, s[16:19], s49 offen offset:1024 sc1
    buffer_load_dwordx4 v[88:91], v33, s[16:19], s49 offen offset:2048 sc1
    buffer_load_dwordx4 v[92:95], v33, s[16:19], s49 offen offset:3072 sc1
kvl_2057:
    s_bitcmp1_b32 s98, 2
    s_cbranch_scc0 kvl_2058
    buffer_load_dwordx4 v[96:99], v33, s[16:19], s50 offen offset:0 sc1
    buffer_load_dwordx4 v[100:103], v33, s[16:19], s50 offen offset:1024 sc1
    buffer_load_dwordx4 v[104:107], v33, s[16:19], s50 offen offset:2048 sc1
    buffer_load_dwordx4 v[108:111], v33, s[16:19], s50 offen offset:3072 sc1
kvl_2058:
    s_bitcmp1_b32 s98, 3
    s_cbranch_scc0 kvl_2059
    buffer_load_dwordx4 v[112:115], v33, s[16:19], s51 offen offset:0 sc1
    buffer_load_dwordx4 v[116:119], v33, s[16:19], s51 offen offset:1024 sc1
    buffer_load_dwordx4 v[120:123], v33, s[16:19], s51 offen offset:2048 sc1
    buffer_load_dwordx4 v[124:127], v33, s[16:19], s51 offen offset:3072 sc1
kvl_2059:
    s_waitcnt vmcnt(0)
    s_bitcmp1_b32 s98, 0
    s_cbranch_scc0 kva_2060
    v_lshlrev_b32 v144, 16, v64
    v_and_b32 v145, 0xffff0000, v64
    v_lshlrev_b32_e64 v146, 16, v65
    v_and_b32 v147, 0xffff0000, v65
    v_lshlrev_b32_e64 v148, 16, v66
    v_and_b32 v149, 0xffff0000, v66
    v_lshlrev_b32_e64 v150, 16, v67
    v_and_b32 v151, 0xffff0000, v67
    v_dot2c_f32_bf16 v144, s56, v68
    v_dot2c_f32_bf16 v145, s57, v68
    v_dot2c_f32_bf16 v146, s56, v69
    v_dot2c_f32_bf16 v147, s57, v69
    v_dot2c_f32_bf16 v148, s56, v70
    v_dot2c_f32_bf16 v149, s57, v70
    v_dot2c_f32_bf16 v150, s56, v71
    v_dot2c_f32_bf16 v151, s57, v71
    v_dot2c_f32_bf16 v144, s56, v72
    v_dot2c_f32_bf16 v145, s57, v72
    v_dot2c_f32_bf16 v146, s56, v73
    v_dot2c_f32_bf16 v147, s57, v73
    v_dot2c_f32_bf16 v148, s56, v74
    v_dot2c_f32_bf16 v149, s57, v74
    v_dot2c_f32_bf16 v150, s56, v75
    v_dot2c_f32_bf16 v151, s57, v75
    v_dot2c_f32_bf16 v144, s56, v76
    v_dot2c_f32_bf16 v145, s57, v76
    v_dot2c_f32_bf16 v146, s56, v77
    v_dot2c_f32_bf16 v147, s57, v77
    v_dot2c_f32_bf16 v148, s56, v78
    v_dot2c_f32_bf16 v149, s57, v78
    v_dot2c_f32_bf16 v150, s56, v79
    v_dot2c_f32_bf16 v151, s57, v79
    v_add_f32 v136, v144, v146
    s_nop 0
    v_add_f32 v137, v148, v150
    v_cmp_u_f32 vcc, v136, v137
    s_cbranch_vccnz kva_2060
    s_bitset0_b32 s98, 0
kva_2060:
    s_bitcmp1_b32 s98, 1
    s_cbranch_scc0 kva_2061
    v_lshlrev_b32_e64 v152, 16, v80
    v_and_b32 v153, 0xffff0000, v80
    v_lshlrev_b32_e64 v154, 16, v81
    v_and_b32 v155, 0xffff0000, v81
    v_lshlrev_b32_e64 v156, 16, v82
    v_and_b32 v157, 0xffff0000, v82
    v_lshlrev_b32_e64 v158, 16, v83
    v_and_b32 v159, 0xffff0000, v83
    v_dot2c_f32_bf16 v152, s56, v84
    v_dot2c_f32_bf16 v153, s57, v84
    v_dot2c_f32_bf16 v154, s56, v85
    v_dot2c_f32_bf16 v155, s57, v85
    v_dot2c_f32_bf16 v156, s56, v86
    v_dot2c_f32_bf16 v157, s57, v86
    v_dot2c_f32_bf16 v158, s56, v87
    v_dot2c_f32_bf16 v159, s57, v87
    v_dot2c_f32_bf16 v152, s56, v88
    v_dot2c_f32_bf16 v153, s57, v88
    v_dot2c_f32_bf16 v154, s56, v89
    v_dot2c_f32_bf16 v155, s57, v89
    v_dot2c_f32_bf16 v156, s56, v90
    v_dot2c_f32_bf16 v157, s57, v90
    v_dot2c_f32_bf16 v158, s56, v91
    v_dot2c_f32_bf16 v159, s57, v91
    v_dot2c_f32_bf16 v152, s56, v92
    v_dot2c_f32_bf16 v153, s57, v92
    v_dot2c_f32_bf16 v154, s56, v93
    v_dot2c_f32_bf16 v155, s57, v93
    v_dot2c_f32_bf16 v156, s56, v94
    v_dot2c_f32_bf16 v157, s57, v94
    v_dot2c_f32_bf16 v158, s56, v95
    v_dot2c_f32_bf16 v159, s57, v95
    v_add_f32 v136, v152, v154
    s_nop 0
    v_add_f32 v137, v156, v158
    v_cmp_u_f32 vcc, v136, v137
    s_cbranch_vccnz kva_2061
    s_bitset0_b32 s98, 1
kva_2061:
    s_bitcmp1_b32 s98, 2
    s_cbranch_scc0 kva_2062
    v_lshlrev_b32_e64 v160, 16, v96
    v_and_b32 v161, 0xffff0000, v96
    v_lshlrev_b32_e64 v162, 16, v97
    v_and_b32 v163, 0xffff0000, v97
    v_lshlrev_b32_e64 v164, 16, v98
    v_and_b32 v165, 0xffff0000, v98
    v_lshlrev_b32_e64 v166, 16, v99
    v_and_b32 v167, 0xffff0000, v99
    v_dot2c_f32_bf16 v160, s56, v100
    v_dot2c_f32_bf16 v161, s57, v100
    v_dot2c_f32_bf16 v162, s56, v101
    v_dot2c_f32_bf16 v163, s57, v101
    v_dot2c_f32_bf16 v164, s56, v102
    v_dot2c_f32_bf16 v165, s57, v102
    v_dot2c_f32_bf16 v166, s56, v103
    v_dot2c_f32_bf16 v167, s57, v103
    v_dot2c_f32_bf16 v160, s56, v104
    v_dot2c_f32_bf16 v161, s57, v104
    v_dot2c_f32_bf16 v162, s56, v105
    v_dot2c_f32_bf16 v163, s57, v105
    v_dot2c_f32_bf16 v164, s56, v106
    v_dot2c_f32_bf16 v165, s57, v106
    v_dot2c_f32_bf16 v166, s56, v107
    v_dot2c_f32_bf16 v167, s57, v107
    v_dot2c_f32_bf16 v160, s56, v108
    v_dot2c_f32_bf16 v161, s57, v108
    v_dot2c_f32_bf16 v162, s56, v109
    v_dot2c_f32_bf16 v163, s57, v109
    v_dot2c_f32_bf16 v164, s56, v110
    v_dot2c_f32_bf16 v165, s57, v110
    v_dot2c_f32_bf16 v166, s56, v111
    v_dot2c_f32_bf16 v167, s57, v111
    v_add_f32 v136, v160, v162
    s_nop 0
    v_add_f32 v137, v164, v166
    v_cmp_u_f32 vcc, v136, v137
    s_cbranch_vccnz kva_2062
    s_bitset0_b32 s98, 2
kva_2062:
    s_bitcmp1_b32 s98, 3
    s_cbranch_scc0 kva_2063
    v_lshlrev_b32_e64 v168, 16, v112
    v_and_b32 v169, 0xffff0000, v112
    v_lshlrev_b32_e64 v170, 16, v113
    v_and_b32 v171, 0xffff0000, v113
    v_lshlrev_b32_e64 v172, 16, v114
    v_and_b32 v173, 0xffff0000, v114
    v_lshlrev_b32_e64 v174, 16, v115
    v_and_b32 v175, 0xffff0000, v115
    v_dot2c_f32_bf16 v168, s56, v116
    v_dot2c_f32_bf16 v169, s57, v116
    v_dot2c_f32_bf16 v170, s56, v117
    v_dot2c_f32_bf16 v171, s57, v117
    v_dot2c_f32_bf16 v172, s56, v118
    v_dot2c_f32_bf16 v173, s57, v118
    v_dot2c_f32_bf16 v174, s56, v119
    v_dot2c_f32_bf16 v175, s57, v119
    v_dot2c_f32_bf16 v168, s56, v120
    v_dot2c_f32_bf16 v169, s57, v120
    v_dot2c_f32_bf16 v170, s56, v121
    v_dot2c_f32_bf16 v171, s57, v121
    v_dot2c_f32_bf16 v172, s56, v122
    v_dot2c_f32_bf16 v173, s57, v122
    v_dot2c_f32_bf16 v174, s56, v123
    v_dot2c_f32_bf16 v175, s57, v123
    v_dot2c_f32_bf16 v168, s56, v124
    v_dot2c_f32_bf16 v169, s57, v124
    v_dot2c_f32_bf16 v170, s56, v125
    v_dot2c_f32_bf16 v171, s57, v125
    v_dot2c_f32_bf16 v172, s56, v126
    v_dot2c_f32_bf16 v173, s57, v126
    v_dot2c_f32_bf16 v174, s56, v127
    v_dot2c_f32_bf16 v175, s57, v127
    v_add_f32 v136, v168, v170
    s_nop 0
    v_add_f32 v137, v172, v174
    v_cmp_u_f32 vcc, v136, v137
    s_cbranch_vccnz kva_2063
    s_bitset0_b32 s98, 3
kva_2063:
    s_branch kvz_55
fcc_64:
poll_65:
    s_nop 0
    buffer_load_dword v38, v37, s[16:19], 0 offen sc1
    s_waitcnt vmcnt(0)
pollc_66:
    v_cmp_le_u32 vcc, s84, v38
    s_nop 0
    s_andn2_b64 s[78:79], s[76:77], vcc
    s_cbranch_scc0 polld_67
    s_sub_u32 s85, s85, 1
    s_cbranch_scc0 poll_65
    s_mov_b32 s85, 0
polld_67:
    s_branch fc_63
fcc_105:
poll_106:
    s_nop 0
    buffer_load_dword v38, v37, s[16:19], 0 offen sc1
    s_waitcnt vmcnt(0)
pollc_107:
    v_cmp_le_u32 vcc, s84, v38
    s_nop 0
    s_andn2_b64 s[78:79], s[76:77], vcc
    s_cbranch_scc0 polld_108
    s_sub_u32 s85, s85, 1
    s_cbranch_scc0 poll_106
    s_mov_b32 s85, 0
polld_108:
    s_branch fc_104
jrr_137:
    s_lshl_b32 s48, s7, 19
    s_lshl_b32 s49, s3, 14
    s_add_u32 s48, s48, s49
    s_add_u32 s48, s48, 1310720
    buffer_load_dwordx4 v[64:67], v35, s[16:19], s48 offen offset:0 sc1
    buffer_load_dwordx4 v[68:71], v35, s[16:19], s48 offen offset:1024 sc1
    buffer_load_dwordx4 v[72:75], v35, s[16:19], s48 offen offset:2048 sc1
    buffer_load_dwordx4 v[76:79], v35, s[16:19], s48 offen offset:3072 sc1
    s_waitcnt vmcnt(0)
    s_branch jrc_138
jrr_142:
    s_lshl_b32 s48, s4, 14
    s_nop 0
    s_add_u32 s48, s48, 2359296
    buffer_load_dwordx4 v[80:83], v35, s[16:19], s48 offen offset:0 sc1
    buffer_load_dwordx4 v[84:87], v35, s[16:19], s48 offen offset:1024 sc1
    buffer_load_dwordx4 v[88:91], v35, s[16:19], s48 offen offset:2048 sc1
    buffer_load_dwordx4 v[92:95], v35, s[16:19], s48 offen offset:3072 sc1
    s_waitcnt vmcnt(0)
    s_branch jrc_143
fcc_149:
poll_150:
    buffer_load_dword v38, v36, s[16:19], 0 offen sc1
    s_waitcnt vmcnt(0)
pollc_151:
    v_cmp_le_u32 vcc, s84, v38
    s_nop 0
    s_andn2_b64 s[78:79], s[76:77], vcc
    s_cbranch_scc0 polld_152
    s_sub_u32 s85, s85, 1
    s_cbranch_scc0 poll_150
    s_mov_b32 s85, 0
polld_152:
    s_branch fc_148
fcc_154:
poll_155:
    s_nop 0
    buffer_load_dword v38, v36, s[16:19], 0 offen sc1
    s_waitcnt vmcnt(0)
pollc_156:
    v_cmp_le_u32 vcc, s84, v38
    s_nop 0
    s_andn2_b64 s[78:79], s[76:77], vcc
    s_cbranch_scc0 polld_157
    s_sub_u32 s85, s85, 1
    s_cbranch_scc0 poll_155
    s_mov_b32 s85, 0
polld_157:
    s_branch fc_153
fcc_159:
poll_160:
    s_nop 0
    buffer_load_dword v38, v37, s[16:19], 0 offen sc1
    s_waitcnt vmcnt(0)
pollc_161:
    v_cmp_le_u32 vcc, s84, v38
    s_nop 0
    s_andn2_b64 s[78:79], s[76:77], vcc
    s_cbranch_scc0 polld_162
    s_sub_u32 s85, s85, 1
    s_cbranch_scc0 poll_160
    s_mov_b32 s85, 0
polld_162:
    s_branch fc_158
sigs_3175:
    s_nop 0
    buffer_store_dword v254, v14, s[16:19], 0 offen sc1
    s_branch sigd_3176
mid_175:
    s_lshl_b32 s58, s7, 1
    s_add_u32 s58, s58, 0
    s_nop 0
    v_bfe_u32 v240, v0, 2, 2
    v_lshlrev_b32_e64 v240, 4, v240
    v_lshl_add_u32 v240, v0, 6, v240
    s_lshl_b32 s48, s6, 12
    s_nop 0
    s_add_u32 s48, s48, 135168
    v_add_u32 v240, s48, v240
    v_xor_b32 v241, 0, v240
    ds_read_b128 v[224:227], v241
    v_xor_b32_e64 v241, 16, v240
    ds_read_b128 v[228:231], v241
    v_xor_b32_e64 v241, 32, v240
    ds_read_b128 v[232:235], v241
    v_xor_b32_e64 v241, 48, v240
    ds_read_b128 v[236:239], v241
    v_mov_b32 v244, 0
    v_mov_b32 v245, 0
    v_mov_b32 v246, 0
    v_mov_b32 v247, 0
    s_mov_b32 s50, 0x3f803f80
    s_lshl_b32 s48, s58, 18
    s_lshl_b32 s49, s3, 14
    s_add_u32 s48, s48, s49
    s_lshl_b32 s49, s4, 10
    s_add_u32 s48, s48, s49
    s_lshl_b32 s49, s6, 8
    s_add_u32 s48, s48, s49
    s_nop 0
    s_add_u32 s48, s48, 1048576
    s_waitcnt lgkmcnt(3)
    v_dot2c_f32_bf16 v244, s50, v224
    v_dot2c_f32_bf16 v246, v224, v224
    v_dot2c_f32_bf16 v245, s50, v225
    v_dot2c_f32_bf16 v247, v225, v225
    v_dot2c_f32_bf16 v244, s50, v226
    v_dot2c_f32_bf16 v246, v226, v226
    v_dot2c_f32_bf16 v245, s50, v227
    v_dot2c_f32_bf16 v247, v227, v227
    s_waitcnt lgkmcnt(2)
    v_dot2c_f32_bf16 v244, s50, v228
    v_dot2c_f32_bf16 v246, v228, v228
    v_dot2c_f32_bf16 v245, s50, v229
    v_dot2c_f32_bf16 v247, v229, v229
    v_dot2c_f32_bf16 v244, s50, v230
    v_dot2c_f32_bf16 v246, v230, v230
    v_dot2c_f32_bf16 v245, s50, v231
    v_dot2c_f32_bf16 v247, v231, v231
    s_waitcnt lgkmcnt(1)
    v_dot2c_f32_bf16 v244, s50, v232
    v_dot2c_f32_bf16 v246, v232, v232
    v_dot2c_f32_bf16 v245, s50, v233
    v_dot2c_f32_bf16 v247, v233, v233
    v_dot2c_f32_bf16 v244, s50, v234
    v_dot2c_f32_bf16 v246, v234, v234
    v_dot2c_f32_bf16 v245, s50, v235
    v_dot2c_f32_bf16 v247, v235, v235
    s_waitcnt lgkmcnt(0)
    v_dot2c_f32_bf16 v244, s50, v236
    v_dot2c_f32_bf16 v246, v236, v236
    v_dot2c_f32_bf16 v245, s50, v237
    v_dot2c_f32_bf16 v247, v237, v237
    v_dot2c_f32_bf16 v244, s50, v238
    v_dot2c_f32_bf16 v246, v238, v238
    v_dot2c_f32_bf16 v245, s50, v239
    v_dot2c_f32_bf16 v247, v239, v239
    v_and_b32 v240, 1, v0
    v_cmp_eq_u32 vcc, 0, v240
    v_add_f32 v244, v244, v245
    v_add_f32 v246, v246, v247
    s_nop 0
    s_nop 0
    v_add_f32_dpp v245, v244, v244 quad_perm:[1,0,3,2] row_mask:0xf bank_mask:0xf
    v_add_f32_dpp v247, v246, v246 quad_perm:[1,0,3,2] row_mask:0xf bank_mask:0xf
    v_cndmask_b32 v253, v247, v245, vcc
    s_mov_b32 s61, s48
    s_mov_b64 vcc, 0
    s_branch midr_176
sigs_179:
    buffer_store_dword v254, v14, s[16:19], 0 offen sc1
    s_branch sigd_180
xpl_185:
    s_nop 0
    buffer_load_dwordx4 v[192:195], v15, s[16:19], s55 offen offset:0 sc1
    buffer_load_dwordx4 v[196:199], v15, s[16:19], s55 offen offset:1024 sc1
    buffer_load_dwordx4 v[200:203], v15, s[16:19], s55 offen offset:2048 sc1
    buffer_load_dwordx4 v[204:207], v15, s[16:19], s55 offen offset:3072 sc1
    s_branch xpc_186
sigs_3192:
    s_nop 0
    buffer_store_dword v254, v14, s[16:19], 0 offen sc1
    s_branch sigd_3193
mid_192:
    s_lshl_b32 s58, s7, 1
    s_add_u32 s58, s58, 1
    s_nop 0
    v_bfe_u32 v240, v0, 2, 2
    v_lshlrev_b32_e64 v240, 4, v240
    v_lshl_add_u32 v240, v0, 6, v240
    s_lshl_b32 s48, s6, 12
    s_nop 0
    s_add_u32 s48, s48, 135168
    v_add_u32 v240, s48, v240
    v_xor_b32 v241, 0, v240
    ds_read_b128 v[224:227], v241
    v_xor_b32_e64 v241, 16, v240
    ds_read_b128 v[228:231], v241
    v_xor_b32_e64 v241, 32, v240
    ds_read_b128 v[232:235], v241
    v_xor_b32_e64 v241, 48, v240
    ds_read_b128 v[236:239], v241
    v_mov_b32 v244, 0
    v_mov_b32 v245, 0
    v_mov_b32 v246, 0
    v_mov_b32 v247, 0
    s_mov_b32 s50, 0x3f803f80
    s_lshl_b32 s48, s58, 18
    s_lshl_b32 s49, s3, 14
    s_add_u32 s48, s48, s49
    s_lshl_b32 s49, s4, 10
    s_add_u32 s48, s48, s49
    s_lshl_b32 s49, s6, 8
    s_add_u32 s48, s48, s49
    s_nop 0
    s_add_u32 s48, s48, 1048576
    s_waitcnt lgkmcnt(3)
    v_dot2c_f32_bf16 v244, s50, v224
    v_dot2c_f32_bf16 v246, v224, v224
    v_dot2c_f32_bf16 v245, s50, v225
    v_dot2c_f32_bf16 v247, v225, v225
    v_dot2c_f32_bf16 v244, s50, v226
    v_dot2c_f32_bf16 v246, v226, v226
    v_dot2c_f32_bf16 v245, s50, v227
    v_dot2c_f32_bf16 v247, v227, v227
    s_waitcnt lgkmcnt(2)
    v_dot2c_f32_bf16 v244, s50, v228
    v_dot2c_f32_bf16 v246, v228, v228
    v_dot2c_f32_bf16 v245, s50, v229
    v_dot2c_f32_bf16 v247, v229, v229
    v_dot2c_f32_bf16 v244, s50, v230
    v_dot2c_f32_bf16 v246, v230, v230
    v_dot2c_f32_bf16 v245, s50, v231
    v_dot2c_f32_bf16 v247, v231, v231
    s_waitcnt lgkmcnt(1)
    v_dot2c_f32_bf16 v244, s50, v232
    v_dot2c_f32_bf16 v246, v232, v232
    v_dot2c_f32_bf16 v245, s50, v233
    v_dot2c_f32_bf16 v247, v233, v233
    v_dot2c_f32_bf16 v244, s50, v234
    v_dot2c_f32_bf16 v246, v234, v234
    v_dot2c_f32_bf16 v245, s50, v235
    v_dot2c_f32_bf16 v247, v235, v235
    s_waitcnt lgkmcnt(0)
    v_dot2c_f32_bf16 v244, s50, v236
    v_dot2c_f32_bf16 v246, v236, v236
    v_dot2c_f32_bf16 v245, s50, v237
    v_dot2c_f32_bf16 v247, v237, v237
    v_dot2c_f32_bf16 v244, s50, v238
    v_dot2c_f32_bf16 v246, v238, v238
    v_dot2c_f32_bf16 v245, s50, v239
    v_dot2c_f32_bf16 v247, v239, v239
    v_and_b32 v240, 1, v0
    v_cmp_eq_u32 vcc, 0, v240
    v_add_f32 v244, v244, v245
    v_add_f32 v246, v246, v247
    s_nop 0
    s_nop 0
    v_add_f32_dpp v245, v244, v244 quad_perm:[1,0,3,2] row_mask:0xf bank_mask:0xf
    v_add_f32_dpp v247, v246, v246 quad_perm:[1,0,3,2] row_mask:0xf bank_mask:0xf
    v_cndmask_b32 v253, v247, v245, vcc
    s_mov_b32 s61, s48
    s_mov_b64 vcc, 0
    s_branch midr_193
sms_194:
    buffer_store_dwordx4 v[224:227], v1, s[16:19], s50 offen offset:0 sc1
    s_branch smd_195
sms_196:
    s_nop 0
    buffer_store_dwordx4 v[228:231], v1, s[16:19], s50 offen offset:2048 sc1
    s_branch smd_197
sms_198:
    s_nop 0
    buffer_store_dwordx4 v[232:235], v1, s[16:19], s51 offen offset:0 sc1
    s_branch smd_199
sms_200:
    s_nop 0
    buffer_store_dwordx4 v[236:239], v1, s[16:19], s51 offen offset:2048 sc1
    s_branch smd_201
sigs_202:
    s_nop 0
    buffer_store_dword v254, v14, s[16:19], 0 offen sc1
    s_branch sigd_203
sms_204:
    s_nop 0
    buffer_store_dwordx2 v[224:225], v1, s[16:19], s52 offen offset:0 sc1
    buffer_store_dwordx2 v[226:227], v1, s[16:19], s52 offen offset:2048 sc1
    s_branch smd_205
sms_206:
    s_nop 0
    buffer_store_dwordx2 v[228:229], v1, s[16:19], s53 offen offset:0 sc1
    buffer_store_dwordx2 v[230:231], v1, s[16:19], s53 offen offset:2048 sc1
    s_branch smd_207
sms_208:
    s_nop 0
    buffer_store_dwordx4 v[232:235], v1, s[16:19], s50 offen offset:0 sc1
    s_branch smd_209
sms_210:
    s_nop 0
    buffer_store_dwordx4 v[236:239], v1, s[16:19], s50 offen offset:2048 sc1
    s_branch smd_211
sms_212:
    s_nop 0
    buffer_store_dwordx4 v[224:227], v1, s[16:19], s51 offen offset:0 sc1
    s_branch smd_213
sms_214:
    s_nop 0
    buffer_store_dwordx4 v[228:231], v1, s[16:19], s51 offen offset:2048 sc1
    s_branch smd_215
sigs_216:
    s_nop 0
    buffer_store_dword v254, v14, s[16:19], 0 offen sc1
    s_branch sigd_217
sigs_221:
    s_nop 0
    buffer_store_dword v254, v14, s[16:19], 0 offen sc1
    s_branch sigd_222
L_end:
    s_endpgm
.fill 64, 4, 0xBF800000
.section .rodata,"a"
.p2align 6
.amdhsa_kernel interleave_layers__linear_attn_block__dense_activation_gelu__prompt_kernel
  .amdhsa_next_free_vgpr 256
  .amdhsa_next_free_sgpr 102
  .amdhsa_accum_offset 256
  .amdhsa_group_segment_fixed_size 0
  .amdhsa_kernarg_size 88
  .amdhsa_user_sgpr_count 2
  .amdhsa_user_sgpr_kernarg_segment_ptr 1
  .amdhsa_system_sgpr_workgroup_id_x 1
  .amdhsa_float_denorm_mode_32 3
.end_amdhsa_kernel
```
